```python
import torch

def _softmax(x, axis=-1):
    return torch.softmax(x, dim=axis)
def _gelu(x):
    return torch.nn.functional.gelu(x, approximate="tanh")
def _silu(x):
    return torch.nn.functional.silu(x)
def _sigmoid(x):
    return torch.sigmoid(x)
def _layernorm(x, axis=-1, eps=1e-5):
    m = x.mean(dim=axis, keepdim=True)
    v = x.var(dim=axis, keepdim=True, unbiased=False)
    return (x - m) / torch.sqrt(v + eps)
def _scatter_add(tgt, idx, src, axis=0):
    return tgt.clone().index_add_(axis, idx, src)
def _segment_sum(src, seg, n):
    out = torch.zeros((n,) + src.shape[1:], dtype=src.dtype)
    return out.index_add_(0, seg, src)
def _pad(x, pw):
    flat = tuple(v for pair in reversed(pw) for v in pair)
    return torch.nn.functional.pad(x, flat)

kernel_name = 'interleave_layers__softmax_full_mha__glu_gated_glu__prompt'

def setup_inputs():

    _w = (lambda a: (lambda t: t.to(torch.bfloat16) if t.is_floating_point() else t)(torch.as_tensor(a)))
    def _A_setup():
        B, S, D = 1, 2048, 512
        return {
            "x": _w((lambda *s: torch.randn(*s, dtype=torch.bfloat16) * 0.05)(B, S, D)),
            "wqkv": _w((lambda *s: torch.randn(*s, dtype=torch.bfloat16) * 0.05)(D, 3 * D)),
            "wo": _w((lambda *s: torch.randn(*s, dtype=torch.bfloat16) * 0.05)(D, D)),
        }
    _A_in = _A_setup()

    def _B_setup():
        B, S, D, F = 1, 2048, 512, 1792
        return {
            "x": _w((lambda *s: torch.randn(*s, dtype=torch.bfloat16) * 0.05)(B, S, D)),
            "w_gate": _w((lambda *s: torch.randn(*s, dtype=torch.bfloat16) * 0.05)(D, F)),
            "w_up": _w((lambda *s: torch.randn(*s, dtype=torch.bfloat16) * 0.05)(D, F)),
            "w_down": _w((lambda *s: torch.randn(*s, dtype=torch.bfloat16) * 0.05)(F, D)),
        }
    _B_in = _B_setup()

    return {
        "A_x": _A_in["x"],
        "A_wqkv": _A_in["wqkv"],
        "A_wo": _A_in["wo"],
        "B_x": _B_in["x"],
        "B_w_gate": _B_in["w_gate"],
        "B_w_up": _B_in["w_up"],
        "B_w_down": _B_in["w_down"],
    }

def reference(A_x, A_wqkv, A_wo, B_x, B_w_gate, B_w_up, B_w_down):
    def _A_ref(x, wqkv, wo):
        B, S, D = x.shape
        H = 32; Dh = D // H
        qkv = (lambda x, *d: x.permute(*d))((x @ wqkv).reshape(B, S, 3, H, Dh), 2, 0, 3, 1, 4)
        q, k, v = qkv[0], qkv[1], qkv[2]
        scale = Dh ** -0.5
        scores = torch.einsum("bhqd,bhkd->bhqk", q, k) * scale
        p = _softmax(scores, axis=-1)
        o = torch.einsum("bhqk,bhkd->bhqd", p, v)
        return (lambda x, *d: x.permute(*d))(o, 0, 2, 1, 3).reshape(B, S, D) @ wo

    def _B_ref(x, w_gate, w_up, w_down):
        g = torch.einsum("bsd,df->bsf", x, w_gate)
        u = torch.einsum("bsd,df->bsf", x, w_up)
        h = _sigmoid(g) * u
        return torch.einsum("bsf,fd->bsd", h, w_down)

    x = A_x
    x = x + _A_ref(_layernorm(x, axis=-1), A_wqkv, A_wo)
    x = x + _B_ref(_layernorm(x, axis=-1), B_w_gate, B_w_up, B_w_down)
    x = x + _A_ref(_layernorm(x, axis=-1), A_wqkv, A_wo)
    x = x + _B_ref(_layernorm(x, axis=-1), B_w_gate, B_w_up, B_w_down)
    return x
```

```asm
; @launch grid=(256,1,1) block=(512,1,1) lds=150528
.amdgcn_target "amdgcn-amd-amdhsa--gfx950"
.text
.globl interleave_layers__softmax_full_mha__glu_gated_glu__prompt_kernel
.p2align 8
.type interleave_layers__softmax_full_mha__glu_gated_glu__prompt_kernel,@function
interleave_layers__softmax_full_mha__glu_gated_glu__prompt_kernel:
    s_cmp_ge_u32 s2, 256
    s_cbranch_scc1 KEND
    s_load_dwordx16 s[64:79], s[0:1], 0
    s_load_dwordx4 s[80:83], s[0:1], 64
    s_getpc_b64 s[30:31]
CPF_PC:
    s_lshr_b32 s28, s2, 3
    s_lshl_b32 s28, s28, 4
    v_add_u32 v6, s28, v0
    v_subrev_u32 v7, 16, v0
    v_cmp_gt_u32 vcc, 16, v0
    s_nop 1
    v_cndmask_b32 v6, v7, v6, vcc
    v_add_u32 v7, ((C_START-CPF_PC)>>7)-40, v0
    v_cmp_le_u32 vcc, 40, v0
    s_nop 1
    v_cndmask_b32 v6, v6, v7, vcc
    v_lshlrev_b32 v6, 7, v6
    v_min_u32 v6, KEND-CPF_PC, v6
    v_cmp_gt_u32 vcc, 64, v0
    s_nop 1
    s_mov_b64 exec, vcc
    global_load_dword v240, v6, s[30:31]
    s_mov_b64 exec, -1
    v_lshrrev_b32 v2, 6, v0
    v_and_b32 v1, 63, v0
    v_readfirstlane_b32 s3, v2
    s_and_b32 s28, s2, 7
    s_lshr_b32 s29, s2, 3
    s_and_b32 s30, s28, 1
    s_lshl_b32 s30, s30, 2
    s_and_b32 s31, s29, 3
    s_add_u32 s84, s30, s31
    s_lshr_b32 s31, s28, 1
    s_lshl_b32 s31, s31, 3
    s_lshr_b32 s32, s29, 2
    s_add_u32 s85, s31, s32
    s_lshl_b32 s30, s28, 2
    s_and_b32 s31, s29, 3
    s_add_u32 s86, s30, s31
    s_lshr_b32 s87, s29, 2
    s_mov_b32 s88, s86
    s_mov_b32 s89, s87
    s_and_b32 s30, s28, 1
    s_mul_i32 s30, s30, 7
    s_lshr_b32 s31, s29, 2
    s_add_u32 s91, s30, s31
    s_lshr_b32 s31, s28, 1
    s_lshl_b32 s31, s31, 2
    s_and_b32 s32, s29, 3
    s_add_u32 s90, s31, s32
    s_mov_b32 s5, 0
    s_mov_b32 s6, 0
    s_mov_b32 s4, 0
    s_waitcnt lgkmcnt(0)
    s_cmp_lt_u32 s3, 4
    s_cbranch_scc1 C_START
    v_lshrrev_b32 v2, 4, v1
    v_and_b32 v3, 15, v1
    v_lshrrev_b32 v3, 2, v3
    v_lshrrev_b32 v4, 5, v1
    v_and_b32 v5, 31, v1
    s_sub_u32 s33, s3, 4
    s_mov_b32 s12, s66
    s_mov_b32 s13, s67
    s_mov_b32 s14, 1572864
    s_mov_b32 s15, 0x20000
    v_lshrrev_b32 v6, 3, v1
    v_and_b32 v7, 7, v1
    v_add_u32 v12, 0, v2
    v_and_b32 v12, 7, v12
    v_xor_b32 v12, v12, v7
    v_lshlrev_b32 v12, 4, v12
    v_lshlrev_b32 v13, 10, v6
    v_add_u32 v8, v12, v13
    v_add_u32 v12, 4, v2
    v_and_b32 v12, 7, v12
    v_xor_b32 v12, v12, v7
    v_lshlrev_b32 v12, 4, v12
    v_lshlrev_b32 v13, 10, v6
    v_add_u32 v9, v12, v13
    s_mov_b32 s35, 3072
    v_mul_lo_u32 v13, v6, s35
    v_and_b32 v12, 1, v2
    v_lshlrev_b32 v12, 2, v12
    v_xor_b32 v12, v12, v7
    v_lshlrev_b32 v14, 4, v12
    v_add_u32 v10, v13, v14
    s_mul_i32 s36, s85, 65536
    s_mul_i32 s37, s33, 16384
    s_add_u32 s36, s36, s37
    s_mul_i32 s37, s33, 49152
    s_lshl_b32 s38, s84, 7
    s_add_u32 s37, s37, s38
    s_mul_i32 s38, s33, 2048
    s_lshl_b32 s39, s33, 11
    s_add_u32 s39, s39, 49152
    s_add_u32 s8, s82, 2097152
    s_addc_u32 s9, s83, 0
    s_cmp_eq_u32 s5, 0
    s_cselect_b32 s8, s64, s8
    s_cselect_b32 s9, s65, s9
    s_mov_b32 s10, 2097152
    s_mov_b32 s11, 0x20000
    s_add_u32 m0, s38, 0
    s_add_u32 s40, s36, 0
    buffer_load_dwordx4 v8, s[8:11], s40 offen sc1 lds
    s_add_u32 m0, s38, 1024
    s_add_u32 s40, s36, 8192
    buffer_load_dwordx4 v9, s[8:11], s40 offen sc1 lds
    s_add_u32 m0, s39, 0
    s_add_u32 s40, s37, 0
    buffer_load_dwordx4 v10, s[12:15], s40 offen lds
    s_add_u32 m0, s39, 1024
    s_add_u32 s40, s37, 24576
    buffer_load_dwordx4 v10, s[12:15], s40 offen lds
    s_add_u32 m0, s39, 8192
    s_add_u32 s40, s37, 1024
    buffer_load_dwordx4 v10, s[12:15], s40 offen lds
    s_add_u32 m0, s39, 9216
    s_add_u32 s40, s37, 25600
    buffer_load_dwordx4 v10, s[12:15], s40 offen lds
    s_add_u32 m0, s39, 16384
    s_add_u32 s40, s37, 2048
    buffer_load_dwordx4 v10, s[12:15], s40 offen lds
    s_add_u32 m0, s39, 17408
    s_add_u32 s40, s37, 26624
    buffer_load_dwordx4 v10, s[12:15], s40 offen lds
    s_add_u32 m0, s38, 8192
    s_add_u32 s40, s36, 128
    buffer_load_dwordx4 v8, s[8:11], s40 offen sc1 lds
    s_add_u32 m0, s38, 9216
    s_add_u32 s40, s36, 8320
    buffer_load_dwordx4 v9, s[8:11], s40 offen sc1 lds
    s_add_u32 m0, s39, 24576
    s_add_u32 s40, s37, 196608
    buffer_load_dwordx4 v10, s[12:15], s40 offen lds
    s_add_u32 m0, s39, 25600
    s_add_u32 s40, s37, 221184
    buffer_load_dwordx4 v10, s[12:15], s40 offen lds
    s_add_u32 m0, s39, 32768
    s_add_u32 s40, s37, 197632
    buffer_load_dwordx4 v10, s[12:15], s40 offen lds
    s_add_u32 m0, s39, 33792
    s_add_u32 s40, s37, 222208
    buffer_load_dwordx4 v10, s[12:15], s40 offen lds
    s_add_u32 m0, s39, 40960
    s_add_u32 s40, s37, 198656
    buffer_load_dwordx4 v10, s[12:15], s40 offen lds
    s_add_u32 m0, s39, 41984
    s_add_u32 s40, s37, 223232
    buffer_load_dwordx4 v10, s[12:15], s40 offen lds
    s_add_u32 m0, s38, 16384
    s_add_u32 s40, s36, 256
    buffer_load_dwordx4 v8, s[8:11], s40 offen sc1 lds
    s_add_u32 m0, s38, 17408
    s_add_u32 s40, s36, 8448
    buffer_load_dwordx4 v9, s[8:11], s40 offen sc1 lds
    s_add_u32 m0, s39, 49152
    s_add_u32 s40, s37, 393216
    buffer_load_dwordx4 v10, s[12:15], s40 offen lds
    s_add_u32 m0, s39, 50176
    s_add_u32 s40, s37, 417792
    buffer_load_dwordx4 v10, s[12:15], s40 offen lds
    s_add_u32 m0, s39, 57344
    s_add_u32 s40, s37, 394240
    buffer_load_dwordx4 v10, s[12:15], s40 offen lds
    s_add_u32 m0, s39, 58368
    s_add_u32 s40, s37, 418816
    buffer_load_dwordx4 v10, s[12:15], s40 offen lds
    s_add_u32 m0, s39, 65536
    s_add_u32 s40, s37, 395264
    buffer_load_dwordx4 v10, s[12:15], s40 offen lds
    s_add_u32 m0, s39, 66560
    s_add_u32 s40, s37, 419840
    buffer_load_dwordx4 v10, s[12:15], s40 offen lds
    v_lshlrev_b32 v12, 4, v1
    v_add_u32 v16, s38, v12
    v_mov_b32 v44, 0
    v_mov_b32 v45, 0
    v_mov_b32 v46, 0
    v_mov_b32 v47, 0
    v_mov_b32 v56, 0x3f803f80
    v_lshlrev_b32 v6, 3, v4
    v_add_u32 v6, v6, v3
    v_lshlrev_b32 v6, 7, v6
    v_and_b32 v7, 3, v1
    v_lshlrev_b32 v7, 3, v7
    v_add_u32 v6, v6, v7
    v_lshrrev_b32 v7, 1, v3
    v_lshlrev_b32 v7, 6, v7
    v_add_u32 v6, v6, v7
    v_and_b32 v13, 1, v2
    v_lshlrev_b32 v7, 5, v13
    v_add_u32 v6, v6, v7
    s_and_b32 s41, s33, 1
    s_lshl_b32 s42, s41, 6
    v_xor_b32 v6, s42, v6
    s_lshr_b32 s42, s33, 1
    s_lshl_b32 s42, s42, 13
    s_add_u32 s42, s42, 49152
    v_add_u32 v7, s42, v6
    v_add_u32 v13, 65536, v6
    v_add_u32 v20, 0, v7
    v_add_u32 v21, 0, v13
    v_add_u32 v22, 24576, v7
    v_add_u32 v23, 24576, v13
    v_add_u32 v24, 49152, v7
    v_add_u32 v25, 49152, v13
    v_add_u32 v26, 73728, v7
    v_add_u32 v27, 73728, v13
    s_lshl_b32 s43, s33, 7
    s_lshl_b32 s44, s41, 7
    s_add_u32 s44, s44, 512
    v_lshrrev_b32 v6, 3, v1
    v_and_b32 v6, 1, v6
    v_and_b32 v7, 1, v2
    v_xor_b32 v6, v6, v7
    v_cmp_eq_u32 vcc, 0, v6
    v_mov_b32 v7, 0x3f803f80
    s_nop 0
    v_cndmask_b32 v32, 0, v7, vcc
    v_cndmask_b32 v33, 0, v7, vcc
    v_cndmask_b32 v34, 0, v7, vcc
    v_cndmask_b32 v35, 0, v7, vcc
    v_mov_b32 v36, 0
    v_mov_b32 v37, 0
    v_mov_b32 v38, 0
    v_mov_b32 v39, 0
    v_mov_b32 v40, 0
    v_mov_b32 v41, 0
    v_mov_b32 v42, 0
    v_mov_b32 v43, 0
    s_setprio 2
    s_waitcnt vmcnt(16)
    s_barrier
    ds_read_b128 v[64:67], v16 offset:0
    ds_read_b128 v[68:71], v16 offset:1024
    ds_read_b64_tr_b16 v[96:97], v20 offset:0
    ds_read_b64_tr_b16 v[98:99], v20 offset:512
    ds_read_b64_tr_b16 v[100:101], v21 offset:0
    ds_read_b64_tr_b16 v[102:103], v21 offset:512
    ds_read_b64_tr_b16 v[104:105], v20 offset:2048
    ds_read_b64_tr_b16 v[106:107], v20 offset:2560
    ds_read_b64_tr_b16 v[108:109], v21 offset:2048
    ds_read_b64_tr_b16 v[110:111], v21 offset:2560
    ds_read_b64_tr_b16 v[112:113], v20 offset:4096
    ds_read_b64_tr_b16 v[114:115], v20 offset:4608
    ds_read_b64_tr_b16 v[116:117], v21 offset:4096
    ds_read_b64_tr_b16 v[118:119], v21 offset:4608
    ds_read_b64_tr_b16 v[120:121], v20 offset:6144
    ds_read_b64_tr_b16 v[122:123], v20 offset:6656
    ds_read_b64_tr_b16 v[124:125], v21 offset:6144
    ds_read_b64_tr_b16 v[126:127], v21 offset:6656
    s_add_u32 m0, s38, 24576
    s_add_u32 s40, s36, 384
    buffer_load_dwordx4 v8, s[8:11], s40 offen sc1 lds
    s_add_u32 m0, s38, 25600
    s_add_u32 s40, s36, 8576
    buffer_load_dwordx4 v9, s[8:11], s40 offen sc1 lds
    s_waitcnt lgkmcnt(15)
    v_dot2_f32_bf16 v44, v64, v56, v44
    v_dot2_f32_bf16 v45, v64, v64, v45
    s_add_u32 m0, s39, 73728
    s_add_u32 s40, s37, 589824
    buffer_load_dwordx4 v10, s[12:15], s40 offen lds
    v_dot2_f32_bf16 v44, v65, v56, v44
    v_dot2_f32_bf16 v45, v65, v65, v45
    v_dot2_f32_bf16 v44, v66, v56, v44
    v_dot2_f32_bf16 v45, v66, v66, v45
    s_add_u32 m0, s39, 74752
    s_add_u32 s40, s37, 614400
    buffer_load_dwordx4 v10, s[12:15], s40 offen lds
    v_dot2_f32_bf16 v44, v67, v56, v44
    v_dot2_f32_bf16 v45, v67, v67, v45
    v_dot2_f32_bf16 v46, v68, v56, v46
    v_dot2_f32_bf16 v47, v68, v68, v47
    s_add_u32 m0, s39, 81920
    s_add_u32 s40, s37, 590848
    buffer_load_dwordx4 v10, s[12:15], s40 offen lds
    v_dot2_f32_bf16 v46, v69, v56, v46
    v_dot2_f32_bf16 v47, v69, v69, v47
    v_dot2_f32_bf16 v46, v70, v56, v46
    v_dot2_f32_bf16 v47, v70, v70, v47
    s_add_u32 m0, s39, 82944
    s_add_u32 s40, s37, 615424
    buffer_load_dwordx4 v10, s[12:15], s40 offen lds
    v_dot2_f32_bf16 v46, v71, v56, v46
    v_dot2_f32_bf16 v47, v71, v71, v47
    s_waitcnt lgkmcnt(0)
    s_add_u32 m0, s39, 90112
    s_add_u32 s40, s37, 591872
    buffer_load_dwordx4 v10, s[12:15], s40 offen lds
    v_mfma_f32_16x16x32_bf16 v[36:39], v[32:35], v[96:99], v[36:39]
    v_mfma_f32_16x16x32_bf16 v[40:43], v[32:35], v[100:103], v[40:43]
    v_mfma_f32_16x16x32_bf16 v[36:39], v[32:35], v[104:107], v[36:39]
    v_mfma_f32_16x16x32_bf16 v[40:43], v[32:35], v[108:111], v[40:43]
    s_add_u32 m0, s39, 91136
    s_add_u32 s40, s37, 616448
    buffer_load_dwordx4 v10, s[12:15], s40 offen lds
    v_mfma_f32_16x16x32_bf16 v[36:39], v[32:35], v[112:115], v[36:39]
    v_mfma_f32_16x16x32_bf16 v[40:43], v[32:35], v[116:119], v[40:43]
    v_mfma_f32_16x16x32_bf16 v[36:39], v[32:35], v[120:123], v[36:39]
    v_mfma_f32_16x16x32_bf16 v[40:43], v[32:35], v[124:127], v[40:43]
    s_add_u32 m0, s38, 32768
    s_add_u32 s40, s36, 512
    buffer_load_dwordx4 v8, s[8:11], s40 offen sc1 lds
    s_add_u32 m0, s38, 33792
    s_add_u32 s40, s36, 8704
    buffer_load_dwordx4 v9, s[8:11], s40 offen sc1 lds
    s_add_u32 m0, s38, 40960
    s_add_u32 s40, s36, 640
    buffer_load_dwordx4 v8, s[8:11], s40 offen sc1 lds
    s_add_u32 m0, s38, 41984
    s_add_u32 s40, s36, 8832
    buffer_load_dwordx4 v9, s[8:11], s40 offen sc1 lds
    s_waitcnt vmcnt(20)
    s_barrier
    ds_read_b128 v[64:67], v16 offset:8192
    ds_read_b128 v[68:71], v16 offset:9216
    ds_read_b64_tr_b16 v[96:97], v22 offset:0
    ds_read_b64_tr_b16 v[98:99], v22 offset:512
    ds_read_b64_tr_b16 v[100:101], v23 offset:0
    ds_read_b64_tr_b16 v[102:103], v23 offset:512
    ds_read_b64_tr_b16 v[104:105], v22 offset:2048
    ds_read_b64_tr_b16 v[106:107], v22 offset:2560
    ds_read_b64_tr_b16 v[108:109], v23 offset:2048
    ds_read_b64_tr_b16 v[110:111], v23 offset:2560
    ds_read_b64_tr_b16 v[112:113], v22 offset:4096
    ds_read_b64_tr_b16 v[114:115], v22 offset:4608
    ds_read_b64_tr_b16 v[116:117], v23 offset:4096
    ds_read_b64_tr_b16 v[118:119], v23 offset:4608
    ds_read_b64_tr_b16 v[120:121], v22 offset:6144
    ds_read_b64_tr_b16 v[122:123], v22 offset:6656
    ds_read_b64_tr_b16 v[124:125], v23 offset:6144
    ds_read_b64_tr_b16 v[126:127], v23 offset:6656
    s_add_u32 m0, s38, 0
    s_add_u32 s40, s36, 768
    buffer_load_dwordx4 v8, s[8:11], s40 offen sc1 lds
    s_add_u32 m0, s38, 1024
    s_add_u32 s40, s36, 8960
    buffer_load_dwordx4 v9, s[8:11], s40 offen sc1 lds
    s_waitcnt lgkmcnt(15)
    v_dot2_f32_bf16 v44, v64, v56, v44
    v_dot2_f32_bf16 v45, v64, v64, v45
    v_dot2_f32_bf16 v44, v65, v56, v44
    v_dot2_f32_bf16 v45, v65, v65, v45
    s_add_u32 m0, s39, 0
    s_add_u32 s40, s37, 786432
    buffer_load_dwordx4 v10, s[12:15], s40 offen lds
    v_dot2_f32_bf16 v44, v66, v56, v44
    v_dot2_f32_bf16 v45, v66, v66, v45
    v_dot2_f32_bf16 v44, v67, v56, v44
    v_dot2_f32_bf16 v45, v67, v67, v45
    v_dot2_f32_bf16 v46, v68, v56, v46
    v_dot2_f32_bf16 v47, v68, v68, v47
    s_add_u32 m0, s39, 1024
    s_add_u32 s40, s37, 811008
    buffer_load_dwordx4 v10, s[12:15], s40 offen lds
    v_dot2_f32_bf16 v46, v69, v56, v46
    v_dot2_f32_bf16 v47, v69, v69, v47
    v_dot2_f32_bf16 v46, v70, v56, v46
    v_dot2_f32_bf16 v47, v70, v70, v47
    v_dot2_f32_bf16 v46, v71, v56, v46
    v_dot2_f32_bf16 v47, v71, v71, v47
    s_add_u32 m0, s39, 8192
    s_add_u32 s40, s37, 787456
    buffer_load_dwordx4 v10, s[12:15], s40 offen lds
    s_waitcnt lgkmcnt(0)
    v_mfma_f32_16x16x32_bf16 v[36:39], v[32:35], v[96:99], v[36:39]
    v_mfma_f32_16x16x32_bf16 v[40:43], v[32:35], v[100:103], v[40:43]
    v_mfma_f32_16x16x32_bf16 v[36:39], v[32:35], v[104:107], v[36:39]
    v_mfma_f32_16x16x32_bf16 v[40:43], v[32:35], v[108:111], v[40:43]
    s_add_u32 m0, s39, 9216
    s_add_u32 s40, s37, 812032
    buffer_load_dwordx4 v10, s[12:15], s40 offen lds
    v_mfma_f32_16x16x32_bf16 v[36:39], v[32:35], v[112:115], v[36:39]
    v_mfma_f32_16x16x32_bf16 v[40:43], v[32:35], v[116:119], v[40:43]
    v_mfma_f32_16x16x32_bf16 v[36:39], v[32:35], v[120:123], v[36:39]
    v_mfma_f32_16x16x32_bf16 v[40:43], v[32:35], v[124:127], v[40:43]
    s_add_u32 m0, s39, 16384
    s_add_u32 s40, s37, 788480
    buffer_load_dwordx4 v10, s[12:15], s40 offen lds
    s_add_u32 m0, s39, 17408
    s_add_u32 s40, s37, 813056
    buffer_load_dwordx4 v10, s[12:15], s40 offen lds
    s_waitcnt vmcnt(20)
    s_barrier
    ds_read_b128 v[64:67], v16 offset:16384
    ds_read_b128 v[68:71], v16 offset:17408
    ds_read_b64_tr_b16 v[96:97], v24 offset:0
    ds_read_b64_tr_b16 v[98:99], v24 offset:512
    ds_read_b64_tr_b16 v[100:101], v25 offset:0
    ds_read_b64_tr_b16 v[102:103], v25 offset:512
    ds_read_b64_tr_b16 v[104:105], v24 offset:2048
    ds_read_b64_tr_b16 v[106:107], v24 offset:2560
    ds_read_b64_tr_b16 v[108:109], v25 offset:2048
    ds_read_b64_tr_b16 v[110:111], v25 offset:2560
    ds_read_b64_tr_b16 v[112:113], v24 offset:4096
    ds_read_b64_tr_b16 v[114:115], v24 offset:4608
    ds_read_b64_tr_b16 v[116:117], v25 offset:4096
    ds_read_b64_tr_b16 v[118:119], v25 offset:4608
    ds_read_b64_tr_b16 v[120:121], v24 offset:6144
    ds_read_b64_tr_b16 v[122:123], v24 offset:6656
    ds_read_b64_tr_b16 v[124:125], v25 offset:6144
    ds_read_b64_tr_b16 v[126:127], v25 offset:6656
    s_add_u32 m0, s38, 8192
    s_add_u32 s40, s36, 896
    buffer_load_dwordx4 v8, s[8:11], s40 offen sc1 lds
    s_add_u32 m0, s38, 9216
    s_add_u32 s40, s36, 9088
    buffer_load_dwordx4 v9, s[8:11], s40 offen sc1 lds
    s_waitcnt lgkmcnt(15)
    v_dot2_f32_bf16 v44, v64, v56, v44
    v_dot2_f32_bf16 v45, v64, v64, v45
    v_dot2_f32_bf16 v44, v65, v56, v44
    v_dot2_f32_bf16 v45, v65, v65, v45
    s_add_u32 m0, s39, 24576
    s_add_u32 s40, s37, 983040
    buffer_load_dwordx4 v10, s[12:15], s40 offen lds
    v_dot2_f32_bf16 v44, v66, v56, v44
    v_dot2_f32_bf16 v45, v66, v66, v45
    v_dot2_f32_bf16 v44, v67, v56, v44
    v_dot2_f32_bf16 v45, v67, v67, v45
    v_dot2_f32_bf16 v46, v68, v56, v46
    v_dot2_f32_bf16 v47, v68, v68, v47
    s_add_u32 m0, s39, 25600
    s_add_u32 s40, s37, 1007616
    buffer_load_dwordx4 v10, s[12:15], s40 offen lds
    v_dot2_f32_bf16 v46, v69, v56, v46
    v_dot2_f32_bf16 v47, v69, v69, v47
    v_dot2_f32_bf16 v46, v70, v56, v46
    v_dot2_f32_bf16 v47, v70, v70, v47
    v_dot2_f32_bf16 v46, v71, v56, v46
    v_dot2_f32_bf16 v47, v71, v71, v47
    s_add_u32 m0, s39, 32768
    s_add_u32 s40, s37, 984064
    buffer_load_dwordx4 v10, s[12:15], s40 offen lds
    s_waitcnt lgkmcnt(0)
    v_mfma_f32_16x16x32_bf16 v[36:39], v[32:35], v[96:99], v[36:39]
    v_mfma_f32_16x16x32_bf16 v[40:43], v[32:35], v[100:103], v[40:43]
    v_mfma_f32_16x16x32_bf16 v[36:39], v[32:35], v[104:107], v[36:39]
    v_mfma_f32_16x16x32_bf16 v[40:43], v[32:35], v[108:111], v[40:43]
    s_add_u32 m0, s39, 33792
    s_add_u32 s40, s37, 1008640
    buffer_load_dwordx4 v10, s[12:15], s40 offen lds
    v_mfma_f32_16x16x32_bf16 v[36:39], v[32:35], v[112:115], v[36:39]
    v_mfma_f32_16x16x32_bf16 v[40:43], v[32:35], v[116:119], v[40:43]
    v_mfma_f32_16x16x32_bf16 v[36:39], v[32:35], v[120:123], v[36:39]
    v_mfma_f32_16x16x32_bf16 v[40:43], v[32:35], v[124:127], v[40:43]
    s_add_u32 m0, s39, 40960
    s_add_u32 s40, s37, 985088
    buffer_load_dwordx4 v10, s[12:15], s40 offen lds
    s_add_u32 m0, s39, 41984
    s_add_u32 s40, s37, 1009664
    buffer_load_dwordx4 v10, s[12:15], s40 offen lds
    s_waitcnt vmcnt(20)
    s_barrier
    ds_read_b128 v[64:67], v16 offset:24576
    ds_read_b128 v[68:71], v16 offset:25600
    ds_read_b64_tr_b16 v[96:97], v26 offset:0
    ds_read_b64_tr_b16 v[98:99], v26 offset:512
    ds_read_b64_tr_b16 v[100:101], v27 offset:0
    ds_read_b64_tr_b16 v[102:103], v27 offset:512
    ds_read_b64_tr_b16 v[104:105], v26 offset:2048
    ds_read_b64_tr_b16 v[106:107], v26 offset:2560
    ds_read_b64_tr_b16 v[108:109], v27 offset:2048
    ds_read_b64_tr_b16 v[110:111], v27 offset:2560
    ds_read_b64_tr_b16 v[112:113], v26 offset:4096
    ds_read_b64_tr_b16 v[114:115], v26 offset:4608
    ds_read_b64_tr_b16 v[116:117], v27 offset:4096
    ds_read_b64_tr_b16 v[118:119], v27 offset:4608
    ds_read_b64_tr_b16 v[120:121], v26 offset:6144
    ds_read_b64_tr_b16 v[122:123], v26 offset:6656
    ds_read_b64_tr_b16 v[124:125], v27 offset:6144
    ds_read_b64_tr_b16 v[126:127], v27 offset:6656
    s_add_u32 m0, s39, 49152
    s_add_u32 s40, s37, 1179648
    buffer_load_dwordx4 v10, s[12:15], s40 offen lds
    s_add_u32 m0, s39, 50176
    s_add_u32 s40, s37, 1204224
    buffer_load_dwordx4 v10, s[12:15], s40 offen lds
    s_waitcnt lgkmcnt(15)
    v_dot2_f32_bf16 v44, v64, v56, v44
    v_dot2_f32_bf16 v45, v64, v64, v45
    v_dot2_f32_bf16 v44, v65, v56, v44
    v_dot2_f32_bf16 v45, v65, v65, v45
    v_dot2_f32_bf16 v44, v66, v56, v44
    v_dot2_f32_bf16 v45, v66, v66, v45
    s_add_u32 m0, s39, 57344
    s_add_u32 s40, s37, 1180672
    buffer_load_dwordx4 v10, s[12:15], s40 offen lds
    v_dot2_f32_bf16 v44, v67, v56, v44
    v_dot2_f32_bf16 v45, v67, v67, v45
    v_dot2_f32_bf16 v46, v68, v56, v46
    v_dot2_f32_bf16 v47, v68, v68, v47
    v_dot2_f32_bf16 v46, v69, v56, v46
    v_dot2_f32_bf16 v47, v69, v69, v47
    v_dot2_f32_bf16 v46, v70, v56, v46
    v_dot2_f32_bf16 v47, v70, v70, v47
    s_add_u32 m0, s39, 58368
    s_add_u32 s40, s37, 1205248
    buffer_load_dwordx4 v10, s[12:15], s40 offen lds
    v_dot2_f32_bf16 v46, v71, v56, v46
    v_dot2_f32_bf16 v47, v71, v71, v47
    s_waitcnt lgkmcnt(0)
    v_mfma_f32_16x16x32_bf16 v[36:39], v[32:35], v[96:99], v[36:39]
    v_mfma_f32_16x16x32_bf16 v[40:43], v[32:35], v[100:103], v[40:43]
    v_mfma_f32_16x16x32_bf16 v[36:39], v[32:35], v[104:107], v[36:39]
    v_mfma_f32_16x16x32_bf16 v[40:43], v[32:35], v[108:111], v[40:43]
    s_add_u32 m0, s39, 65536
    s_add_u32 s40, s37, 1181696
    buffer_load_dwordx4 v10, s[12:15], s40 offen lds
    v_mfma_f32_16x16x32_bf16 v[36:39], v[32:35], v[112:115], v[36:39]
    v_mfma_f32_16x16x32_bf16 v[40:43], v[32:35], v[116:119], v[40:43]
    v_mfma_f32_16x16x32_bf16 v[36:39], v[32:35], v[120:123], v[36:39]
    v_mfma_f32_16x16x32_bf16 v[40:43], v[32:35], v[124:127], v[40:43]
    s_add_u32 m0, s39, 66560
    s_add_u32 s40, s37, 1206272
    buffer_load_dwordx4 v10, s[12:15], s40 offen lds
    s_waitcnt vmcnt(14)
    s_barrier
    ds_read_b128 v[64:67], v16 offset:32768
    ds_read_b128 v[68:71], v16 offset:33792
    ds_read_b64_tr_b16 v[96:97], v20 offset:0
    ds_read_b64_tr_b16 v[98:99], v20 offset:512
    ds_read_b64_tr_b16 v[100:101], v21 offset:0
    ds_read_b64_tr_b16 v[102:103], v21 offset:512
    ds_read_b64_tr_b16 v[104:105], v20 offset:2048
    ds_read_b64_tr_b16 v[106:107], v20 offset:2560
    ds_read_b64_tr_b16 v[108:109], v21 offset:2048
    ds_read_b64_tr_b16 v[110:111], v21 offset:2560
    ds_read_b64_tr_b16 v[112:113], v20 offset:4096
    ds_read_b64_tr_b16 v[114:115], v20 offset:4608
    ds_read_b64_tr_b16 v[116:117], v21 offset:4096
    ds_read_b64_tr_b16 v[118:119], v21 offset:4608
    ds_read_b64_tr_b16 v[120:121], v20 offset:6144
    ds_read_b64_tr_b16 v[122:123], v20 offset:6656
    ds_read_b64_tr_b16 v[124:125], v21 offset:6144
    ds_read_b64_tr_b16 v[126:127], v21 offset:6656
    s_add_u32 m0, s39, 73728
    s_add_u32 s40, s37, 1376256
    buffer_load_dwordx4 v10, s[12:15], s40 offen lds
    s_add_u32 m0, s39, 74752
    s_add_u32 s40, s37, 1400832
    buffer_load_dwordx4 v10, s[12:15], s40 offen lds
    s_waitcnt lgkmcnt(15)
    v_dot2_f32_bf16 v44, v64, v56, v44
    v_dot2_f32_bf16 v45, v64, v64, v45
    v_dot2_f32_bf16 v44, v65, v56, v44
    v_dot2_f32_bf16 v45, v65, v65, v45
    v_dot2_f32_bf16 v44, v66, v56, v44
    v_dot2_f32_bf16 v45, v66, v66, v45
    s_add_u32 m0, s39, 81920
    s_add_u32 s40, s37, 1377280
    buffer_load_dwordx4 v10, s[12:15], s40 offen lds
    v_dot2_f32_bf16 v44, v67, v56, v44
    v_dot2_f32_bf16 v45, v67, v67, v45
    v_dot2_f32_bf16 v46, v68, v56, v46
    v_dot2_f32_bf16 v47, v68, v68, v47
    v_dot2_f32_bf16 v46, v69, v56, v46
    v_dot2_f32_bf16 v47, v69, v69, v47
    v_dot2_f32_bf16 v46, v70, v56, v46
    v_dot2_f32_bf16 v47, v70, v70, v47
    s_add_u32 m0, s39, 82944
    s_add_u32 s40, s37, 1401856
    buffer_load_dwordx4 v10, s[12:15], s40 offen lds
    v_dot2_f32_bf16 v46, v71, v56, v46
    v_dot2_f32_bf16 v47, v71, v71, v47
    s_waitcnt lgkmcnt(0)
    v_mfma_f32_16x16x32_bf16 v[36:39], v[32:35], v[96:99], v[36:39]
    v_mfma_f32_16x16x32_bf16 v[40:43], v[32:35], v[100:103], v[40:43]
    v_mfma_f32_16x16x32_bf16 v[36:39], v[32:35], v[104:107], v[36:39]
    v_mfma_f32_16x16x32_bf16 v[40:43], v[32:35], v[108:111], v[40:43]
    s_add_u32 m0, s39, 90112
    s_add_u32 s40, s37, 1378304
    buffer_load_dwordx4 v10, s[12:15], s40 offen lds
    v_mfma_f32_16x16x32_bf16 v[36:39], v[32:35], v[112:115], v[36:39]
    v_mfma_f32_16x16x32_bf16 v[40:43], v[32:35], v[116:119], v[40:43]
    v_mfma_f32_16x16x32_bf16 v[36:39], v[32:35], v[120:123], v[36:39]
    v_mfma_f32_16x16x32_bf16 v[40:43], v[32:35], v[124:127], v[40:43]
    s_add_u32 m0, s39, 91136
    s_add_u32 s40, s37, 1402880
    buffer_load_dwordx4 v10, s[12:15], s40 offen lds
    s_waitcnt vmcnt(12)
    s_barrier
    ds_read_b128 v[64:67], v16 offset:40960
    ds_read_b128 v[68:71], v16 offset:41984
    ds_read_b64_tr_b16 v[96:97], v22 offset:0
    ds_read_b64_tr_b16 v[98:99], v22 offset:512
    ds_read_b64_tr_b16 v[100:101], v23 offset:0
    ds_read_b64_tr_b16 v[102:103], v23 offset:512
    ds_read_b64_tr_b16 v[104:105], v22 offset:2048
    ds_read_b64_tr_b16 v[106:107], v22 offset:2560
    ds_read_b64_tr_b16 v[108:109], v23 offset:2048
    ds_read_b64_tr_b16 v[110:111], v23 offset:2560
    ds_read_b64_tr_b16 v[112:113], v22 offset:4096
    ds_read_b64_tr_b16 v[114:115], v22 offset:4608
    ds_read_b64_tr_b16 v[116:117], v23 offset:4096
    ds_read_b64_tr_b16 v[118:119], v23 offset:4608
    ds_read_b64_tr_b16 v[120:121], v22 offset:6144
    ds_read_b64_tr_b16 v[122:123], v22 offset:6656
    ds_read_b64_tr_b16 v[124:125], v23 offset:6144
    ds_read_b64_tr_b16 v[126:127], v23 offset:6656
    s_waitcnt lgkmcnt(15)
    v_dot2_f32_bf16 v44, v64, v56, v44
    v_dot2_f32_bf16 v45, v64, v64, v45
    v_dot2_f32_bf16 v44, v65, v56, v44
    v_dot2_f32_bf16 v45, v65, v65, v45
    v_dot2_f32_bf16 v44, v66, v56, v44
    v_dot2_f32_bf16 v45, v66, v66, v45
    v_dot2_f32_bf16 v44, v67, v56, v44
    v_dot2_f32_bf16 v45, v67, v67, v45
    v_dot2_f32_bf16 v46, v68, v56, v46
    v_dot2_f32_bf16 v47, v68, v68, v47
    v_dot2_f32_bf16 v46, v69, v56, v46
    v_dot2_f32_bf16 v47, v69, v69, v47
    v_dot2_f32_bf16 v46, v70, v56, v46
    v_dot2_f32_bf16 v47, v70, v70, v47
    v_dot2_f32_bf16 v46, v71, v56, v46
    v_dot2_f32_bf16 v47, v71, v71, v47
    s_waitcnt lgkmcnt(0)
    v_mfma_f32_16x16x32_bf16 v[36:39], v[32:35], v[96:99], v[36:39]
    v_mfma_f32_16x16x32_bf16 v[40:43], v[32:35], v[100:103], v[40:43]
    v_mfma_f32_16x16x32_bf16 v[36:39], v[32:35], v[104:107], v[36:39]
    v_mfma_f32_16x16x32_bf16 v[40:43], v[32:35], v[108:111], v[40:43]
    v_mfma_f32_16x16x32_bf16 v[36:39], v[32:35], v[112:115], v[36:39]
    v_mfma_f32_16x16x32_bf16 v[40:43], v[32:35], v[116:119], v[40:43]
    v_mfma_f32_16x16x32_bf16 v[36:39], v[32:35], v[120:123], v[36:39]
    v_mfma_f32_16x16x32_bf16 v[40:43], v[32:35], v[124:127], v[40:43]
    s_waitcnt vmcnt(6)
    s_barrier
    ds_read_b128 v[64:67], v16 offset:0
    ds_read_b128 v[68:71], v16 offset:1024
    ds_read_b64_tr_b16 v[96:97], v24 offset:0
    ds_read_b64_tr_b16 v[98:99], v24 offset:512
    ds_read_b64_tr_b16 v[100:101], v25 offset:0
    ds_read_b64_tr_b16 v[102:103], v25 offset:512
    ds_read_b64_tr_b16 v[104:105], v24 offset:2048
    ds_read_b64_tr_b16 v[106:107], v24 offset:2560
    ds_read_b64_tr_b16 v[108:109], v25 offset:2048
    ds_read_b64_tr_b16 v[110:111], v25 offset:2560
    ds_read_b64_tr_b16 v[112:113], v24 offset:4096
    ds_read_b64_tr_b16 v[114:115], v24 offset:4608
    ds_read_b64_tr_b16 v[116:117], v25 offset:4096
    ds_read_b64_tr_b16 v[118:119], v25 offset:4608
    ds_read_b64_tr_b16 v[120:121], v24 offset:6144
    ds_read_b64_tr_b16 v[122:123], v24 offset:6656
    ds_read_b64_tr_b16 v[124:125], v25 offset:6144
    ds_read_b64_tr_b16 v[126:127], v25 offset:6656
    s_waitcnt lgkmcnt(15)
    v_dot2_f32_bf16 v44, v64, v56, v44
    v_dot2_f32_bf16 v45, v64, v64, v45
    v_dot2_f32_bf16 v44, v65, v56, v44
    v_dot2_f32_bf16 v45, v65, v65, v45
    v_dot2_f32_bf16 v44, v66, v56, v44
    v_dot2_f32_bf16 v45, v66, v66, v45
    v_dot2_f32_bf16 v44, v67, v56, v44
    v_dot2_f32_bf16 v45, v67, v67, v45
    v_dot2_f32_bf16 v46, v68, v56, v46
    v_dot2_f32_bf16 v47, v68, v68, v47
    v_dot2_f32_bf16 v46, v69, v56, v46
    v_dot2_f32_bf16 v47, v69, v69, v47
    v_dot2_f32_bf16 v46, v70, v56, v46
    v_dot2_f32_bf16 v47, v70, v70, v47
    v_dot2_f32_bf16 v46, v71, v56, v46
    v_dot2_f32_bf16 v47, v71, v71, v47
    s_waitcnt lgkmcnt(0)
    v_mfma_f32_16x16x32_bf16 v[36:39], v[32:35], v[96:99], v[36:39]
    v_mfma_f32_16x16x32_bf16 v[40:43], v[32:35], v[100:103], v[40:43]
    v_mfma_f32_16x16x32_bf16 v[36:39], v[32:35], v[104:107], v[36:39]
    v_mfma_f32_16x16x32_bf16 v[40:43], v[32:35], v[108:111], v[40:43]
    v_mfma_f32_16x16x32_bf16 v[36:39], v[32:35], v[112:115], v[36:39]
    v_mfma_f32_16x16x32_bf16 v[40:43], v[32:35], v[116:119], v[40:43]
    v_mfma_f32_16x16x32_bf16 v[36:39], v[32:35], v[120:123], v[36:39]
    v_mfma_f32_16x16x32_bf16 v[40:43], v[32:35], v[124:127], v[40:43]
    s_waitcnt vmcnt(0)
    s_barrier
    ds_read_b128 v[64:67], v16 offset:8192
    ds_read_b128 v[68:71], v16 offset:9216
    ds_read_b64_tr_b16 v[96:97], v26 offset:0
    ds_read_b64_tr_b16 v[98:99], v26 offset:512
    ds_read_b64_tr_b16 v[100:101], v27 offset:0
    ds_read_b64_tr_b16 v[102:103], v27 offset:512
    ds_read_b64_tr_b16 v[104:105], v26 offset:2048
    ds_read_b64_tr_b16 v[106:107], v26 offset:2560
    ds_read_b64_tr_b16 v[108:109], v27 offset:2048
    ds_read_b64_tr_b16 v[110:111], v27 offset:2560
    ds_read_b64_tr_b16 v[112:113], v26 offset:4096
    ds_read_b64_tr_b16 v[114:115], v26 offset:4608
    ds_read_b64_tr_b16 v[116:117], v27 offset:4096
    ds_read_b64_tr_b16 v[118:119], v27 offset:4608
    ds_read_b64_tr_b16 v[120:121], v26 offset:6144
    ds_read_b64_tr_b16 v[122:123], v26 offset:6656
    ds_read_b64_tr_b16 v[124:125], v27 offset:6144
    ds_read_b64_tr_b16 v[126:127], v27 offset:6656
    s_waitcnt lgkmcnt(15)
    v_dot2_f32_bf16 v44, v64, v56, v44
    v_dot2_f32_bf16 v45, v64, v64, v45
    v_dot2_f32_bf16 v44, v65, v56, v44
    v_dot2_f32_bf16 v45, v65, v65, v45
    v_dot2_f32_bf16 v44, v66, v56, v44
    v_dot2_f32_bf16 v45, v66, v66, v45
    v_dot2_f32_bf16 v44, v67, v56, v44
    v_dot2_f32_bf16 v45, v67, v67, v45
    v_dot2_f32_bf16 v46, v68, v56, v46
    v_dot2_f32_bf16 v47, v68, v68, v47
    v_dot2_f32_bf16 v46, v69, v56, v46
    v_dot2_f32_bf16 v47, v69, v69, v47
    v_dot2_f32_bf16 v46, v70, v56, v46
    v_dot2_f32_bf16 v47, v70, v70, v47
    v_dot2_f32_bf16 v46, v71, v56, v46
    v_dot2_f32_bf16 v47, v71, v71, v47
    s_waitcnt lgkmcnt(0)
    v_mfma_f32_16x16x32_bf16 v[36:39], v[32:35], v[96:99], v[36:39]
    v_mfma_f32_16x16x32_bf16 v[40:43], v[32:35], v[100:103], v[40:43]
    v_mfma_f32_16x16x32_bf16 v[36:39], v[32:35], v[104:107], v[36:39]
    v_mfma_f32_16x16x32_bf16 v[40:43], v[32:35], v[108:111], v[40:43]
    v_mfma_f32_16x16x32_bf16 v[36:39], v[32:35], v[112:115], v[36:39]
    v_mfma_f32_16x16x32_bf16 v[40:43], v[32:35], v[116:119], v[40:43]
    v_mfma_f32_16x16x32_bf16 v[36:39], v[32:35], v[120:123], v[36:39]
    v_mfma_f32_16x16x32_bf16 v[40:43], v[32:35], v[124:127], v[40:43]
    v_add_f32_dpp v44, v44, v44 quad_perm:[1,0,3,2] row_mask:0xf bank_mask:0xf
    v_add_f32_dpp v45, v45, v45 quad_perm:[1,0,3,2] row_mask:0xf bank_mask:0xf
    v_add_f32_dpp v46, v46, v46 quad_perm:[1,0,3,2] row_mask:0xf bank_mask:0xf
    v_add_f32_dpp v47, v47, v47 quad_perm:[1,0,3,2] row_mask:0xf bank_mask:0xf
    v_add_f32_dpp v44, v44, v44 quad_perm:[2,3,0,1] row_mask:0xf bank_mask:0xf
    v_add_f32_dpp v45, v45, v45 quad_perm:[2,3,0,1] row_mask:0xf bank_mask:0xf
    v_add_f32_dpp v46, v46, v46 quad_perm:[2,3,0,1] row_mask:0xf bank_mask:0xf
    v_add_f32_dpp v47, v47, v47 quad_perm:[2,3,0,1] row_mask:0xf bank_mask:0xf
    v_add_f32_dpp v44, v44, v44 row_half_mirror row_mask:0xf bank_mask:0xf
    v_add_f32_dpp v45, v45, v45 row_half_mirror row_mask:0xf bank_mask:0xf
    v_add_f32_dpp v46, v46, v46 row_half_mirror row_mask:0xf bank_mask:0xf
    v_add_f32_dpp v47, v47, v47 row_half_mirror row_mask:0xf bank_mask:0xf
    v_lshrrev_b32 v6, 3, v1
    v_lshlrev_b32 v6, 2, v6
    s_mul_i32 s41, s33, 64
    s_add_u32 s41, s41, 147456
    v_add_u32 v6, s41, v6
    v_mul_f32 v44, 0x3b000000, v44
    v_mul_f32 v45, 0x3b000000, v45
    v_fma_f32 v45, -v44, v44, v45
    v_max_f32 v45, 0, v45
    v_add_f32 v45, 0x3727c5ac, v45
    v_rsq_f32 v45, v45
    ds_write_b32 v6, v44 offset:0
    ds_write_b32 v6, v45 offset:512
    v_mul_f32 v46, 0x3b000000, v46
    v_mul_f32 v47, 0x3b000000, v47
    v_fma_f32 v47, -v46, v46, v47
    v_max_f32 v47, 0, v47
    v_add_f32 v47, 0x3727c5ac, v47
    v_rsq_f32 v47, v47
    ds_write_b32 v6, v46 offset:32
    ds_write_b32 v6, v47 offset:544
    v_lshlrev_b32 v6, 4, v4
    v_and_b32 v7, 15, v1
    v_add_u32 v6, v6, v7
    v_lshlrev_b32 v6, 2, v6
    v_add_u32 v6, 148480, v6
    v_add_u32 v7, s43, v6
    v_add_u32 v6, s44, v6
    ds_write_b32 v7, v36
    ds_write_b32 v6, v40
    s_waitcnt lgkmcnt(0)
    s_setprio 0
    s_barrier
    s_branch H_P1_END
C_START:
    s_mov_b32 s56, s66
    s_mov_b32 s57, s67
    s_mov_b32 s58, 1572864
    s_mov_b32 s59, 0x20000
    s_lshr_b32 s46, s2, 3
    s_lshl_b32 s46, s46, 2
    s_add_u32 s46, s46, s3
    s_lshl_b32 s46, s46, 1
    s_add_u32 s46, s46, 256
    s_mul_i32 s46, s46, 3072
    s_and_b32 s47, s2, 1
    s_lshl_b32 s47, s47, 9
    s_add_u32 s46, s46, s47
    v_lshrrev_b32 v244, 3, v1
    v_lshlrev_b32 v244, 10, v244
    v_lshrrev_b32 v245, 2, v1
    v_and_b32 v245, 1, v245
    v_mul_u32_u24 v245, 3072, v245
    v_add_u32 v244, v244, v245
    v_and_b32 v245, 3, v1
    v_lshlrev_b32 v245, 7, v245
    v_add_u32 v244, v244, v245
    s_mov_b64 exec, 0xffffff
    buffer_load_dword v246, v244, s[56:59], s46 offen
    s_mov_b64 exec, -1
    s_or_b32 s28, s2, s3
    s_cmp_lg_u32 s28, 0
    s_cbranch_scc1 C_P1
    s_memrealtime s[28:29]
    s_waitcnt lgkmcnt(0)
    s_or_b32 s28, s28, 1
    v_mov_b32 v6, 0
    v_mov_b32 v7, s28
    s_mov_b64 exec, 1
    global_store_dword v6, v7, s[80:81] sc1
    s_mov_b64 exec, -1
C_P1:
    v_lshrrev_b32 v2, 4, v1
    v_and_b32 v3, 15, v1
    v_lshrrev_b32 v3, 2, v3
    v_lshrrev_b32 v4, 5, v1
    v_and_b32 v5, 31, v1
    s_and_b32 s33, s3, 1
    s_lshr_b32 s34, s3, 1
    s_cmp_eq_u32 s5, 0
    s_cbranch_scc1 P1X_RM
    v_lshlrev_b32 v6, 4, v1
    s_lshl_b32 s35, s33, 10
    v_add_u32 v6, s35, v6
    v_add_u32 v8, 0, v6
    v_add_u32 v9, 2048, v6
    v_add_u32 v10, 4096, v6
    v_add_u32 v11, 6144, v6
    s_branch P1X_D
P1X_RM:
    v_lshrrev_b32 v6, 1, v5
    v_and_b32 v6, 7, v6
    v_xor_b32 v6, v6, v4
    v_lshlrev_b32 v6, 4, v6
    v_lshlrev_b32 v7, 7, v5
    v_add_u32 v6, v6, v7
    s_mul_i32 s35, s33, 4096
    v_add_u32 v6, s35, v6
    v_xor_b32 v8, 0, v6
    v_xor_b32 v9, 32, v6
    v_xor_b32 v10, 64, v6
    v_xor_b32 v11, 96, v6
P1X_D:
    v_lshlrev_b32 v6, 3, v4
    v_add_u32 v6, v6, v3
    v_lshlrev_b32 v6, 7, v6
    v_and_b32 v7, 3, v1
    v_lshlrev_b32 v7, 3, v7
    v_add_u32 v6, v6, v7
    v_lshrrev_b32 v7, 1, v3
    v_lshlrev_b32 v7, 6, v7
    v_and_b32 v48, 1, v2
    s_lshl_b32 s35, s34, 6
    v_xor_b32 v7, s35, v7
    v_add_u32 v6, v6, v7
    v_lshlrev_b32 v7, 5, v48
    v_add_u32 v6, v6, v7
    v_add_u32 v6, 49152, v6
    v_add_u32 v12, 0, v6
    v_add_u32 v13, 24576, v6
    v_add_u32 v14, 49152, v6
    v_add_u32 v15, 73728, v6
    v_mov_b32 v64, 0
    v_mov_b32 v65, 0
    v_mov_b32 v66, 0
    v_mov_b32 v67, 0
    v_mov_b32 v68, 0
    v_mov_b32 v69, 0
    v_mov_b32 v70, 0
    v_mov_b32 v71, 0
    v_mov_b32 v72, 0
    v_mov_b32 v73, 0
    v_mov_b32 v74, 0
    v_mov_b32 v75, 0
    v_mov_b32 v76, 0
    v_mov_b32 v77, 0
    v_mov_b32 v78, 0
    v_mov_b32 v79, 0
    v_mov_b32 v80, 0
    v_mov_b32 v81, 0
    v_mov_b32 v82, 0
    v_mov_b32 v83, 0
    v_mov_b32 v84, 0
    v_mov_b32 v85, 0
    v_mov_b32 v86, 0
    v_mov_b32 v87, 0
    v_mov_b32 v88, 0
    v_mov_b32 v89, 0
    v_mov_b32 v90, 0
    v_mov_b32 v91, 0
    v_mov_b32 v92, 0
    v_mov_b32 v93, 0
    v_mov_b32 v94, 0
    v_mov_b32 v95, 0
    v_mov_b32 v96, 0
    v_mov_b32 v97, 0
    v_mov_b32 v98, 0
    v_mov_b32 v99, 0
    v_mov_b32 v100, 0
    v_mov_b32 v101, 0
    v_mov_b32 v102, 0
    v_mov_b32 v103, 0
    v_mov_b32 v104, 0
    v_mov_b32 v105, 0
    v_mov_b32 v106, 0
    v_mov_b32 v107, 0
    v_mov_b32 v108, 0
    v_mov_b32 v109, 0
    v_mov_b32 v110, 0
    v_mov_b32 v111, 0
    s_cmp_eq_u32 s5, 0
    s_cbranch_scc1 C_P1_GO
    s_cmp_lg_u32 s3, 0
    s_cbranch_scc1 W0S2
    s_lshl_b32 s31, s85, 3
    s_sub_u32 s29, s5, 1
    s_mul_i32 s29, s29, 163840
    s_add_u32 s29, s29, 67239936
    s_lshl_b32 s28, s31, 7
    s_add_u32 s29, s29, s28
    v_min_u32 v6, 7, v1
    v_lshlrev_b32 v6, 7, v6
    v_add_u32 v6, s29, v6
    s_mov_b32 s30, 20000
POLL3:
    global_load_dword v7, v6, s[82:83] sc1
    s_waitcnt vmcnt(0)
    v_cmp_ne_u32 vcc, s4, v7
    s_nop 4
    s_cbranch_vccz POLL3D
    s_sub_u32 s30, s30, 1
    s_cmp_lg_u32 s30, 0
    s_cbranch_scc1 POLL3
POLL3D:
W0S2:
    s_barrier
C_P1_GO:
    s_barrier
    ds_read_b128 v[112:115], v8 offset:0
    ds_read_b64_tr_b16 v[116:117], v12 offset:0
    ds_read_b64_tr_b16 v[118:119], v12 offset:512
    ds_read_b64_tr_b16 v[120:121], v12 offset:8192
    ds_read_b64_tr_b16 v[122:123], v12 offset:8704
    ds_read_b64_tr_b16 v[124:125], v12 offset:16384
    ds_read_b64_tr_b16 v[126:127], v12 offset:16896
    ds_read_b128 v[128:131], v9 offset:0
    ds_read_b64_tr_b16 v[132:133], v12 offset:2048
    ds_read_b64_tr_b16 v[134:135], v12 offset:2560
    ds_read_b64_tr_b16 v[136:137], v12 offset:10240
    ds_read_b64_tr_b16 v[138:139], v12 offset:10752
    ds_read_b64_tr_b16 v[140:141], v12 offset:18432
    ds_read_b64_tr_b16 v[142:143], v12 offset:18944
    s_waitcnt lgkmcnt(7)
    v_mfma_f32_32x32x16_bf16 v[64:79], v[116:119], v[112:115], v[64:79]
    ds_read_b128 v[144:147], v10 offset:0
    ds_read_b64_tr_b16 v[148:149], v12 offset:4096
    ds_read_b64_tr_b16 v[150:151], v12 offset:4608
    v_mfma_f32_32x32x16_bf16 v[80:95], v[120:123], v[112:115], v[80:95]
    ds_read_b64_tr_b16 v[152:153], v12 offset:12288
    ds_read_b64_tr_b16 v[154:155], v12 offset:12800
    ds_read_b64_tr_b16 v[156:157], v12 offset:20480
    v_mfma_f32_32x32x16_bf16 v[96:111], v[112:115], v[124:127], v[96:111]
    ds_read_b64_tr_b16 v[158:159], v12 offset:20992
    s_waitcnt lgkmcnt(7)
    v_mfma_f32_32x32x16_bf16 v[64:79], v[132:135], v[128:131], v[64:79]
    ds_read_b128 v[112:115], v11 offset:0
    ds_read_b64_tr_b16 v[116:117], v12 offset:6144
    ds_read_b64_tr_b16 v[118:119], v12 offset:6656
    v_mfma_f32_32x32x16_bf16 v[80:95], v[136:139], v[128:131], v[80:95]
    ds_read_b64_tr_b16 v[120:121], v12 offset:14336
    ds_read_b64_tr_b16 v[122:123], v12 offset:14848
    ds_read_b64_tr_b16 v[124:125], v12 offset:22528
    v_mfma_f32_32x32x16_bf16 v[96:111], v[128:131], v[140:143], v[96:111]
    ds_read_b64_tr_b16 v[126:127], v12 offset:23040
    s_waitcnt lgkmcnt(0)
    s_barrier
    v_mfma_f32_32x32x16_bf16 v[64:79], v[148:151], v[144:147], v[64:79]
    ds_read_b128 v[128:131], v8 offset:8192
    ds_read_b64_tr_b16 v[132:133], v13 offset:0
    ds_read_b64_tr_b16 v[134:135], v13 offset:512
    v_mfma_f32_32x32x16_bf16 v[80:95], v[152:155], v[144:147], v[80:95]
    ds_read_b64_tr_b16 v[136:137], v13 offset:8192
    ds_read_b64_tr_b16 v[138:139], v13 offset:8704
    ds_read_b64_tr_b16 v[140:141], v13 offset:16384
    v_mfma_f32_32x32x16_bf16 v[96:111], v[144:147], v[156:159], v[96:111]
    ds_read_b64_tr_b16 v[142:143], v13 offset:16896
    s_waitcnt lgkmcnt(7)
    v_mfma_f32_32x32x16_bf16 v[64:79], v[116:119], v[112:115], v[64:79]
    ds_read_b128 v[144:147], v9 offset:8192
    ds_read_b64_tr_b16 v[148:149], v13 offset:2048
    ds_read_b64_tr_b16 v[150:151], v13 offset:2560
    v_mfma_f32_32x32x16_bf16 v[80:95], v[120:123], v[112:115], v[80:95]
    ds_read_b64_tr_b16 v[152:153], v13 offset:10240
    ds_read_b64_tr_b16 v[154:155], v13 offset:10752
    ds_read_b64_tr_b16 v[156:157], v13 offset:18432
    v_mfma_f32_32x32x16_bf16 v[96:111], v[112:115], v[124:127], v[96:111]
    ds_read_b64_tr_b16 v[158:159], v13 offset:18944
    s_waitcnt lgkmcnt(7)
    v_mfma_f32_32x32x16_bf16 v[64:79], v[132:135], v[128:131], v[64:79]
    ds_read_b128 v[112:115], v10 offset:8192
    ds_read_b64_tr_b16 v[116:117], v13 offset:4096
    ds_read_b64_tr_b16 v[118:119], v13 offset:4608
    v_mfma_f32_32x32x16_bf16 v[80:95], v[136:139], v[128:131], v[80:95]
    ds_read_b64_tr_b16 v[120:121], v13 offset:12288
    ds_read_b64_tr_b16 v[122:123], v13 offset:12800
    ds_read_b64_tr_b16 v[124:125], v13 offset:20480
    v_mfma_f32_32x32x16_bf16 v[96:111], v[128:131], v[140:143], v[96:111]
    ds_read_b64_tr_b16 v[126:127], v13 offset:20992
    s_waitcnt lgkmcnt(7)
    v_mfma_f32_32x32x16_bf16 v[64:79], v[148:151], v[144:147], v[64:79]
    ds_read_b128 v[128:131], v11 offset:8192
    ds_read_b64_tr_b16 v[132:133], v13 offset:6144
    ds_read_b64_tr_b16 v[134:135], v13 offset:6656
    v_mfma_f32_32x32x16_bf16 v[80:95], v[152:155], v[144:147], v[80:95]
    ds_read_b64_tr_b16 v[136:137], v13 offset:14336
    ds_read_b64_tr_b16 v[138:139], v13 offset:14848
    ds_read_b64_tr_b16 v[140:141], v13 offset:22528
    v_mfma_f32_32x32x16_bf16 v[96:111], v[144:147], v[156:159], v[96:111]
    ds_read_b64_tr_b16 v[142:143], v13 offset:23040
    s_waitcnt lgkmcnt(0)
    s_barrier
    v_mfma_f32_32x32x16_bf16 v[64:79], v[116:119], v[112:115], v[64:79]
    ds_read_b128 v[144:147], v8 offset:16384
    ds_read_b64_tr_b16 v[148:149], v14 offset:0
    ds_read_b64_tr_b16 v[150:151], v14 offset:512
    v_mfma_f32_32x32x16_bf16 v[80:95], v[120:123], v[112:115], v[80:95]
    ds_read_b64_tr_b16 v[152:153], v14 offset:8192
    ds_read_b64_tr_b16 v[154:155], v14 offset:8704
    ds_read_b64_tr_b16 v[156:157], v14 offset:16384
    v_mfma_f32_32x32x16_bf16 v[96:111], v[112:115], v[124:127], v[96:111]
    ds_read_b64_tr_b16 v[158:159], v14 offset:16896
    s_waitcnt lgkmcnt(7)
    v_mfma_f32_32x32x16_bf16 v[64:79], v[132:135], v[128:131], v[64:79]
    ds_read_b128 v[112:115], v9 offset:16384
    ds_read_b64_tr_b16 v[116:117], v14 offset:2048
    ds_read_b64_tr_b16 v[118:119], v14 offset:2560
    v_mfma_f32_32x32x16_bf16 v[80:95], v[136:139], v[128:131], v[80:95]
    ds_read_b64_tr_b16 v[120:121], v14 offset:10240
    ds_read_b64_tr_b16 v[122:123], v14 offset:10752
    ds_read_b64_tr_b16 v[124:125], v14 offset:18432
    v_mfma_f32_32x32x16_bf16 v[96:111], v[128:131], v[140:143], v[96:111]
    ds_read_b64_tr_b16 v[126:127], v14 offset:18944
    s_waitcnt lgkmcnt(7)
    v_mfma_f32_32x32x16_bf16 v[64:79], v[148:151], v[144:147], v[64:79]
    ds_read_b128 v[128:131], v10 offset:16384
    ds_read_b64_tr_b16 v[132:133], v14 offset:4096
    ds_read_b64_tr_b16 v[134:135], v14 offset:4608
    v_mfma_f32_32x32x16_bf16 v[80:95], v[152:155], v[144:147], v[80:95]
    ds_read_b64_tr_b16 v[136:137], v14 offset:12288
    ds_read_b64_tr_b16 v[138:139], v14 offset:12800
    ds_read_b64_tr_b16 v[140:141], v14 offset:20480
    v_mfma_f32_32x32x16_bf16 v[96:111], v[144:147], v[156:159], v[96:111]
    ds_read_b64_tr_b16 v[142:143], v14 offset:20992
    s_waitcnt lgkmcnt(7)
    v_mfma_f32_32x32x16_bf16 v[64:79], v[116:119], v[112:115], v[64:79]
    ds_read_b128 v[144:147], v11 offset:16384
    ds_read_b64_tr_b16 v[148:149], v14 offset:6144
    ds_read_b64_tr_b16 v[150:151], v14 offset:6656
    v_mfma_f32_32x32x16_bf16 v[80:95], v[120:123], v[112:115], v[80:95]
    ds_read_b64_tr_b16 v[152:153], v14 offset:14336
    ds_read_b64_tr_b16 v[154:155], v14 offset:14848
    ds_read_b64_tr_b16 v[156:157], v14 offset:22528
    v_mfma_f32_32x32x16_bf16 v[96:111], v[112:115], v[124:127], v[96:111]
    ds_read_b64_tr_b16 v[158:159], v14 offset:23040
    s_waitcnt lgkmcnt(0)
    s_barrier
    v_mfma_f32_32x32x16_bf16 v[64:79], v[132:135], v[128:131], v[64:79]
    ds_read_b128 v[112:115], v8 offset:24576
    ds_read_b64_tr_b16 v[116:117], v15 offset:0
    ds_read_b64_tr_b16 v[118:119], v15 offset:512
    v_mfma_f32_32x32x16_bf16 v[80:95], v[136:139], v[128:131], v[80:95]
    ds_read_b64_tr_b16 v[120:121], v15 offset:8192
    ds_read_b64_tr_b16 v[122:123], v15 offset:8704
    ds_read_b64_tr_b16 v[124:125], v15 offset:16384
    v_mfma_f32_32x32x16_bf16 v[96:111], v[128:131], v[140:143], v[96:111]
    ds_read_b64_tr_b16 v[126:127], v15 offset:16896
    s_waitcnt lgkmcnt(7)
    v_mfma_f32_32x32x16_bf16 v[64:79], v[148:151], v[144:147], v[64:79]
    ds_read_b128 v[128:131], v9 offset:24576
    ds_read_b64_tr_b16 v[132:133], v15 offset:2048
    ds_read_b64_tr_b16 v[134:135], v15 offset:2560
    v_mfma_f32_32x32x16_bf16 v[80:95], v[152:155], v[144:147], v[80:95]
    ds_read_b64_tr_b16 v[136:137], v15 offset:10240
    ds_read_b64_tr_b16 v[138:139], v15 offset:10752
    ds_read_b64_tr_b16 v[140:141], v15 offset:18432
    v_mfma_f32_32x32x16_bf16 v[96:111], v[144:147], v[156:159], v[96:111]
    ds_read_b64_tr_b16 v[142:143], v15 offset:18944
    s_waitcnt lgkmcnt(7)
    v_mfma_f32_32x32x16_bf16 v[64:79], v[116:119], v[112:115], v[64:79]
    ds_read_b128 v[144:147], v10 offset:24576
    ds_read_b64_tr_b16 v[148:149], v15 offset:4096
    ds_read_b64_tr_b16 v[150:151], v15 offset:4608
    v_mfma_f32_32x32x16_bf16 v[80:95], v[120:123], v[112:115], v[80:95]
    ds_read_b64_tr_b16 v[152:153], v15 offset:12288
    ds_read_b64_tr_b16 v[154:155], v15 offset:12800
    ds_read_b64_tr_b16 v[156:157], v15 offset:20480
    v_mfma_f32_32x32x16_bf16 v[96:111], v[112:115], v[124:127], v[96:111]
    ds_read_b64_tr_b16 v[158:159], v15 offset:20992
    s_waitcnt lgkmcnt(7)
    v_mfma_f32_32x32x16_bf16 v[64:79], v[132:135], v[128:131], v[64:79]
    ds_read_b128 v[112:115], v11 offset:24576
    ds_read_b64_tr_b16 v[116:117], v15 offset:6144
    ds_read_b64_tr_b16 v[118:119], v15 offset:6656
    v_mfma_f32_32x32x16_bf16 v[80:95], v[136:139], v[128:131], v[80:95]
    ds_read_b64_tr_b16 v[120:121], v15 offset:14336
    ds_read_b64_tr_b16 v[122:123], v15 offset:14848
    ds_read_b64_tr_b16 v[124:125], v15 offset:22528
    v_mfma_f32_32x32x16_bf16 v[96:111], v[128:131], v[140:143], v[96:111]
    ds_read_b64_tr_b16 v[126:127], v15 offset:23040
    s_waitcnt lgkmcnt(0)
    s_barrier
    v_mfma_f32_32x32x16_bf16 v[64:79], v[148:151], v[144:147], v[64:79]
    ds_read_b128 v[128:131], v8 offset:32768
    ds_read_b64_tr_b16 v[132:133], v12 offset:0
    ds_read_b64_tr_b16 v[134:135], v12 offset:512
    v_mfma_f32_32x32x16_bf16 v[80:95], v[152:155], v[144:147], v[80:95]
    ds_read_b64_tr_b16 v[136:137], v12 offset:8192
    ds_read_b64_tr_b16 v[138:139], v12 offset:8704
    ds_read_b64_tr_b16 v[140:141], v12 offset:16384
    v_mfma_f32_32x32x16_bf16 v[96:111], v[144:147], v[156:159], v[96:111]
    ds_read_b64_tr_b16 v[142:143], v12 offset:16896
    s_waitcnt lgkmcnt(7)
    v_mfma_f32_32x32x16_bf16 v[64:79], v[116:119], v[112:115], v[64:79]
    ds_read_b128 v[144:147], v9 offset:32768
    ds_read_b64_tr_b16 v[148:149], v12 offset:2048
    ds_read_b64_tr_b16 v[150:151], v12 offset:2560
    v_mfma_f32_32x32x16_bf16 v[80:95], v[120:123], v[112:115], v[80:95]
    ds_read_b64_tr_b16 v[152:153], v12 offset:10240
    ds_read_b64_tr_b16 v[154:155], v12 offset:10752
    ds_read_b64_tr_b16 v[156:157], v12 offset:18432
    v_mfma_f32_32x32x16_bf16 v[96:111], v[112:115], v[124:127], v[96:111]
    ds_read_b64_tr_b16 v[158:159], v12 offset:18944
    s_waitcnt lgkmcnt(7)
    v_mfma_f32_32x32x16_bf16 v[64:79], v[132:135], v[128:131], v[64:79]
    ds_read_b128 v[112:115], v10 offset:32768
    ds_read_b64_tr_b16 v[116:117], v12 offset:4096
    ds_read_b64_tr_b16 v[118:119], v12 offset:4608
    v_mfma_f32_32x32x16_bf16 v[80:95], v[136:139], v[128:131], v[80:95]
    ds_read_b64_tr_b16 v[120:121], v12 offset:12288
    ds_read_b64_tr_b16 v[122:123], v12 offset:12800
    ds_read_b64_tr_b16 v[124:125], v12 offset:20480
    v_mfma_f32_32x32x16_bf16 v[96:111], v[128:131], v[140:143], v[96:111]
    ds_read_b64_tr_b16 v[126:127], v12 offset:20992
    s_waitcnt lgkmcnt(7)
    v_mfma_f32_32x32x16_bf16 v[64:79], v[148:151], v[144:147], v[64:79]
    ds_read_b128 v[128:131], v11 offset:32768
    ds_read_b64_tr_b16 v[132:133], v12 offset:6144
    ds_read_b64_tr_b16 v[134:135], v12 offset:6656
    v_mfma_f32_32x32x16_bf16 v[80:95], v[152:155], v[144:147], v[80:95]
    ds_read_b64_tr_b16 v[136:137], v12 offset:14336
    ds_read_b64_tr_b16 v[138:139], v12 offset:14848
    ds_read_b64_tr_b16 v[140:141], v12 offset:22528
    v_mfma_f32_32x32x16_bf16 v[96:111], v[144:147], v[156:159], v[96:111]
    ds_read_b64_tr_b16 v[142:143], v12 offset:23040
    s_waitcnt lgkmcnt(0)
    s_barrier
    v_mfma_f32_32x32x16_bf16 v[64:79], v[116:119], v[112:115], v[64:79]
    ds_read_b128 v[144:147], v8 offset:40960
    ds_read_b64_tr_b16 v[148:149], v13 offset:0
    ds_read_b64_tr_b16 v[150:151], v13 offset:512
    v_mfma_f32_32x32x16_bf16 v[80:95], v[120:123], v[112:115], v[80:95]
    ds_read_b64_tr_b16 v[152:153], v13 offset:8192
    ds_read_b64_tr_b16 v[154:155], v13 offset:8704
    ds_read_b64_tr_b16 v[156:157], v13 offset:16384
    v_mfma_f32_32x32x16_bf16 v[96:111], v[112:115], v[124:127], v[96:111]
    ds_read_b64_tr_b16 v[158:159], v13 offset:16896
    s_waitcnt lgkmcnt(7)
    v_mfma_f32_32x32x16_bf16 v[64:79], v[132:135], v[128:131], v[64:79]
    ds_read_b128 v[112:115], v9 offset:40960
    ds_read_b64_tr_b16 v[116:117], v13 offset:2048
    ds_read_b64_tr_b16 v[118:119], v13 offset:2560
    v_mfma_f32_32x32x16_bf16 v[80:95], v[136:139], v[128:131], v[80:95]
    ds_read_b64_tr_b16 v[120:121], v13 offset:10240
    ds_read_b64_tr_b16 v[122:123], v13 offset:10752
    ds_read_b64_tr_b16 v[124:125], v13 offset:18432
    v_mfma_f32_32x32x16_bf16 v[96:111], v[128:131], v[140:143], v[96:111]
    ds_read_b64_tr_b16 v[126:127], v13 offset:18944
    s_waitcnt lgkmcnt(7)
    v_mfma_f32_32x32x16_bf16 v[64:79], v[148:151], v[144:147], v[64:79]
    ds_read_b128 v[128:131], v10 offset:40960
    ds_read_b64_tr_b16 v[132:133], v13 offset:4096
    ds_read_b64_tr_b16 v[134:135], v13 offset:4608
    v_mfma_f32_32x32x16_bf16 v[80:95], v[152:155], v[144:147], v[80:95]
    ds_read_b64_tr_b16 v[136:137], v13 offset:12288
    ds_read_b64_tr_b16 v[138:139], v13 offset:12800
    ds_read_b64_tr_b16 v[140:141], v13 offset:20480
    v_mfma_f32_32x32x16_bf16 v[96:111], v[144:147], v[156:159], v[96:111]
    ds_read_b64_tr_b16 v[142:143], v13 offset:20992
    s_waitcnt lgkmcnt(7)
    v_mfma_f32_32x32x16_bf16 v[64:79], v[116:119], v[112:115], v[64:79]
    ds_read_b128 v[144:147], v11 offset:40960
    ds_read_b64_tr_b16 v[148:149], v13 offset:6144
    ds_read_b64_tr_b16 v[150:151], v13 offset:6656
    v_mfma_f32_32x32x16_bf16 v[80:95], v[120:123], v[112:115], v[80:95]
    ds_read_b64_tr_b16 v[152:153], v13 offset:14336
    ds_read_b64_tr_b16 v[154:155], v13 offset:14848
    ds_read_b64_tr_b16 v[156:157], v13 offset:22528
    v_mfma_f32_32x32x16_bf16 v[96:111], v[112:115], v[124:127], v[96:111]
    ds_read_b64_tr_b16 v[158:159], v13 offset:23040
    s_waitcnt lgkmcnt(0)
    s_barrier
    v_mfma_f32_32x32x16_bf16 v[64:79], v[132:135], v[128:131], v[64:79]
    ds_read_b128 v[112:115], v8 offset:0
    ds_read_b64_tr_b16 v[116:117], v14 offset:0
    ds_read_b64_tr_b16 v[118:119], v14 offset:512
    v_mfma_f32_32x32x16_bf16 v[80:95], v[136:139], v[128:131], v[80:95]
    ds_read_b64_tr_b16 v[120:121], v14 offset:8192
    ds_read_b64_tr_b16 v[122:123], v14 offset:8704
    ds_read_b64_tr_b16 v[124:125], v14 offset:16384
    v_mfma_f32_32x32x16_bf16 v[96:111], v[128:131], v[140:143], v[96:111]
    ds_read_b64_tr_b16 v[126:127], v14 offset:16896
    s_waitcnt lgkmcnt(7)
    v_mfma_f32_32x32x16_bf16 v[64:79], v[148:151], v[144:147], v[64:79]
    ds_read_b128 v[128:131], v9 offset:0
    ds_read_b64_tr_b16 v[132:133], v14 offset:2048
    ds_read_b64_tr_b16 v[134:135], v14 offset:2560
    v_mfma_f32_32x32x16_bf16 v[80:95], v[152:155], v[144:147], v[80:95]
    ds_read_b64_tr_b16 v[136:137], v14 offset:10240
    ds_read_b64_tr_b16 v[138:139], v14 offset:10752
    ds_read_b64_tr_b16 v[140:141], v14 offset:18432
    v_mfma_f32_32x32x16_bf16 v[96:111], v[144:147], v[156:159], v[96:111]
    ds_read_b64_tr_b16 v[142:143], v14 offset:18944
    s_waitcnt lgkmcnt(7)
    v_mfma_f32_32x32x16_bf16 v[64:79], v[116:119], v[112:115], v[64:79]
    ds_read_b128 v[144:147], v10 offset:0
    ds_read_b64_tr_b16 v[148:149], v14 offset:4096
    ds_read_b64_tr_b16 v[150:151], v14 offset:4608
    v_mfma_f32_32x32x16_bf16 v[80:95], v[120:123], v[112:115], v[80:95]
    ds_read_b64_tr_b16 v[152:153], v14 offset:12288
    ds_read_b64_tr_b16 v[154:155], v14 offset:12800
    ds_read_b64_tr_b16 v[156:157], v14 offset:20480
    v_mfma_f32_32x32x16_bf16 v[96:111], v[112:115], v[124:127], v[96:111]
    ds_read_b64_tr_b16 v[158:159], v14 offset:20992
    s_waitcnt lgkmcnt(7)
    v_mfma_f32_32x32x16_bf16 v[64:79], v[132:135], v[128:131], v[64:79]
    ds_read_b128 v[112:115], v11 offset:0
    ds_read_b64_tr_b16 v[116:117], v14 offset:6144
    ds_read_b64_tr_b16 v[118:119], v14 offset:6656
    v_mfma_f32_32x32x16_bf16 v[80:95], v[136:139], v[128:131], v[80:95]
    ds_read_b64_tr_b16 v[120:121], v14 offset:14336
    ds_read_b64_tr_b16 v[122:123], v14 offset:14848
    ds_read_b64_tr_b16 v[124:125], v14 offset:22528
    v_mfma_f32_32x32x16_bf16 v[96:111], v[128:131], v[140:143], v[96:111]
    ds_read_b64_tr_b16 v[126:127], v14 offset:23040
    s_waitcnt lgkmcnt(0)
    s_barrier
    v_mfma_f32_32x32x16_bf16 v[64:79], v[148:151], v[144:147], v[64:79]
    ds_read_b128 v[128:131], v8 offset:8192
    ds_read_b64_tr_b16 v[132:133], v15 offset:0
    ds_read_b64_tr_b16 v[134:135], v15 offset:512
    v_mfma_f32_32x32x16_bf16 v[80:95], v[152:155], v[144:147], v[80:95]
    ds_read_b64_tr_b16 v[136:137], v15 offset:8192
    ds_read_b64_tr_b16 v[138:139], v15 offset:8704
    ds_read_b64_tr_b16 v[140:141], v15 offset:16384
    v_mfma_f32_32x32x16_bf16 v[96:111], v[144:147], v[156:159], v[96:111]
    ds_read_b64_tr_b16 v[142:143], v15 offset:16896
    s_waitcnt lgkmcnt(7)
    v_mfma_f32_32x32x16_bf16 v[64:79], v[116:119], v[112:115], v[64:79]
    ds_read_b128 v[144:147], v9 offset:8192
    ds_read_b64_tr_b16 v[148:149], v15 offset:2048
    ds_read_b64_tr_b16 v[150:151], v15 offset:2560
    v_mfma_f32_32x32x16_bf16 v[80:95], v[120:123], v[112:115], v[80:95]
    ds_read_b64_tr_b16 v[152:153], v15 offset:10240
    ds_read_b64_tr_b16 v[154:155], v15 offset:10752
    ds_read_b64_tr_b16 v[156:157], v15 offset:18432
    v_mfma_f32_32x32x16_bf16 v[96:111], v[112:115], v[124:127], v[96:111]
    ds_read_b64_tr_b16 v[158:159], v15 offset:18944
    s_waitcnt lgkmcnt(7)
    v_mfma_f32_32x32x16_bf16 v[64:79], v[132:135], v[128:131], v[64:79]
    ds_read_b128 v[112:115], v10 offset:8192
    ds_read_b64_tr_b16 v[116:117], v15 offset:4096
    ds_read_b64_tr_b16 v[118:119], v15 offset:4608
    v_mfma_f32_32x32x16_bf16 v[80:95], v[136:139], v[128:131], v[80:95]
    ds_read_b64_tr_b16 v[120:121], v15 offset:12288
    ds_read_b64_tr_b16 v[122:123], v15 offset:12800
    ds_read_b64_tr_b16 v[124:125], v15 offset:20480
    v_mfma_f32_32x32x16_bf16 v[96:111], v[128:131], v[140:143], v[96:111]
    ds_read_b64_tr_b16 v[126:127], v15 offset:20992
    s_waitcnt lgkmcnt(7)
    v_mfma_f32_32x32x16_bf16 v[64:79], v[148:151], v[144:147], v[64:79]
    ds_read_b128 v[128:131], v11 offset:8192
    ds_read_b64_tr_b16 v[132:133], v15 offset:6144
    ds_read_b64_tr_b16 v[134:135], v15 offset:6656
    v_mfma_f32_32x32x16_bf16 v[80:95], v[152:155], v[144:147], v[80:95]
    ds_read_b64_tr_b16 v[136:137], v15 offset:14336
    ds_read_b64_tr_b16 v[138:139], v15 offset:14848
    ds_read_b64_tr_b16 v[140:141], v15 offset:22528
    v_mfma_f32_32x32x16_bf16 v[96:111], v[144:147], v[156:159], v[96:111]
    ds_read_b64_tr_b16 v[142:143], v15 offset:23040
    s_waitcnt lgkmcnt(7)
    v_mfma_f32_32x32x16_bf16 v[64:79], v[116:119], v[112:115], v[64:79]
    v_mfma_f32_32x32x16_bf16 v[80:95], v[120:123], v[112:115], v[80:95]
    v_mfma_f32_32x32x16_bf16 v[96:111], v[112:115], v[124:127], v[96:111]
    s_waitcnt lgkmcnt(0)
    v_mfma_f32_32x32x16_bf16 v[64:79], v[132:135], v[128:131], v[64:79]
    v_mfma_f32_32x32x16_bf16 v[80:95], v[136:139], v[128:131], v[80:95]
    v_mfma_f32_32x32x16_bf16 v[96:111], v[128:131], v[140:143], v[96:111]
    s_barrier
    s_cmp_lg_u32 s3, 0
    s_cbranch_scc1 W0S4
    s_cmp_lg_u32 s5, 0
    s_cbranch_scc1 EPE_D
    v_mov_b32 v243, 0
    global_load_dword v248, v243, s[80:81] sc1
EPE_D:
W0S4:
    s_add_u32 s20, s82, s6
    s_addc_u32 s21, s83, 0
    s_add_u32 s20, s20, 4194304
    s_addc_u32 s21, s21, 0
    s_mov_b32 s22, 6291456
    s_mov_b32 s23, 0x20000
    s_lshl_b32 s35, s33, 7
    v_lshlrev_b32 v6, 2, v5
    v_add_u32 v6, s35, v6
    v_add_u32 v7, 147456, v6
    ds_read_b32 v48, v7 offset:0
    ds_read_b32 v49, v7 offset:512
    s_lshl_b32 s35, s34, 7
    s_add_u32 s35, s35, 148480
    v_lshlrev_b32 v6, 4, v4
    v_add_u32 v6, s35, v6
    ds_read_b128 v[8:11], v6 offset:0
    ds_read_b128 v[12:15], v6 offset:32
    ds_read_b128 v[16:19], v6 offset:64
    ds_read_b128 v[20:23], v6 offset:96
    ds_read_b128 v[24:27], v6 offset:256
    ds_read_b128 v[28:31], v6 offset:288
    ds_read_b128 v[32:35], v6 offset:320
    ds_read_b128 v[36:39], v6 offset:352
    v_lshlrev_b32 v7, 2, v5
    v_add_u32 v7, s35, v7
    ds_read_b32 v50, v7 offset:512
    s_lshl_b32 s36, s33, 7
    s_add_u32 s36, s36, 147456
    v_lshlrev_b32 v7, 4, v4
    v_add_u32 v7, s36, v7
    ds_read_b128 v[112:115], v7 offset:0
    ds_read_b128 v[128:131], v7 offset:512
    ds_read_b128 v[116:119], v7 offset:32
    ds_read_b128 v[132:135], v7 offset:544
    ds_read_b128 v[120:123], v7 offset:64
    ds_read_b128 v[136:139], v7 offset:576
    ds_read_b128 v[124:127], v7 offset:96
    ds_read_b128 v[140:143], v7 offset:608
    s_lshl_b32 s37, s85, 1
    s_add_u32 s37, s37, s33
    s_lshl_b32 s38, s84, 2
    s_lshl_b32 s39, s34, 1
    s_add_u32 s38, s38, s39
    s_lshl_b32 s39, s38, 6
    s_add_u32 s39, s39, s37
    s_lshl_b32 s39, s39, 10
    s_add_u32 s40, s39, 65536
    s_add_u32 s41, s39, 2097152
    s_add_u32 s42, s40, 2097152
    s_lshl_b32 s43, s38, 16
    s_lshl_b32 s44, s37, 10
    s_add_u32 s43, s43, s44
    s_add_u32 s43, s43, 4194304
    s_add_u32 s44, s43, 512
    v_lshlrev_b32 v51, 4, v1
    v_lshrrev_b32 v52, 4, v5
    v_lshlrev_b32 v52, 16, v52
    v_lshlrev_b32 v53, 8, v4
    v_add_u32 v52, v52, v53
    v_and_b32 v53, 15, v5
    v_lshlrev_b32 v53, 4, v53
    v_add_u32 v52, v52, v53
    s_waitcnt lgkmcnt(0)
    v_mul_f32 v53, 0x3eb8aa3b, v49
    v_pk_fma_f32 v[64:65], v[48:49], v[8:9], v[64:65] op_sel:[0,0,0] op_sel_hi:[0,1,1] neg_lo:[1,0,0] neg_hi:[1,0,0]
    v_pk_fma_f32 v[66:67], v[48:49], v[10:11], v[66:67] op_sel:[0,0,0] op_sel_hi:[0,1,1] neg_lo:[1,0,0] neg_hi:[1,0,0]
    v_pk_fma_f32 v[68:69], v[48:49], v[12:13], v[68:69] op_sel:[0,0,0] op_sel_hi:[0,1,1] neg_lo:[1,0,0] neg_hi:[1,0,0]
    v_pk_fma_f32 v[70:71], v[48:49], v[14:15], v[70:71] op_sel:[0,0,0] op_sel_hi:[0,1,1] neg_lo:[1,0,0] neg_hi:[1,0,0]
    v_pk_fma_f32 v[72:73], v[48:49], v[16:17], v[72:73] op_sel:[0,0,0] op_sel_hi:[0,1,1] neg_lo:[1,0,0] neg_hi:[1,0,0]
    v_pk_fma_f32 v[74:75], v[48:49], v[18:19], v[74:75] op_sel:[0,0,0] op_sel_hi:[0,1,1] neg_lo:[1,0,0] neg_hi:[1,0,0]
    v_pk_fma_f32 v[76:77], v[48:49], v[20:21], v[76:77] op_sel:[0,0,0] op_sel_hi:[0,1,1] neg_lo:[1,0,0] neg_hi:[1,0,0]
    v_pk_fma_f32 v[78:79], v[48:49], v[22:23], v[78:79] op_sel:[0,0,0] op_sel_hi:[0,1,1] neg_lo:[1,0,0] neg_hi:[1,0,0]
    v_pk_mul_f32 v[64:65], v[52:53], v[64:65] op_sel:[1,0] op_sel_hi:[1,1]
    v_pk_mul_f32 v[66:67], v[52:53], v[66:67] op_sel:[1,0] op_sel_hi:[1,1]
    v_pk_mul_f32 v[68:69], v[52:53], v[68:69] op_sel:[1,0] op_sel_hi:[1,1]
    v_pk_mul_f32 v[70:71], v[52:53], v[70:71] op_sel:[1,0] op_sel_hi:[1,1]
    v_pk_mul_f32 v[72:73], v[52:53], v[72:73] op_sel:[1,0] op_sel_hi:[1,1]
    v_pk_mul_f32 v[74:75], v[52:53], v[74:75] op_sel:[1,0] op_sel_hi:[1,1]
    v_pk_mul_f32 v[76:77], v[52:53], v[76:77] op_sel:[1,0] op_sel_hi:[1,1]
    v_pk_mul_f32 v[78:79], v[52:53], v[78:79] op_sel:[1,0] op_sel_hi:[1,1]
    v_cvt_pk_bf16_f32 v40, v64, v65
    v_cvt_pk_bf16_f32 v41, v66, v67
    v_cvt_pk_bf16_f32 v42, v68, v69
    v_cvt_pk_bf16_f32 v43, v70, v71
    v_cvt_pk_bf16_f32 v44, v72, v73
    v_cvt_pk_bf16_f32 v45, v74, v75
    v_cvt_pk_bf16_f32 v46, v76, v77
    v_cvt_pk_bf16_f32 v47, v78, v79
    buffer_store_dwordx4 v[40:43], v51, s[20:23], s39 offen sc1
    buffer_store_dwordx4 v[44:47], v51, s[20:23], s40 offen sc1
    v_pk_fma_f32 v[80:81], v[48:49], v[24:25], v[80:81] op_sel:[0,0,0] op_sel_hi:[0,1,1] neg_lo:[1,0,0] neg_hi:[1,0,0]
    v_pk_fma_f32 v[82:83], v[48:49], v[26:27], v[82:83] op_sel:[0,0,0] op_sel_hi:[0,1,1] neg_lo:[1,0,0] neg_hi:[1,0,0]
    v_pk_fma_f32 v[84:85], v[48:49], v[28:29], v[84:85] op_sel:[0,0,0] op_sel_hi:[0,1,1] neg_lo:[1,0,0] neg_hi:[1,0,0]
    v_pk_fma_f32 v[86:87], v[48:49], v[30:31], v[86:87] op_sel:[0,0,0] op_sel_hi:[0,1,1] neg_lo:[1,0,0] neg_hi:[1,0,0]
    v_pk_fma_f32 v[88:89], v[48:49], v[32:33], v[88:89] op_sel:[0,0,0] op_sel_hi:[0,1,1] neg_lo:[1,0,0] neg_hi:[1,0,0]
    v_pk_fma_f32 v[90:91], v[48:49], v[34:35], v[90:91] op_sel:[0,0,0] op_sel_hi:[0,1,1] neg_lo:[1,0,0] neg_hi:[1,0,0]
    v_pk_fma_f32 v[92:93], v[48:49], v[36:37], v[92:93] op_sel:[0,0,0] op_sel_hi:[0,1,1] neg_lo:[1,0,0] neg_hi:[1,0,0]
    v_pk_fma_f32 v[94:95], v[48:49], v[38:39], v[94:95] op_sel:[0,0,0] op_sel_hi:[0,1,1] neg_lo:[1,0,0] neg_hi:[1,0,0]
    v_pk_mul_f32 v[80:81], v[48:49], v[80:81] op_sel:[1,0] op_sel_hi:[1,1]
    v_pk_mul_f32 v[82:83], v[48:49], v[82:83] op_sel:[1,0] op_sel_hi:[1,1]
    v_pk_mul_f32 v[84:85], v[48:49], v[84:85] op_sel:[1,0] op_sel_hi:[1,1]
    v_pk_mul_f32 v[86:87], v[48:49], v[86:87] op_sel:[1,0] op_sel_hi:[1,1]
    v_pk_mul_f32 v[88:89], v[48:49], v[88:89] op_sel:[1,0] op_sel_hi:[1,1]
    v_pk_mul_f32 v[90:91], v[48:49], v[90:91] op_sel:[1,0] op_sel_hi:[1,1]
    v_pk_mul_f32 v[92:93], v[48:49], v[92:93] op_sel:[1,0] op_sel_hi:[1,1]
    v_pk_mul_f32 v[94:95], v[48:49], v[94:95] op_sel:[1,0] op_sel_hi:[1,1]
    v_cvt_pk_bf16_f32 v56, v80, v81
    v_cvt_pk_bf16_f32 v57, v82, v83
    v_cvt_pk_bf16_f32 v58, v84, v85
    v_cvt_pk_bf16_f32 v59, v86, v87
    v_cvt_pk_bf16_f32 v60, v88, v89
    v_cvt_pk_bf16_f32 v61, v90, v91
    v_cvt_pk_bf16_f32 v62, v92, v93
    v_cvt_pk_bf16_f32 v63, v94, v95
    buffer_store_dwordx4 v[56:59], v51, s[20:23], s41 offen sc1
    buffer_store_dwordx4 v[60:63], v51, s[20:23], s42 offen sc1
    v_pk_fma_f32 v[96:97], v[112:113], v[50:51], v[96:97] op_sel:[0,0,0] op_sel_hi:[1,0,1] neg_lo:[1,0,0] neg_hi:[1,0,0]
    v_pk_fma_f32 v[98:99], v[114:115], v[50:51], v[98:99] op_sel:[0,0,0] op_sel_hi:[1,0,1] neg_lo:[1,0,0] neg_hi:[1,0,0]
    v_pk_fma_f32 v[100:101], v[116:117], v[50:51], v[100:101] op_sel:[0,0,0] op_sel_hi:[1,0,1] neg_lo:[1,0,0] neg_hi:[1,0,0]
    v_pk_fma_f32 v[102:103], v[118:119], v[50:51], v[102:103] op_sel:[0,0,0] op_sel_hi:[1,0,1] neg_lo:[1,0,0] neg_hi:[1,0,0]
    v_pk_fma_f32 v[104:105], v[120:121], v[50:51], v[104:105] op_sel:[0,0,0] op_sel_hi:[1,0,1] neg_lo:[1,0,0] neg_hi:[1,0,0]
    v_pk_fma_f32 v[106:107], v[122:123], v[50:51], v[106:107] op_sel:[0,0,0] op_sel_hi:[1,0,1] neg_lo:[1,0,0] neg_hi:[1,0,0]
    v_pk_fma_f32 v[108:109], v[124:125], v[50:51], v[108:109] op_sel:[0,0,0] op_sel_hi:[1,0,1] neg_lo:[1,0,0] neg_hi:[1,0,0]
    v_pk_fma_f32 v[110:111], v[126:127], v[50:51], v[110:111] op_sel:[0,0,0] op_sel_hi:[1,0,1] neg_lo:[1,0,0] neg_hi:[1,0,0]
    v_pk_mul_f32 v[96:97], v[128:129], v[96:97]
    v_pk_mul_f32 v[98:99], v[130:131], v[98:99]
    v_pk_mul_f32 v[100:101], v[132:133], v[100:101]
    v_pk_mul_f32 v[102:103], v[134:135], v[102:103]
    v_pk_mul_f32 v[104:105], v[136:137], v[104:105]
    v_pk_mul_f32 v[106:107], v[138:139], v[106:107]
    v_pk_mul_f32 v[108:109], v[140:141], v[108:109]
    v_pk_mul_f32 v[110:111], v[142:143], v[110:111]
    v_cvt_pk_bf16_f32 v8, v96, v97
    v_cvt_pk_bf16_f32 v9, v98, v99
    v_cvt_pk_bf16_f32 v10, v100, v101
    v_cvt_pk_bf16_f32 v11, v102, v103
    v_cvt_pk_bf16_f32 v12, v104, v105
    v_cvt_pk_bf16_f32 v13, v106, v107
    v_cvt_pk_bf16_f32 v14, v108, v109
    v_cvt_pk_bf16_f32 v15, v110, v111
    buffer_store_dwordx4 v[8:11], v52, s[20:23], s43 offen sc1
    buffer_store_dwordx4 v[12:15], v52, s[20:23], s44 offen sc1
    s_cmp_lg_u32 s3, 0
    s_cbranch_scc1 W0S5
    s_cmp_lg_u32 s4, 0
    s_cbranch_scc1 EPD
    s_waitcnt vmcnt(0)
    v_readfirstlane_b32 s4, v248
    s_nop 1
    s_cmp_lg_u32 s4, 0
    s_cbranch_scc1 EPD
    v_mov_b32 v6, 0
    s_mov_b32 s30, 20000
EPL:
    global_load_dword v7, v6, s[80:81] sc1
    s_waitcnt vmcnt(0)
    v_readfirstlane_b32 s4, v7
    s_nop 1
    s_cmp_lg_u32 s4, 0
    s_cbranch_scc1 EPD
    s_sub_u32 s30, s30, 1
    s_cmp_lg_u32 s30, 0
    s_cbranch_scc1 EPL
EPD:
W0S5:
    s_waitcnt vmcnt(0)
    s_barrier
    s_cmp_lg_u32 s3, 0
    s_cbranch_scc1 W0S6
    s_lshl_b32 s31, s84, 5
    s_add_u32 s31, s31, s85
    s_add_u32 s29, s5, 0
    s_mul_i32 s29, s29, 163840
    s_add_u32 s29, s29, 67108864
    s_lshl_b32 s28, s31, 7
    s_add_u32 s29, s29, s28
    v_mov_b32 v6, s29
    v_mov_b32 v7, s4
    s_mov_b64 exec, 1
    global_store_dword v6, v7, s[82:83] sc1
    s_mov_b64 exec, -1
    s_lshr_b32 s31, s86, 2
    s_lshl_b32 s31, s31, 5
    s_add_u32 s29, s5, 0
    s_mul_i32 s29, s29, 163840
    s_add_u32 s29, s29, 67108864
    s_lshl_b32 s28, s31, 7
    s_add_u32 s29, s29, s28
    v_min_u32 v6, 31, v1
    v_lshlrev_b32 v6, 7, v6
    v_add_u32 v6, s29, v6
    s_mov_b32 s30, 20000
POLL7:
    global_load_dword v7, v6, s[82:83] sc1
    s_waitcnt vmcnt(0)
    v_cmp_ne_u32 vcc, s4, v7
    s_nop 4
    s_cbranch_vccz POLL7D
    s_sub_u32 s30, s30, 1
    s_cmp_lg_u32 s30, 0
    s_cbranch_scc1 POLL7
POLL7D:
W0S6:
    s_barrier
    s_add_u32 s8, s82, s6
    s_addc_u32 s9, s83, 0
    s_add_u32 s8, s8, 4194304
    s_addc_u32 s9, s9, 0
    s_mov_b32 s10, 6291456
    s_mov_b32 s11, 0x20000
    s_lshl_b32 s32, s87, 3
    s_add_u32 s32, s32, s3
    v_lshlrev_b32 v2, 4, v1
    s_lshl_b32 s33, s86, 16
    s_lshl_b32 s34, s32, 10
    s_add_u32 s34, s34, s33
    buffer_load_dwordx4 v[8:11], v2, s[8:11], s34 offen sc1
    s_lshl_b32 s35, s3, 10
    s_add_u32 s36, s33, s35
    s_add_u32 s37, s36, 2097152
    s_add_u32 s38, s36, 4194304
    v_mov_b32 v6, v2
    s_add_u32 m0, s35, 0
    s_add_u32 s40, s37, 0
    buffer_load_dwordx4 v6, s[8:11], s40 offen sc1 lds
    s_add_u32 m0, s35, 65536
    s_add_u32 s40, s38, 0
    buffer_load_dwordx4 v6, s[8:11], s40 offen sc1 lds
    s_add_u32 m0, s35, 8192
    s_add_u32 s40, s37, 8192
    buffer_load_dwordx4 v6, s[8:11], s40 offen sc1 lds
    s_add_u32 m0, s35, 73728
    s_add_u32 s40, s38, 8192
    buffer_load_dwordx4 v6, s[8:11], s40 offen sc1 lds
    s_add_u32 s20, s82, s6
    s_addc_u32 s21, s83, 0
    s_add_u32 s20, s20, 10485760
    s_addc_u32 s21, s21, 0
    s_mov_b32 s22, 2097152
    s_mov_b32 s23, 0x20000
    v_lshrrev_b32 v4, 5, v1
    v_lshlrev_b32 v4, 8, v4
    v_and_b32 v5, 15, v1
    v_lshlrev_b32 v5, 4, v5
    v_add_u32 v3, v4, v5
    v_add_u32 v3, 65536, v3
    s_mov_b32 s44, 0x0000ffff
    s_mov_b32 s45, 0x0000ffff
    v_mov_b32 v20, 0x3f803f80
    v_mov_b32 v21, 0x3f803f80
    v_mov_b32 v22, 0x3f803f80
    v_mov_b32 v23, 0x3f803f80
    v_mov_b32 v24, 0x3f803f80
    v_mov_b32 v25, 0x3f803f80
    v_mov_b32 v26, 0x3f803f80
    v_mov_b32 v27, 0x3f803f80
    v_mov_b32 v28, 0x3f803f80
    v_mov_b32 v29, 0x3f803f80
    v_mov_b32 v30, 0x3f803f80
    v_mov_b32 v31, 0x3f803f80
    v_mov_b32 v32, 0x3f803f80
    v_mov_b32 v33, 0x3f803f80
    v_mov_b32 v34, 0x3f803f80
    v_mov_b32 v35, 0x3f803f80
    v_mov_b32 v80, 0
    v_mov_b32 v81, 0
    v_mov_b32 v82, 0
    v_mov_b32 v83, 0
    v_mov_b32 v84, 0
    v_mov_b32 v85, 0
    v_mov_b32 v86, 0
    v_mov_b32 v87, 0
    v_mov_b32 v88, 0
    v_mov_b32 v89, 0
    v_mov_b32 v90, 0
    v_mov_b32 v91, 0
    v_mov_b32 v92, 0
    v_mov_b32 v93, 0
    v_mov_b32 v94, 0
    v_mov_b32 v95, 0
    s_mov_b32 s12, s68
    s_mov_b32 s13, s69
    s_mov_b32 s14, 524288
    s_mov_b32 s15, 0x20000
    v_lshrrev_b32 v4, 3, v1
    v_and_b32 v7, 7, v1
    v_lshlrev_b32 v4, 10, v4
    v_lshrrev_b32 v5, 4, v1
    v_and_b32 v5, 1, v5
    v_lshlrev_b32 v5, 2, v5
    v_xor_b32 v5, v5, v7
    v_lshlrev_b32 v5, 4, v5
    v_add_u32 v7, v4, v5
    s_mov_b32 s16, s72
    s_mov_b32 s17, s73
    s_mov_b32 s18, 1835008
    s_mov_b32 s19, 0x20000
    s_cmp_ge_u32 s3, 4
    s_cselect_b32 s16, s74, s16
    s_cselect_b32 s17, s75, s17
    v_lshrrev_b32 v4, 1, v1
    s_mov_b32 s56, 3584
    v_mul_lo_u32 v4, v4, s56
    v_and_b32 v5, 1, v1
    v_lshlrev_b32 v5, 7, v5
    v_add_u32 v4, v4, v5
    s_and_b32 s56, s90, 3
    s_lshl_b32 s56, s56, 2
    s_and_b32 s57, s3, 3
    s_add_u32 s56, s56, s57
    s_mul_i32 s56, s56, 114688
    s_lshl_b32 s57, s91, 8
    s_add_u32 s56, s56, s57
    s_and_b32 s51, s3, 3
    s_lshr_b32 s52, s3, 2
    s_lshl_b32 s53, s51, 12
    s_lshl_b32 s54, s52, 16
    s_add_u32 s53, s53, s54
    s_lshl_b32 s54, s51, 15
    s_lshl_b32 s55, s52, 18
    s_add_u32 s54, s54, s55
    s_lshl_b32 s55, s89, 7
    s_add_u32 s54, s54, s55
    s_waitcnt vmcnt(2)
    s_barrier
    ds_read_b128 v[12:15], v2 offset:0
    ds_read_b128 v[16:19], v2 offset:1024
    s_mov_b64 exec, s[44:45]
    ds_read_b128 v[20:23], v3 offset:0
    ds_read_b128 v[24:27], v3 offset:512
    s_mov_b64 exec, -1
    s_waitcnt lgkmcnt(0)
    v_mfma_f32_32x32x16_bf16 v[48:63], v[12:15], v[8:11], 0
    v_mfma_f32_32x32x16_bf16 v[64:79], v[16:19], v[8:11], 0
    ds_read_b128 v[12:15], v2 offset:2048
    s_mov_b32 s49, 0
P2C_LOOP:
    s_cmp_lt_u32 s49, 7
    s_cbranch_scc1 P2C_DISP
P2C_L3:
    s_nop 6
    v_exp_f32 v48, v48
    v_exp_f32 v49, v49
    v_exp_f32 v50, v50
    v_exp_f32 v51, v51
    v_exp_f32 v52, v52
    v_exp_f32 v53, v53
    v_exp_f32 v54, v54
    v_exp_f32 v55, v55
    v_exp_f32 v56, v56
    v_cvt_pk_bf16_f32 v112, v48, v49
    v_cvt_pk_bf16_f32 v113, v50, v51
    v_cvt_pk_bf16_f32 v114, v52, v53
    v_cvt_pk_bf16_f32 v115, v54, v55
    v_exp_f32 v57, v57
    v_exp_f32 v58, v58
    s_waitcnt lgkmcnt(0)
    v_mfma_f32_32x32x16_bf16 v[80:95], v[20:23], v[112:115], v[80:95]
    v_exp_f32 v59, v59
    v_exp_f32 v60, v60
    v_exp_f32 v61, v61
    v_exp_f32 v62, v62
    v_exp_f32 v63, v63
    s_mov_b64 exec, s[44:45]
    ds_read_b128 v[28:31], v3 offset:1024
    ds_read_b128 v[32:35], v3 offset:1536
    s_mov_b64 exec, -1
    v_cvt_pk_bf16_f32 v116, v56, v57
    v_cvt_pk_bf16_f32 v117, v58, v59
    v_cvt_pk_bf16_f32 v118, v60, v61
    v_cvt_pk_bf16_f32 v119, v62, v63
    v_mfma_f32_32x32x16_bf16 v[48:63], v[12:15], v[8:11], 0
    ds_read_b128 v[16:19], v2 offset:3072
    v_mfma_f32_32x32x16_bf16 v[80:95], v[24:27], v[116:119], v[80:95]
    v_exp_f32 v64, v64
    v_exp_f32 v65, v65
    v_exp_f32 v66, v66
    v_exp_f32 v67, v67
    v_exp_f32 v68, v68
    v_exp_f32 v69, v69
    v_exp_f32 v70, v70
    v_exp_f32 v71, v71
    v_exp_f32 v72, v72
    v_cvt_pk_bf16_f32 v112, v64, v65
    v_cvt_pk_bf16_f32 v113, v66, v67
    v_cvt_pk_bf16_f32 v114, v68, v69
    v_cvt_pk_bf16_f32 v115, v70, v71
    v_exp_f32 v73, v73
    v_exp_f32 v74, v74
    s_waitcnt lgkmcnt(0)
    v_mfma_f32_32x32x16_bf16 v[80:95], v[28:31], v[112:115], v[80:95]
    v_exp_f32 v75, v75
    v_exp_f32 v76, v76
    v_exp_f32 v77, v77
    v_exp_f32 v78, v78
    v_exp_f32 v79, v79
    s_mov_b64 exec, s[44:45]
    ds_read_b128 v[20:23], v3 offset:2048
    ds_read_b128 v[24:27], v3 offset:2560
    s_mov_b64 exec, -1
    v_cvt_pk_bf16_f32 v116, v72, v73
    v_cvt_pk_bf16_f32 v117, v74, v75
    v_cvt_pk_bf16_f32 v118, v76, v77
    v_cvt_pk_bf16_f32 v119, v78, v79
    v_mfma_f32_32x32x16_bf16 v[64:79], v[16:19], v[8:11], 0
    ds_read_b128 v[12:15], v2 offset:4096
    v_mfma_f32_32x32x16_bf16 v[80:95], v[32:35], v[116:119], v[80:95]
    v_exp_f32 v48, v48
    v_exp_f32 v49, v49
    v_exp_f32 v50, v50
    v_exp_f32 v51, v51
    v_exp_f32 v52, v52
    v_exp_f32 v53, v53
    v_exp_f32 v54, v54
    v_exp_f32 v55, v55
    v_exp_f32 v56, v56
    v_cvt_pk_bf16_f32 v112, v48, v49
    v_cvt_pk_bf16_f32 v113, v50, v51
    v_cvt_pk_bf16_f32 v114, v52, v53
    v_cvt_pk_bf16_f32 v115, v54, v55
    v_exp_f32 v57, v57
    v_exp_f32 v58, v58
    s_waitcnt lgkmcnt(0)
    v_mfma_f32_32x32x16_bf16 v[80:95], v[20:23], v[112:115], v[80:95]
    v_exp_f32 v59, v59
    v_exp_f32 v60, v60
    v_exp_f32 v61, v61
    v_exp_f32 v62, v62
    v_exp_f32 v63, v63
    s_mov_b64 exec, s[44:45]
    ds_read_b128 v[28:31], v3 offset:3072
    ds_read_b128 v[32:35], v3 offset:3584
    s_mov_b64 exec, -1
    v_cvt_pk_bf16_f32 v116, v56, v57
    v_cvt_pk_bf16_f32 v117, v58, v59
    v_cvt_pk_bf16_f32 v118, v60, v61
    v_cvt_pk_bf16_f32 v119, v62, v63
    v_mfma_f32_32x32x16_bf16 v[48:63], v[12:15], v[8:11], 0
    ds_read_b128 v[16:19], v2 offset:5120
    v_mfma_f32_32x32x16_bf16 v[80:95], v[24:27], v[116:119], v[80:95]
    v_exp_f32 v64, v64
    v_exp_f32 v65, v65
    v_exp_f32 v66, v66
    v_exp_f32 v67, v67
    v_exp_f32 v68, v68
    v_exp_f32 v69, v69
    v_exp_f32 v70, v70
    v_exp_f32 v71, v71
    v_exp_f32 v72, v72
    v_cvt_pk_bf16_f32 v112, v64, v65
    v_cvt_pk_bf16_f32 v113, v66, v67
    v_cvt_pk_bf16_f32 v114, v68, v69
    v_cvt_pk_bf16_f32 v115, v70, v71
    v_exp_f32 v73, v73
    v_exp_f32 v74, v74
    s_waitcnt lgkmcnt(0)
    v_mfma_f32_32x32x16_bf16 v[80:95], v[28:31], v[112:115], v[80:95]
    v_exp_f32 v75, v75
    v_exp_f32 v76, v76
    v_exp_f32 v77, v77
    v_exp_f32 v78, v78
    v_exp_f32 v79, v79
    s_mov_b64 exec, s[44:45]
    ds_read_b128 v[20:23], v3 offset:4096
    ds_read_b128 v[24:27], v3 offset:4608
    s_mov_b64 exec, -1
    v_cvt_pk_bf16_f32 v116, v72, v73
    v_cvt_pk_bf16_f32 v117, v74, v75
    v_cvt_pk_bf16_f32 v118, v76, v77
    v_cvt_pk_bf16_f32 v119, v78, v79
    v_mfma_f32_32x32x16_bf16 v[64:79], v[16:19], v[8:11], 0
    ds_read_b128 v[12:15], v2 offset:6144
    v_mfma_f32_32x32x16_bf16 v[80:95], v[32:35], v[116:119], v[80:95]
    v_exp_f32 v48, v48
    v_exp_f32 v49, v49
    v_exp_f32 v50, v50
    v_exp_f32 v51, v51
    v_exp_f32 v52, v52
    v_exp_f32 v53, v53
    v_exp_f32 v54, v54
    v_exp_f32 v55, v55
    v_exp_f32 v56, v56
    v_cvt_pk_bf16_f32 v112, v48, v49
    v_cvt_pk_bf16_f32 v113, v50, v51
    v_cvt_pk_bf16_f32 v114, v52, v53
    v_cvt_pk_bf16_f32 v115, v54, v55
    v_exp_f32 v57, v57
    v_exp_f32 v58, v58
    s_waitcnt lgkmcnt(0)
    v_mfma_f32_32x32x16_bf16 v[80:95], v[20:23], v[112:115], v[80:95]
    v_exp_f32 v59, v59
    v_exp_f32 v60, v60
    v_exp_f32 v61, v61
    v_exp_f32 v62, v62
    v_exp_f32 v63, v63
    s_mov_b64 exec, s[44:45]
    ds_read_b128 v[28:31], v3 offset:5120
    ds_read_b128 v[32:35], v3 offset:5632
    s_mov_b64 exec, -1
    v_cvt_pk_bf16_f32 v116, v56, v57
    v_cvt_pk_bf16_f32 v117, v58, v59
    v_cvt_pk_bf16_f32 v118, v60, v61
    v_cvt_pk_bf16_f32 v119, v62, v63
    v_mfma_f32_32x32x16_bf16 v[48:63], v[12:15], v[8:11], 0
    ds_read_b128 v[16:19], v2 offset:7168
    v_mfma_f32_32x32x16_bf16 v[80:95], v[24:27], v[116:119], v[80:95]
    s_cmp_lg_u32 s49, 0
    s_cbranch_scc1 P2C_EKV
    s_waitcnt vmcnt(4)
    s_barrier
P2C_EKV:
    v_exp_f32 v64, v64
    v_exp_f32 v65, v65
    v_exp_f32 v66, v66
    v_exp_f32 v67, v67
    v_exp_f32 v68, v68
    v_exp_f32 v69, v69
    v_exp_f32 v70, v70
    v_exp_f32 v71, v71
    v_exp_f32 v72, v72
    v_cvt_pk_bf16_f32 v112, v64, v65
    v_cvt_pk_bf16_f32 v113, v66, v67
    v_cvt_pk_bf16_f32 v114, v68, v69
    v_cvt_pk_bf16_f32 v115, v70, v71
    v_exp_f32 v73, v73
    v_exp_f32 v74, v74
    s_waitcnt lgkmcnt(0)
    v_mfma_f32_32x32x16_bf16 v[80:95], v[28:31], v[112:115], v[80:95]
    v_exp_f32 v75, v75
    v_exp_f32 v76, v76
    v_exp_f32 v77, v77
    v_exp_f32 v78, v78
    v_exp_f32 v79, v79
    s_mov_b64 exec, s[44:45]
    ds_read_b128 v[20:23], v3 offset:6144
    ds_read_b128 v[24:27], v3 offset:6656
    s_mov_b64 exec, -1
    v_cvt_pk_bf16_f32 v116, v72, v73
    v_cvt_pk_bf16_f32 v117, v74, v75
    v_cvt_pk_bf16_f32 v118, v76, v77
    v_cvt_pk_bf16_f32 v119, v78, v79
    v_mfma_f32_32x32x16_bf16 v[64:79], v[16:19], v[8:11], 0
    ds_read_b128 v[12:15], v2 offset:8192
    v_mfma_f32_32x32x16_bf16 v[80:95], v[32:35], v[116:119], v[80:95]
    v_exp_f32 v48, v48
    v_exp_f32 v49, v49
    v_exp_f32 v50, v50
    v_exp_f32 v51, v51
    v_exp_f32 v52, v52
    v_exp_f32 v53, v53
    v_exp_f32 v54, v54
    v_exp_f32 v55, v55
    v_exp_f32 v56, v56
    v_cvt_pk_bf16_f32 v112, v48, v49
    v_cvt_pk_bf16_f32 v113, v50, v51
    v_cvt_pk_bf16_f32 v114, v52, v53
    v_cvt_pk_bf16_f32 v115, v54, v55
    v_exp_f32 v57, v57
    v_exp_f32 v58, v58
    s_waitcnt lgkmcnt(0)
    v_mfma_f32_32x32x16_bf16 v[80:95], v[20:23], v[112:115], v[80:95]
    v_exp_f32 v59, v59
    v_exp_f32 v60, v60
    v_exp_f32 v61, v61
    v_exp_f32 v62, v62
    v_exp_f32 v63, v63
    s_mov_b64 exec, s[44:45]
    ds_read_b128 v[28:31], v3 offset:7168
    ds_read_b128 v[32:35], v3 offset:7680
    s_mov_b64 exec, -1
    v_cvt_pk_bf16_f32 v116, v56, v57
    v_cvt_pk_bf16_f32 v117, v58, v59
    v_cvt_pk_bf16_f32 v118, v60, v61
    v_cvt_pk_bf16_f32 v119, v62, v63
    v_mfma_f32_32x32x16_bf16 v[48:63], v[12:15], v[8:11], 0
    ds_read_b128 v[16:19], v2 offset:9216
    v_mfma_f32_32x32x16_bf16 v[80:95], v[24:27], v[116:119], v[80:95]
    v_exp_f32 v64, v64
    v_exp_f32 v65, v65
    v_exp_f32 v66, v66
    v_exp_f32 v67, v67
    v_exp_f32 v68, v68
    v_exp_f32 v69, v69
    v_exp_f32 v70, v70
    v_exp_f32 v71, v71
    v_exp_f32 v72, v72
    v_cvt_pk_bf16_f32 v112, v64, v65
    v_cvt_pk_bf16_f32 v113, v66, v67
    v_cvt_pk_bf16_f32 v114, v68, v69
    v_cvt_pk_bf16_f32 v115, v70, v71
    v_exp_f32 v73, v73
    v_exp_f32 v74, v74
    s_waitcnt lgkmcnt(0)
    v_mfma_f32_32x32x16_bf16 v[80:95], v[28:31], v[112:115], v[80:95]
    v_exp_f32 v75, v75
    v_exp_f32 v76, v76
    v_exp_f32 v77, v77
    v_exp_f32 v78, v78
    v_exp_f32 v79, v79
    s_mov_b64 exec, s[44:45]
    ds_read_b128 v[20:23], v3 offset:8192
    ds_read_b128 v[24:27], v3 offset:8704
    s_mov_b64 exec, -1
    v_cvt_pk_bf16_f32 v116, v72, v73
    v_cvt_pk_bf16_f32 v117, v74, v75
    v_cvt_pk_bf16_f32 v118, v76, v77
    v_cvt_pk_bf16_f32 v119, v78, v79
    v_mfma_f32_32x32x16_bf16 v[64:79], v[16:19], v[8:11], 0
    ds_read_b128 v[12:15], v2 offset:10240
    v_mfma_f32_32x32x16_bf16 v[80:95], v[32:35], v[116:119], v[80:95]
    v_add_u32 v2, 8192, v2
    v_add_u32 v3, 8192, v3
    s_add_u32 s49, s49, 1
    s_cmp_lt_u32 s49, 8
    s_cbranch_scc1 P2C_LOOP
    s_branch P2C_DONE
P2C_DISP:
    s_cmp_eq_u32 s49, 1
    s_cbranch_scc1 P2C_H1
    s_cmp_eq_u32 s49, 2
    s_cbranch_scc1 P2C_H2
    s_cmp_eq_u32 s49, 3
    s_cbranch_scc1 P2C_H3
    s_cmp_eq_u32 s49, 4
    s_cbranch_scc1 P2C_H4
    s_cmp_eq_u32 s49, 5
    s_cbranch_scc1 P2C_H5
    s_cmp_eq_u32 s49, 6
    s_cbranch_scc1 P2C_H6
P2C_H0:
    s_add_u32 m0, s35, 16384
    s_add_u32 s40, s37, 16384
    buffer_load_dwordx4 v6, s[8:11], s40 offen sc1 lds
    s_add_u32 m0, s35, 81920
    s_add_u32 s40, s38, 16384
    buffer_load_dwordx4 v6, s[8:11], s40 offen sc1 lds
    s_add_u32 m0, s35, 24576
    s_add_u32 s40, s37, 24576
    buffer_load_dwordx4 v6, s[8:11], s40 offen sc1 lds
    s_add_u32 m0, s35, 90112
    s_add_u32 s40, s38, 24576
    buffer_load_dwordx4 v6, s[8:11], s40 offen sc1 lds
    s_branch P2C_L3
P2C_H1:
    s_waitcnt vmcnt(0)
    s_barrier
    s_add_u32 m0, s35, 32768
    s_add_u32 s40, s37, 32768
    buffer_load_dwordx4 v6, s[8:11], s40 offen sc1 lds
    s_add_u32 m0, s35, 98304
    s_add_u32 s40, s38, 32768
    buffer_load_dwordx4 v6, s[8:11], s40 offen sc1 lds
    s_add_u32 m0, s35, 40960
    s_add_u32 s40, s37, 40960
    buffer_load_dwordx4 v6, s[8:11], s40 offen sc1 lds
    s_add_u32 m0, s35, 106496
    s_add_u32 s40, s38, 40960
    buffer_load_dwordx4 v6, s[8:11], s40 offen sc1 lds
    s_branch P2C_L3
P2C_H2:
    s_add_u32 m0, s35, 49152
    s_add_u32 s40, s37, 49152
    buffer_load_dwordx4 v6, s[8:11], s40 offen sc1 lds
    s_add_u32 m0, s35, 114688
    s_add_u32 s40, s38, 49152
    buffer_load_dwordx4 v6, s[8:11], s40 offen sc1 lds
    s_add_u32 m0, s35, 57344
    s_add_u32 s40, s37, 57344
    buffer_load_dwordx4 v6, s[8:11], s40 offen sc1 lds
    s_add_u32 m0, s35, 122880
    s_add_u32 s40, s38, 57344
    buffer_load_dwordx4 v6, s[8:11], s40 offen sc1 lds
    s_branch P2C_L3
P2C_H3:
    s_waitcnt vmcnt(4)
    s_barrier
    s_branch P2C_L3
P2C_H4:
    s_waitcnt vmcnt(0)
    s_cmp_ge_u32 s2, 224
    s_cbranch_scc1 P2C_L3
    buffer_load_dword v5, v4, s[16:19], s56 offen
    s_branch P2C_L3
P2C_H5:
    s_barrier
    s_add_u32 m0, s53, 0
    s_add_u32 s40, s54, 0
    buffer_load_dwordx4 v7, s[12:15], s40 offen lds
    s_add_u32 m0, s53, 1024
    s_add_u32 s40, s54, 8192
    buffer_load_dwordx4 v7, s[12:15], s40 offen lds
    s_add_u32 m0, s53, 2048
    s_add_u32 s40, s54, 16384
    buffer_load_dwordx4 v7, s[12:15], s40 offen lds
    s_add_u32 m0, s53, 3072
    s_add_u32 s40, s54, 24576
    buffer_load_dwordx4 v7, s[12:15], s40 offen lds
    s_branch P2C_L3
P2C_H6:
    s_add_u32 m0, s53, 16384
    s_add_u32 s40, s54, 131072
    buffer_load_dwordx4 v7, s[12:15], s40 offen lds
    s_add_u32 m0, s53, 17408
    s_add_u32 s40, s54, 139264
    buffer_load_dwordx4 v7, s[12:15], s40 offen lds
    s_add_u32 m0, s53, 18432
    s_add_u32 s40, s54, 147456
    buffer_load_dwordx4 v7, s[12:15], s40 offen lds
    s_add_u32 m0, s53, 19456
    s_add_u32 s40, s54, 155648
    buffer_load_dwordx4 v7, s[12:15], s40 offen lds
    s_branch P2C_L3
P2C_DONE:
    s_waitcnt lgkmcnt(0)
    v_add_u32 v2, 0xffff0000, v2
    s_nop 15
    v_cmp_le_f32 vcc, 0x1f800000, v88
    s_nop 1
    s_mov_b64 s[46:47], vcc
    v_cmp_ge_f32 vcc, 0x5f800000, v88
    s_nop 1
    s_and_b64 s[46:47], s[46:47], vcc
    s_mov_b32 s48, 0x7b800000
    v_cmp_gt_f32_e64 vcc, s48, |v80|
    s_nop 1
    s_and_b64 s[46:47], s[46:47], vcc
    v_cmp_gt_f32_e64 vcc, s48, |v81|
    s_nop 1
    s_and_b64 s[46:47], s[46:47], vcc
    v_cmp_gt_f32_e64 vcc, s48, |v82|
    s_nop 1
    s_and_b64 s[46:47], s[46:47], vcc
    v_cmp_gt_f32_e64 vcc, s48, |v83|
    s_nop 1
    s_and_b64 s[46:47], s[46:47], vcc
    v_cmp_gt_f32_e64 vcc, s48, |v84|
    s_nop 1
    s_and_b64 s[46:47], s[46:47], vcc
    v_cmp_gt_f32_e64 vcc, s48, |v85|
    s_nop 1
    s_and_b64 s[46:47], s[46:47], vcc
    v_cmp_gt_f32_e64 vcc, s48, |v86|
    s_nop 1
    s_and_b64 s[46:47], s[46:47], vcc
    v_cmp_gt_f32_e64 vcc, s48, |v87|
    s_nop 1
    s_and_b64 s[46:47], s[46:47], vcc
    s_cmp_eq_u64 s[46:47], -1
    s_cbranch_scc1 P2C_FIN
    s_add_u32 s37, s33, 2097152
    s_add_u32 s38, s33, 4194304
    v_add_u32 v3, 0xffff0000, v3
    v_add_u32 v3, 0xffff0000, v3
    v_mov_b32 v96, 0xff800000
    s_mov_b32 s49, 0
    s_mov_b32 s40, s37
P2C_MX:
    buffer_load_dwordx4 v[12:15], v2, s[8:11], s40 offen sc1
    s_waitcnt vmcnt(0)
    v_mfma_f32_32x32x16_bf16 v[48:63], v[12:15], v[8:11], 0
    s_nop 11
    v_max3_f32 v96, v48, v49, v96
    v_max3_f32 v96, v50, v51, v96
    v_max3_f32 v96, v52, v53, v96
    v_max3_f32 v96, v54, v55, v96
    v_max3_f32 v96, v56, v57, v96
    v_max3_f32 v96, v58, v59, v96
    v_max3_f32 v96, v60, v61, v96
    v_max3_f32 v96, v62, v63, v96
    s_add_u32 s40, s40, 1024
    s_add_u32 s49, s49, 1
    s_cmp_lt_u32 s49, 64
    s_cbranch_scc1 P2C_MX
    v_mov_b32 v97, v96
    s_nop 1
    v_permlane32_swap_b32 v96, v97
    v_max_f32 v96, v96, v97
    v_sub_f32 v64, 0, v96
    v_sub_f32 v65, 0, v96
    v_sub_f32 v66, 0, v96
    v_sub_f32 v67, 0, v96
    v_sub_f32 v68, 0, v96
    v_sub_f32 v69, 0, v96
    v_sub_f32 v70, 0, v96
    v_sub_f32 v71, 0, v96
    v_sub_f32 v72, 0, v96
    v_sub_f32 v73, 0, v96
    v_sub_f32 v74, 0, v96
    v_sub_f32 v75, 0, v96
    v_sub_f32 v76, 0, v96
    v_sub_f32 v77, 0, v96
    v_sub_f32 v78, 0, v96
    v_sub_f32 v79, 0, v96
    v_mov_b32 v80, 0
    v_mov_b32 v81, 0
    v_mov_b32 v82, 0
    v_mov_b32 v83, 0
    v_mov_b32 v84, 0
    v_mov_b32 v85, 0
    v_mov_b32 v86, 0
    v_mov_b32 v87, 0
    v_mov_b32 v88, 0
    v_mov_b32 v89, 0
    v_mov_b32 v90, 0
    v_mov_b32 v91, 0
    v_mov_b32 v92, 0
    v_mov_b32 v93, 0
    v_mov_b32 v94, 0
    v_mov_b32 v95, 0
    s_mov_b32 s49, 0
    s_mov_b32 s40, s37
    s_mov_b32 s41, s38
P2C_FB:
    buffer_load_dwordx4 v[12:15], v2, s[8:11], s40 offen sc1
    s_mov_b64 exec, s[44:45]
    buffer_load_dwordx4 v[20:23], v3, s[8:11], s41 offen offset:0 sc1
    buffer_load_dwordx4 v[24:27], v3, s[8:11], s41 offen offset:512 sc1
    s_mov_b64 exec, -1
    s_waitcnt vmcnt(0)
    v_mfma_f32_32x32x16_bf16 v[48:63], v[12:15], v[8:11], v[64:79]
    s_nop 11
    v_exp_f32 v48, v48
    v_exp_f32 v49, v49
    v_exp_f32 v50, v50
    v_exp_f32 v51, v51
    v_exp_f32 v52, v52
    v_exp_f32 v53, v53
    v_exp_f32 v54, v54
    v_exp_f32 v55, v55
    v_exp_f32 v56, v56
    v_exp_f32 v57, v57
    v_exp_f32 v58, v58
    v_exp_f32 v59, v59
    v_exp_f32 v60, v60
    v_exp_f32 v61, v61
    v_exp_f32 v62, v62
    v_exp_f32 v63, v63
    v_cvt_pk_bf16_f32 v112, v48, v49
    v_cvt_pk_bf16_f32 v113, v50, v51
    v_cvt_pk_bf16_f32 v114, v52, v53
    v_cvt_pk_bf16_f32 v115, v54, v55
    v_cvt_pk_bf16_f32 v116, v56, v57
    v_cvt_pk_bf16_f32 v117, v58, v59
    v_cvt_pk_bf16_f32 v118, v60, v61
    v_cvt_pk_bf16_f32 v119, v62, v63
    v_mfma_f32_32x32x16_bf16 v[80:95], v[20:23], v[112:115], v[80:95]
    s_nop 0
    v_mfma_f32_32x32x16_bf16 v[80:95], v[24:27], v[116:119], v[80:95]
    s_add_u32 s40, s40, 1024
    s_add_u32 s41, s41, 1024
    s_add_u32 s49, s49, 1
    s_cmp_lt_u32 s49, 64
    s_cbranch_scc1 P2C_FB
    s_nop 15
P2C_FIN:
    v_rcp_f32 v6, v88
    s_nop 0
    v_mul_f32 v80, v80, v6
    v_mul_f32 v81, v81, v6
    v_mul_f32 v82, v82, v6
    v_mul_f32 v83, v83, v6
    v_mul_f32 v84, v84, v6
    v_mul_f32 v85, v85, v6
    v_mul_f32 v86, v86, v6
    v_mul_f32 v87, v87, v6
    v_cvt_pk_bf16_f32 v112, v80, v81
    v_cvt_pk_bf16_f32 v113, v82, v83
    v_cvt_pk_bf16_f32 v114, v84, v85
    v_cvt_pk_bf16_f32 v115, v86, v87
    s_lshl_b32 s34, s32, 5
    s_add_u32 s34, s34, s86
    s_lshl_b32 s34, s34, 10
    buffer_store_dwordx4 v[112:115], v2, s[20:23], s34 offen sc1
    s_waitcnt vmcnt(0)
    s_barrier
    s_cmp_lg_u32 s3, 0
    s_cbranch_scc1 W0S8
    s_lshl_b32 s31, s87, 5
    s_add_u32 s31, s31, s86
    s_add_u32 s29, s5, 0
    s_mul_i32 s29, s29, 163840
    s_add_u32 s29, s29, 67141632
    s_lshl_b32 s28, s31, 7
    s_add_u32 s29, s29, s28
    v_mov_b32 v6, s29
    v_mov_b32 v7, s4
    s_mov_b64 exec, 1
    global_store_dword v6, v7, s[82:83] sc1
    s_mov_b64 exec, -1
W0S8:
    v_lshrrev_b32 v2, 4, v1
    v_and_b32 v3, 15, v1
    v_lshrrev_b32 v3, 2, v3
    v_lshrrev_b32 v4, 5, v1
    v_and_b32 v5, 31, v1
    s_add_u32 s24, s82, 2097152
    s_addc_u32 s25, s83, 0
    s_cmp_eq_u32 s5, 0
    s_cselect_b32 s24, s64, s24
    s_cselect_b32 s25, s65, s25
    s_mov_b32 s26, 2097152
    s_mov_b32 s27, 0x20000
    s_and_b32 s33, s3, 1
    s_lshr_b32 s34, s3, 1
    s_lshl_b32 s35, s88, 6
    s_lshl_b32 s36, s33, 5
    s_add_u32 s35, s35, s36
    s_lshl_b32 s35, s35, 10
    s_lshl_b32 s36, s89, 7
    s_lshl_b32 s37, s34, 6
    s_add_u32 s36, s36, s37
    s_add_u32 s35, s35, s36
    s_lshl_b32 s41, s88, 3
    s_add_u32 s41, s41, s89
    s_lshl_b32 s41, s41, 13
    s_lshl_b32 s36, s34, 12
    s_add_u32 s41, s41, s36
    s_lshl_b32 s36, s33, 10
    s_add_u32 s41, s41, s36
    s_cmp_eq_u32 s5, 0
    s_cselect_b32 s42, 1024, 16
    s_cselect_b32 s43, s35, s41
    s_cselect_b32 s44, 16, 512
    s_cselect_b32 s45, 32, 2048
    v_mul_u32_u24 v6, s42, v5
    v_lshlrev_b32 v7, 3, v4
    v_add_u32 v6, v6, v7
    buffer_load_dwordx2 v[48:49], v6, s[24:27], s43 offen sc1
    s_add_u32 s43, s43, s44
    buffer_load_dwordx2 v[50:51], v6, s[24:27], s43 offen sc1
    s_add_u32 s43, s43, s45
    s_sub_u32 s43, s43, s44
    buffer_load_dwordx2 v[52:53], v6, s[24:27], s43 offen sc1
    s_add_u32 s43, s43, s44
    buffer_load_dwordx2 v[54:55], v6, s[24:27], s43 offen sc1
    s_lshl_b32 s36, s33, 13
    v_lshlrev_b32 v7, 4, v1
    v_add_u32 v7, s36, v7
    v_add_u32 v8, 0, v7
    v_add_u32 v9, 65536, v7
    v_add_u32 v10, 131072, v7
    v_lshlrev_b32 v7, 2, v4
    v_add_u32 v7, v7, v3
    v_lshlrev_b32 v7, 7, v7
    v_and_b32 v16, 3, v1
    v_lshlrev_b32 v16, 3, v16
    v_add_u32 v7, v7, v16
    v_lshrrev_b32 v16, 1, v3
    v_lshlrev_b32 v16, 6, v16
    s_lshl_b32 s36, s34, 6
    v_xor_b32 v16, s36, v16
    v_add_u32 v7, v7, v16
    v_and_b32 v16, 1, v2
    v_lshlrev_b32 v16, 5, v16
    v_add_u32 v7, v7, v16
    v_add_u32 v12, 0, v7
    v_add_u32 v13, 65536, v7
    v_add_u32 v14, 131072, v7
    s_cmp_lg_u32 s3, 0
    s_cbranch_scc1 W0S9
    s_lshr_b32 s31, s88, 2
    s_lshl_b32 s31, s31, 5
    s_add_u32 s29, s5, 0
    s_mul_i32 s29, s29, 163840
    s_add_u32 s29, s29, 67141632
    s_lshl_b32 s28, s31, 7
    s_add_u32 s29, s29, s28
    v_min_u32 v6, 31, v1
    v_lshlrev_b32 v6, 7, v6
    v_add_u32 v6, s29, v6
    s_mov_b32 s30, 20000
POLL10:
    global_load_dword v7, v6, s[82:83] sc1
    s_waitcnt vmcnt(0)
    v_cmp_ne_u32 vcc, s4, v7
    s_nop 4
    s_cbranch_vccz POLL10D
    s_sub_u32 s30, s30, 1
    s_cmp_lg_u32 s30, 0
    s_cbranch_scc1 POLL10
POLL10D:
W0S9:
    s_barrier
    s_waitcnt vmcnt(0)
    v_lshlrev_b32 v64, 16, v48
    v_and_b32 v65, 0xffff0000, v48
    v_lshlrev_b32 v66, 16, v49
    v_and_b32 v67, 0xffff0000, v49
    v_lshlrev_b32 v68, 16, v50
    v_and_b32 v69, 0xffff0000, v50
    v_lshlrev_b32 v70, 16, v51
    v_and_b32 v71, 0xffff0000, v51
    v_lshlrev_b32 v72, 16, v52
    v_and_b32 v73, 0xffff0000, v52
    v_lshlrev_b32 v74, 16, v53
    v_and_b32 v75, 0xffff0000, v53
    v_lshlrev_b32 v76, 16, v54
    v_and_b32 v77, 0xffff0000, v54
    v_lshlrev_b32 v78, 16, v55
    v_and_b32 v79, 0xffff0000, v55
    v_mov_b32 v80, 0
    v_mov_b32 v81, 0
    v_mov_b32 v82, 0
    v_mov_b32 v83, 0
    v_mov_b32 v84, 0
    v_mov_b32 v85, 0
    v_mov_b32 v86, 0
    v_mov_b32 v87, 0
    v_mov_b32 v88, 0
    v_mov_b32 v89, 0
    v_mov_b32 v90, 0
    v_mov_b32 v91, 0
    v_mov_b32 v92, 0
    v_mov_b32 v93, 0
    v_mov_b32 v94, 0
    v_mov_b32 v95, 0
    s_barrier
    ds_read_b128 v[96:99], v8 offset:32768
    ds_read_b64_tr_b16 v[100:101], v12 offset:0
    ds_read_b64_tr_b16 v[102:103], v12 offset:1024
    ds_read_b128 v[104:107], v8 offset:33792
    ds_read_b64_tr_b16 v[108:109], v12 offset:2048
    ds_read_b64_tr_b16 v[110:111], v12 offset:3072
    ds_read_b128 v[112:115], v8 offset:34816
    ds_read_b64_tr_b16 v[116:117], v12 offset:4096
    ds_read_b64_tr_b16 v[118:119], v12 offset:5120
    s_waitcnt lgkmcnt(6)
    v_mfma_f32_32x32x16_bf16 v[64:79], v[100:103], v[96:99], v[64:79]
    ds_read_b128 v[96:99], v8 offset:35840
    ds_read_b64_tr_b16 v[100:101], v12 offset:6144
    ds_read_b64_tr_b16 v[102:103], v12 offset:7168
    s_waitcnt lgkmcnt(6)
    v_mfma_f32_32x32x16_bf16 v[80:95], v[108:111], v[104:107], v[80:95]
    ds_read_b128 v[104:107], v8 offset:36864
    ds_read_b64_tr_b16 v[108:109], v12 offset:8192
    ds_read_b64_tr_b16 v[110:111], v12 offset:9216
    s_waitcnt lgkmcnt(6)
    v_mfma_f32_32x32x16_bf16 v[64:79], v[116:119], v[112:115], v[64:79]
    ds_read_b128 v[112:115], v8 offset:37888
    ds_read_b64_tr_b16 v[116:117], v12 offset:10240
    ds_read_b64_tr_b16 v[118:119], v12 offset:11264
    s_waitcnt lgkmcnt(6)
    v_mfma_f32_32x32x16_bf16 v[80:95], v[100:103], v[96:99], v[80:95]
    ds_read_b128 v[96:99], v8 offset:38912
    ds_read_b64_tr_b16 v[100:101], v12 offset:12288
    ds_read_b64_tr_b16 v[102:103], v12 offset:13312
    s_waitcnt lgkmcnt(6)
    v_mfma_f32_32x32x16_bf16 v[64:79], v[108:111], v[104:107], v[64:79]
    ds_read_b128 v[104:107], v8 offset:39936
    ds_read_b64_tr_b16 v[108:109], v12 offset:14336
    ds_read_b64_tr_b16 v[110:111], v12 offset:15360
    s_waitcnt lgkmcnt(6)
    v_mfma_f32_32x32x16_bf16 v[80:95], v[116:119], v[112:115], v[80:95]
    s_waitcnt lgkmcnt(0)
    s_barrier
    ds_read_b128 v[112:115], v8 offset:49152
    ds_read_b64_tr_b16 v[116:117], v12 offset:16384
    ds_read_b64_tr_b16 v[118:119], v12 offset:17408
    v_mfma_f32_32x32x16_bf16 v[64:79], v[100:103], v[96:99], v[64:79]
    ds_read_b128 v[96:99], v8 offset:50176
    ds_read_b64_tr_b16 v[100:101], v12 offset:18432
    ds_read_b64_tr_b16 v[102:103], v12 offset:19456
    s_waitcnt lgkmcnt(6)
    v_mfma_f32_32x32x16_bf16 v[80:95], v[108:111], v[104:107], v[80:95]
    ds_read_b128 v[104:107], v8 offset:51200
    ds_read_b64_tr_b16 v[108:109], v12 offset:20480
    ds_read_b64_tr_b16 v[110:111], v12 offset:21504
    s_waitcnt lgkmcnt(6)
    v_mfma_f32_32x32x16_bf16 v[64:79], v[116:119], v[112:115], v[64:79]
    ds_read_b128 v[112:115], v8 offset:52224
    ds_read_b64_tr_b16 v[116:117], v12 offset:22528
    ds_read_b64_tr_b16 v[118:119], v12 offset:23552
    s_waitcnt lgkmcnt(6)
    v_mfma_f32_32x32x16_bf16 v[80:95], v[100:103], v[96:99], v[80:95]
    ds_read_b128 v[96:99], v8 offset:53248
    ds_read_b64_tr_b16 v[100:101], v12 offset:24576
    ds_read_b64_tr_b16 v[102:103], v12 offset:25600
    s_waitcnt lgkmcnt(6)
    v_mfma_f32_32x32x16_bf16 v[64:79], v[108:111], v[104:107], v[64:79]
    ds_read_b128 v[104:107], v8 offset:54272
    ds_read_b64_tr_b16 v[108:109], v12 offset:26624
    ds_read_b64_tr_b16 v[110:111], v12 offset:27648
    s_waitcnt lgkmcnt(6)
    v_mfma_f32_32x32x16_bf16 v[80:95], v[116:119], v[112:115], v[80:95]
    ds_read_b128 v[112:115], v8 offset:55296
    ds_read_b64_tr_b16 v[116:117], v12 offset:28672
    ds_read_b64_tr_b16 v[118:119], v12 offset:29696
    s_waitcnt lgkmcnt(6)
    v_mfma_f32_32x32x16_bf16 v[64:79], v[100:103], v[96:99], v[64:79]
    ds_read_b128 v[96:99], v8 offset:56320
    ds_read_b64_tr_b16 v[100:101], v12 offset:30720
    ds_read_b64_tr_b16 v[102:103], v12 offset:31744
    s_waitcnt lgkmcnt(6)
    v_mfma_f32_32x32x16_bf16 v[80:95], v[108:111], v[104:107], v[80:95]
    s_waitcnt lgkmcnt(0)
    s_barrier
    ds_read_b128 v[104:107], v9 offset:32768
    ds_read_b64_tr_b16 v[108:109], v13 offset:0
    ds_read_b64_tr_b16 v[110:111], v13 offset:1024
    v_mfma_f32_32x32x16_bf16 v[64:79], v[116:119], v[112:115], v[64:79]
    ds_read_b128 v[112:115], v9 offset:33792
    ds_read_b64_tr_b16 v[116:117], v13 offset:2048
    ds_read_b64_tr_b16 v[118:119], v13 offset:3072
    s_waitcnt lgkmcnt(6)
    v_mfma_f32_32x32x16_bf16 v[80:95], v[100:103], v[96:99], v[80:95]
    ds_read_b128 v[96:99], v9 offset:34816
    ds_read_b64_tr_b16 v[100:101], v13 offset:4096
    ds_read_b64_tr_b16 v[102:103], v13 offset:5120
    s_waitcnt lgkmcnt(6)
    v_mfma_f32_32x32x16_bf16 v[64:79], v[108:111], v[104:107], v[64:79]
    ds_read_b128 v[104:107], v9 offset:35840
    ds_read_b64_tr_b16 v[108:109], v13 offset:6144
    ds_read_b64_tr_b16 v[110:111], v13 offset:7168
    s_waitcnt lgkmcnt(6)
    v_mfma_f32_32x32x16_bf16 v[80:95], v[116:119], v[112:115], v[80:95]
    ds_read_b128 v[112:115], v9 offset:36864
    ds_read_b64_tr_b16 v[116:117], v13 offset:8192
    ds_read_b64_tr_b16 v[118:119], v13 offset:9216
    s_waitcnt lgkmcnt(6)
    v_mfma_f32_32x32x16_bf16 v[64:79], v[100:103], v[96:99], v[64:79]
    ds_read_b128 v[96:99], v9 offset:37888
    ds_read_b64_tr_b16 v[100:101], v13 offset:10240
    ds_read_b64_tr_b16 v[102:103], v13 offset:11264
    s_waitcnt lgkmcnt(6)
    v_mfma_f32_32x32x16_bf16 v[80:95], v[108:111], v[104:107], v[80:95]
    ds_read_b128 v[104:107], v9 offset:38912
    ds_read_b64_tr_b16 v[108:109], v13 offset:12288
    ds_read_b64_tr_b16 v[110:111], v13 offset:13312
    s_waitcnt lgkmcnt(6)
    v_mfma_f32_32x32x16_bf16 v[64:79], v[116:119], v[112:115], v[64:79]
    ds_read_b128 v[112:115], v9 offset:39936
    ds_read_b64_tr_b16 v[116:117], v13 offset:14336
    ds_read_b64_tr_b16 v[118:119], v13 offset:15360
    s_waitcnt lgkmcnt(6)
    v_mfma_f32_32x32x16_bf16 v[80:95], v[100:103], v[96:99], v[80:95]
    s_waitcnt lgkmcnt(0)
    s_barrier
    ds_read_b128 v[96:99], v9 offset:49152
    ds_read_b64_tr_b16 v[100:101], v13 offset:16384
    ds_read_b64_tr_b16 v[102:103], v13 offset:17408
    v_mfma_f32_32x32x16_bf16 v[64:79], v[108:111], v[104:107], v[64:79]
    ds_read_b128 v[104:107], v9 offset:50176
    ds_read_b64_tr_b16 v[108:109], v13 offset:18432
    ds_read_b64_tr_b16 v[110:111], v13 offset:19456
    s_waitcnt lgkmcnt(6)
    v_mfma_f32_32x32x16_bf16 v[80:95], v[116:119], v[112:115], v[80:95]
    ds_read_b128 v[112:115], v9 offset:51200
    ds_read_b64_tr_b16 v[116:117], v13 offset:20480
    ds_read_b64_tr_b16 v[118:119], v13 offset:21504
    s_waitcnt lgkmcnt(6)
    v_mfma_f32_32x32x16_bf16 v[64:79], v[100:103], v[96:99], v[64:79]
    ds_read_b128 v[96:99], v9 offset:52224
    ds_read_b64_tr_b16 v[100:101], v13 offset:22528
    ds_read_b64_tr_b16 v[102:103], v13 offset:23552
    s_waitcnt lgkmcnt(6)
    v_mfma_f32_32x32x16_bf16 v[80:95], v[108:111], v[104:107], v[80:95]
    ds_read_b128 v[104:107], v9 offset:53248
    ds_read_b64_tr_b16 v[108:109], v13 offset:24576
    ds_read_b64_tr_b16 v[110:111], v13 offset:25600
    s_waitcnt lgkmcnt(6)
    v_mfma_f32_32x32x16_bf16 v[64:79], v[116:119], v[112:115], v[64:79]
    ds_read_b128 v[112:115], v9 offset:54272
    ds_read_b64_tr_b16 v[116:117], v13 offset:26624
    ds_read_b64_tr_b16 v[118:119], v13 offset:27648
    s_waitcnt lgkmcnt(6)
    v_mfma_f32_32x32x16_bf16 v[80:95], v[100:103], v[96:99], v[80:95]
    ds_read_b128 v[96:99], v9 offset:55296
    ds_read_b64_tr_b16 v[100:101], v13 offset:28672
    ds_read_b64_tr_b16 v[102:103], v13 offset:29696
    s_waitcnt lgkmcnt(6)
    v_mfma_f32_32x32x16_bf16 v[64:79], v[108:111], v[104:107], v[64:79]
    ds_read_b128 v[104:107], v9 offset:56320
    ds_read_b64_tr_b16 v[108:109], v13 offset:30720
    ds_read_b64_tr_b16 v[110:111], v13 offset:31744
    s_waitcnt lgkmcnt(6)
    v_mfma_f32_32x32x16_bf16 v[80:95], v[116:119], v[112:115], v[80:95]
    s_waitcnt lgkmcnt(3)
    v_mfma_f32_32x32x16_bf16 v[64:79], v[100:103], v[96:99], v[64:79]
    s_waitcnt lgkmcnt(0)
    v_mfma_f32_32x32x16_bf16 v[80:95], v[108:111], v[104:107], v[80:95]
    s_add_u32 s20, s82, s6
    s_addc_u32 s21, s83, 0
    s_mov_b32 s22, 2097152
    s_mov_b32 s23, 0x20000
    s_add_u32 s24, s82, s6
    s_addc_u32 s25, s83, 0
    s_add_u32 s24, s24, 20971520
    s_addc_u32 s25, s25, 0
    s_mov_b32 s26, 262144
    s_mov_b32 s27, 0x20000
    s_nop 1
    v_add_f32 v64, v64, v80
    v_add_f32 v65, v65, v81
    v_add_f32 v66, v66, v82
    v_add_f32 v67, v67, v83
    v_add_f32 v68, v68, v84
    v_add_f32 v69, v69, v85
    v_add_f32 v70, v70, v86
    v_add_f32 v71, v71, v87
    v_add_f32 v72, v72, v88
    v_add_f32 v73, v73, v89
    v_add_f32 v74, v74, v90
    v_add_f32 v75, v75, v91
    v_add_f32 v76, v76, v92
    v_add_f32 v77, v77, v93
    v_add_f32 v78, v78, v94
    v_add_f32 v79, v79, v95
    v_cvt_pk_bf16_f32 v48, v64, v65
    v_cvt_pk_bf16_f32 v49, v66, v67
    v_cvt_pk_bf16_f32 v50, v68, v69
    v_cvt_pk_bf16_f32 v51, v70, v71
    v_cvt_pk_bf16_f32 v52, v72, v73
    v_cvt_pk_bf16_f32 v53, v74, v75
    v_cvt_pk_bf16_f32 v54, v76, v77
    v_cvt_pk_bf16_f32 v55, v78, v79
    v_permlane32_swap_b32 v48, v50
    v_permlane32_swap_b32 v49, v51
    v_permlane32_swap_b32 v52, v54
    v_permlane32_swap_b32 v53, v55
    v_lshlrev_b32 v6, 4, v1
    buffer_store_dwordx4 v[48:51], v6, s[20:23], s41 offen offset:0 sc1
    buffer_store_dwordx4 v[52:55], v6, s[20:23], s41 offen offset:2048 sc1
    v_pk_add_f32 v[96:97], v[64:65], v[66:67]
    v_pk_mul_f32 v[98:99], v[64:65], v[64:65]
    v_pk_fma_f32 v[98:99], v[66:67], v[66:67], v[98:99]
    v_pk_add_f32 v[96:97], v[96:97], v[68:69]
    v_pk_fma_f32 v[98:99], v[68:69], v[68:69], v[98:99]
    v_pk_add_f32 v[96:97], v[96:97], v[70:71]
    v_pk_fma_f32 v[98:99], v[70:71], v[70:71], v[98:99]
    v_pk_add_f32 v[96:97], v[96:97], v[72:73]
    v_pk_fma_f32 v[98:99], v[72:73], v[72:73], v[98:99]
    v_pk_add_f32 v[96:97], v[96:97], v[74:75]
    v_pk_fma_f32 v[98:99], v[74:75], v[74:75], v[98:99]
    v_pk_add_f32 v[96:97], v[96:97], v[76:77]
    v_pk_fma_f32 v[98:99], v[76:77], v[76:77], v[98:99]
    v_pk_add_f32 v[96:97], v[96:97], v[78:79]
    v_pk_fma_f32 v[98:99], v[78:79], v[78:79], v[98:99]
    v_add_f32 v100, v96, v97
    v_add_f32 v101, v98, v99
    v_mov_b32 v102, v100
    v_mov_b32 v103, v101
    s_nop 0
    v_permlane32_swap_b32 v100, v102
    v_permlane32_swap_b32 v101, v103
    v_add_f32 v100, v100, v102
    v_add_f32 v101, v101, v103
    s_lshl_b32 s36, s88, 1
    s_add_u32 s36, s36, s33
    s_lshl_b32 s36, s36, 12
    s_lshl_b32 s37, s89, 1
    s_add_u32 s37, s37, s34
    s_lshl_b32 s37, s37, 8
    s_add_u32 s36, s36, s37
    v_lshlrev_b32 v6, 3, v5
    s_mov_b64 exec, 0xffffffff
    buffer_store_dwordx2 v[100:101], v6, s[24:27], s36 offen sc1
    s_mov_b64 exec, -1
    s_waitcnt vmcnt(0)
    s_barrier
    s_cmp_lg_u32 s3, 0
    s_cbranch_scc1 W0S11
    s_lshl_b32 s31, s88, 3
    s_add_u32 s31, s31, s89
    s_add_u32 s29, s5, 0
    s_mul_i32 s29, s29, 163840
    s_add_u32 s29, s29, 67174400
    s_lshl_b32 s28, s31, 7
    s_add_u32 s29, s29, s28
    v_mov_b32 v6, s29
    v_mov_b32 v7, s4
    s_mov_b64 exec, 1
    global_store_dword v6, v7, s[82:83] sc1
    s_mov_b64 exec, -1
W0S11:
    s_cmp_lt_u32 s2, 224
    s_cbranch_scc1 C_P4
    s_mov_b32 s56, s76
    s_mov_b32 s57, s77
    s_mov_b32 s58, 1835008
    s_mov_b32 s59, 0x20000
    s_lshr_b32 s46, s2, 3
    s_mul_i32 s46, s46, 57344
    s_mul_i32 s47, s3, 14336
    s_add_u32 s46, s46, s47
    v_lshlrev_b32 v244, 7, v1
    buffer_load_dword v245, v244, s[56:59], s46 offen
    s_add_u32 s46, s46, 8192
    s_mov_b32 exec_hi, 0xffff
    buffer_load_dword v246, v244, s[56:59], s46 offen
    s_mov_b64 exec, -1
    s_branch C_P5
C_P4:
    v_lshrrev_b32 v2, 4, v1
    v_and_b32 v3, 15, v1
    v_lshrrev_b32 v3, 2, v3
    v_lshrrev_b32 v4, 5, v1
    v_and_b32 v5, 31, v1
    s_and_b32 s33, s3, 1
    s_lshr_b32 s34, s3, 1
    v_lshlrev_b32 v6, 4, v1
    s_lshl_b32 s35, s33, 13
    v_add_u32 v6, s35, v6
    v_add_u32 v8, 0, v6
    v_add_u32 v9, 2048, v6
    v_add_u32 v10, 4096, v6
    v_add_u32 v11, 6144, v6
    v_add_u32 v12, 49152, v6
    v_add_u32 v13, 51200, v6
    v_add_u32 v14, 53248, v6
    v_add_u32 v15, 55296, v6
    v_add_u32 v16, 98304, v6
    v_add_u32 v17, 100352, v6
    v_add_u32 v18, 102400, v6
    v_add_u32 v19, 104448, v6
    v_lshlrev_b32 v6, 3, v4
    v_add_u32 v6, v6, v3
    v_lshlrev_b32 v6, 7, v6
    v_and_b32 v7, 3, v1
    v_lshlrev_b32 v7, 3, v7
    v_add_u32 v6, v6, v7
    v_lshrrev_b32 v7, 1, v3
    v_lshlrev_b32 v7, 6, v7
    v_and_b32 v48, 1, v2
    v_add_u32 v6, v6, v7
    v_lshlrev_b32 v7, 5, v48
    v_add_u32 v6, v6, v7
    v_lshlrev_b32 v7, 14, v48
    v_add_u32 v6, v6, v7
    s_lshl_b32 s35, s34, 13
    s_add_u32 s35, s35, 16384
    v_add_u32 v6, s35, v6
    v_xor_b32 v20, 0, v6
    v_xor_b32 v21, 32, v6
    v_xor_b32 v22, 64, v6
    v_xor_b32 v23, 96, v6
    v_xor_b32 v24, 0, v6
    v_add_u32 v24, 49152, v24
    v_xor_b32 v25, 32, v6
    v_add_u32 v25, 49152, v25
    v_xor_b32 v26, 64, v6
    v_add_u32 v26, 49152, v26
    v_xor_b32 v27, 96, v6
    v_add_u32 v27, 49152, v27
    v_xor_b32 v28, 0, v6
    v_add_u32 v28, 98304, v28
    v_xor_b32 v29, 32, v6
    v_add_u32 v29, 98304, v29
    v_xor_b32 v30, 64, v6
    v_add_u32 v30, 98304, v30
    v_xor_b32 v31, 96, v6
    v_add_u32 v31, 98304, v31
    v_mov_b32 v64, 0
    v_mov_b32 v65, 0
    v_mov_b32 v66, 0
    v_mov_b32 v67, 0
    v_mov_b32 v68, 0
    v_mov_b32 v69, 0
    v_mov_b32 v70, 0
    v_mov_b32 v71, 0
    v_mov_b32 v72, 0
    v_mov_b32 v73, 0
    v_mov_b32 v74, 0
    v_mov_b32 v75, 0
    v_mov_b32 v76, 0
    v_mov_b32 v77, 0
    v_mov_b32 v78, 0
    v_mov_b32 v79, 0
    v_mov_b32 v80, 0
    v_mov_b32 v81, 0
    v_mov_b32 v82, 0
    v_mov_b32 v83, 0
    v_mov_b32 v84, 0
    v_mov_b32 v85, 0
    v_mov_b32 v86, 0
    v_mov_b32 v87, 0
    v_mov_b32 v88, 0
    v_mov_b32 v89, 0
    v_mov_b32 v90, 0
    v_mov_b32 v91, 0
    v_mov_b32 v92, 0
    v_mov_b32 v93, 0
    v_mov_b32 v94, 0
    v_mov_b32 v95, 0
    v_mov_b32 v96, 0
    v_mov_b32 v97, 0
    v_mov_b32 v98, 0
    v_mov_b32 v99, 0
    v_mov_b32 v100, 0
    v_mov_b32 v101, 0
    v_mov_b32 v102, 0
    v_mov_b32 v103, 0
    v_mov_b32 v104, 0
    v_mov_b32 v105, 0
    v_mov_b32 v106, 0
    v_mov_b32 v107, 0
    v_mov_b32 v108, 0
    v_mov_b32 v109, 0
    v_mov_b32 v110, 0
    v_mov_b32 v111, 0
    v_mov_b32 v112, 0
    v_mov_b32 v113, 0
    v_mov_b32 v114, 0
    v_mov_b32 v115, 0
    v_mov_b32 v116, 0
    v_mov_b32 v117, 0
    v_mov_b32 v118, 0
    v_mov_b32 v119, 0
    v_mov_b32 v120, 0
    v_mov_b32 v121, 0
    v_mov_b32 v122, 0
    v_mov_b32 v123, 0
    v_mov_b32 v124, 0
    v_mov_b32 v125, 0
    v_mov_b32 v126, 0
    v_mov_b32 v127, 0
    v_mov_b32 v128, 0
    v_mov_b32 v129, 0
    v_mov_b32 v130, 0
    v_mov_b32 v131, 0
    v_mov_b32 v132, 0
    v_mov_b32 v133, 0
    v_mov_b32 v134, 0
    v_mov_b32 v135, 0
    v_mov_b32 v136, 0
    v_mov_b32 v137, 0
    v_mov_b32 v138, 0
    v_mov_b32 v139, 0
    v_mov_b32 v140, 0
    v_mov_b32 v141, 0
    v_mov_b32 v142, 0
    v_mov_b32 v143, 0
    v_mov_b32 v144, 0
    v_mov_b32 v145, 0
    v_mov_b32 v146, 0
    v_mov_b32 v147, 0
    v_mov_b32 v148, 0
    v_mov_b32 v149, 0
    v_mov_b32 v150, 0
    v_mov_b32 v151, 0
    v_mov_b32 v152, 0
    v_mov_b32 v153, 0
    v_mov_b32 v154, 0
    v_mov_b32 v155, 0
    v_mov_b32 v156, 0
    v_mov_b32 v157, 0
    v_mov_b32 v158, 0
    v_mov_b32 v159, 0
    v_mov_b32 v160, 0
    v_mov_b32 v161, 0
    v_mov_b32 v162, 0
    v_mov_b32 v163, 0
    v_mov_b32 v164, 0
    v_mov_b32 v165, 0
    v_mov_b32 v166, 0
    v_mov_b32 v167, 0
    v_mov_b32 v168, 0
    v_mov_b32 v169, 0
    v_mov_b32 v170, 0
    v_mov_b32 v171, 0
    v_mov_b32 v172, 0
    v_mov_b32 v173, 0
    v_mov_b32 v174, 0
    v_mov_b32 v175, 0
    v_mov_b32 v176, 0
    v_mov_b32 v177, 0
    v_mov_b32 v178, 0
    v_mov_b32 v179, 0
    v_mov_b32 v180, 0
    v_mov_b32 v181, 0
    v_mov_b32 v182, 0
    v_mov_b32 v183, 0
    v_mov_b32 v184, 0
    v_mov_b32 v185, 0
    v_mov_b32 v186, 0
    v_mov_b32 v187, 0
    v_mov_b32 v188, 0
    v_mov_b32 v189, 0
    v_mov_b32 v190, 0
    v_mov_b32 v191, 0
    s_cmp_lg_u32 s3, 0
    s_cbranch_scc1 W0S12
    s_lshl_b32 s31, s90, 4
    s_add_u32 s29, s5, 0
    s_mul_i32 s29, s29, 163840
    s_add_u32 s29, s29, 67174400
    s_lshl_b32 s28, s31, 7
    s_add_u32 s29, s29, s28
    v_min_u32 v6, 15, v1
    v_lshlrev_b32 v6, 7, v6
    v_add_u32 v6, s29, v6
    s_mov_b32 s30, 20000
POLL13:
    global_load_dword v7, v6, s[82:83] sc1
    s_waitcnt vmcnt(0)
    v_cmp_ne_u32 vcc, s4, v7
    s_nop 4
    s_cbranch_vccz POLL13D
    s_sub_u32 s30, s30, 1
    s_cmp_lg_u32 s30, 0
    s_cbranch_scc1 POLL13
POLL13D:
W0S12:
    s_barrier
    s_barrier
    ds_read_b128 v[192:195], v8 offset:0
    ds_read_b128 v[196:199], v8 offset:1024
    ds_read_b64_tr_b16 v[200:201], v20 offset:0
    ds_read_b64_tr_b16 v[202:203], v20 offset:512
    ds_read_b64_tr_b16 v[204:205], v21 offset:0
    ds_read_b64_tr_b16 v[206:207], v21 offset:512
    ds_read_b64_tr_b16 v[208:209], v22 offset:0
    ds_read_b64_tr_b16 v[210:211], v22 offset:512
    ds_read_b64_tr_b16 v[212:213], v23 offset:0
    ds_read_b64_tr_b16 v[214:215], v23 offset:512
    s_waitcnt lgkmcnt(0)
    v_mfma_f32_32x32x16_bf16 v[64:79], v[200:203], v[192:195], v[64:79]
    ds_read_b128 v[216:219], v9 offset:0
    ds_read_b128 v[220:223], v9 offset:1024
    v_mfma_f32_32x32x16_bf16 v[128:143], v[200:203], v[196:199], v[128:143]
    ds_read_b64_tr_b16 v[224:225], v20 offset:2048
    ds_read_b64_tr_b16 v[226:227], v20 offset:2560
    v_mfma_f32_32x32x16_bf16 v[80:95], v[204:207], v[192:195], v[80:95]
    ds_read_b64_tr_b16 v[228:229], v21 offset:2048
    ds_read_b64_tr_b16 v[230:231], v21 offset:2560
    v_mfma_f32_32x32x16_bf16 v[144:159], v[204:207], v[196:199], v[144:159]
    ds_read_b64_tr_b16 v[232:233], v22 offset:2048
    ds_read_b64_tr_b16 v[234:235], v22 offset:2560
    v_mfma_f32_32x32x16_bf16 v[96:111], v[208:211], v[192:195], v[96:111]
    ds_read_b64_tr_b16 v[236:237], v23 offset:2048
    ds_read_b64_tr_b16 v[238:239], v23 offset:2560
    v_mfma_f32_32x32x16_bf16 v[160:175], v[208:211], v[196:199], v[160:175]
    v_mfma_f32_32x32x16_bf16 v[112:127], v[212:215], v[192:195], v[112:127]
    v_mfma_f32_32x32x16_bf16 v[176:191], v[212:215], v[196:199], v[176:191]
    s_waitcnt lgkmcnt(0)
    v_mfma_f32_32x32x16_bf16 v[64:79], v[224:227], v[216:219], v[64:79]
    ds_read_b128 v[192:195], v10 offset:0
    ds_read_b128 v[196:199], v10 offset:1024
    v_mfma_f32_32x32x16_bf16 v[128:143], v[224:227], v[220:223], v[128:143]
    ds_read_b64_tr_b16 v[200:201], v20 offset:4096
    ds_read_b64_tr_b16 v[202:203], v20 offset:4608
    v_mfma_f32_32x32x16_bf16 v[80:95], v[228:231], v[216:219], v[80:95]
    ds_read_b64_tr_b16 v[204:205], v21 offset:4096
    ds_read_b64_tr_b16 v[206:207], v21 offset:4608
    v_mfma_f32_32x32x16_bf16 v[144:159], v[228:231], v[220:223], v[144:159]
    ds_read_b64_tr_b16 v[208:209], v22 offset:4096
    ds_read_b64_tr_b16 v[210:211], v22 offset:4608
    v_mfma_f32_32x32x16_bf16 v[96:111], v[232:235], v[216:219], v[96:111]
    ds_read_b64_tr_b16 v[212:213], v23 offset:4096
    ds_read_b64_tr_b16 v[214:215], v23 offset:4608
    v_mfma_f32_32x32x16_bf16 v[160:175], v[232:235], v[220:223], v[160:175]
    v_mfma_f32_32x32x16_bf16 v[112:127], v[236:239], v[216:219], v[112:127]
    v_mfma_f32_32x32x16_bf16 v[176:191], v[236:239], v[220:223], v[176:191]
    s_waitcnt lgkmcnt(0)
    v_mfma_f32_32x32x16_bf16 v[64:79], v[200:203], v[192:195], v[64:79]
    ds_read_b128 v[216:219], v11 offset:0
    ds_read_b128 v[220:223], v11 offset:1024
    v_mfma_f32_32x32x16_bf16 v[128:143], v[200:203], v[196:199], v[128:143]
    ds_read_b64_tr_b16 v[224:225], v20 offset:6144
    ds_read_b64_tr_b16 v[226:227], v20 offset:6656
    v_mfma_f32_32x32x16_bf16 v[80:95], v[204:207], v[192:195], v[80:95]
    ds_read_b64_tr_b16 v[228:229], v21 offset:6144
    ds_read_b64_tr_b16 v[230:231], v21 offset:6656
    v_mfma_f32_32x32x16_bf16 v[144:159], v[204:207], v[196:199], v[144:159]
    ds_read_b64_tr_b16 v[232:233], v22 offset:6144
    ds_read_b64_tr_b16 v[234:235], v22 offset:6656
    v_mfma_f32_32x32x16_bf16 v[96:111], v[208:211], v[192:195], v[96:111]
    ds_read_b64_tr_b16 v[236:237], v23 offset:6144
    ds_read_b64_tr_b16 v[238:239], v23 offset:6656
    v_mfma_f32_32x32x16_bf16 v[160:175], v[208:211], v[196:199], v[160:175]
    v_mfma_f32_32x32x16_bf16 v[112:127], v[212:215], v[192:195], v[112:127]
    v_mfma_f32_32x32x16_bf16 v[176:191], v[212:215], v[196:199], v[176:191]
    s_waitcnt lgkmcnt(0)
    s_barrier
    v_mfma_f32_32x32x16_bf16 v[64:79], v[224:227], v[216:219], v[64:79]
    ds_read_b128 v[192:195], v12 offset:0
    ds_read_b128 v[196:199], v12 offset:1024
    v_mfma_f32_32x32x16_bf16 v[128:143], v[224:227], v[220:223], v[128:143]
    ds_read_b64_tr_b16 v[200:201], v24 offset:0
    ds_read_b64_tr_b16 v[202:203], v24 offset:512
    v_mfma_f32_32x32x16_bf16 v[80:95], v[228:231], v[216:219], v[80:95]
    ds_read_b64_tr_b16 v[204:205], v25 offset:0
    ds_read_b64_tr_b16 v[206:207], v25 offset:512
    v_mfma_f32_32x32x16_bf16 v[144:159], v[228:231], v[220:223], v[144:159]
    ds_read_b64_tr_b16 v[208:209], v26 offset:0
    ds_read_b64_tr_b16 v[210:211], v26 offset:512
    v_mfma_f32_32x32x16_bf16 v[96:111], v[232:235], v[216:219], v[96:111]
    ds_read_b64_tr_b16 v[212:213], v27 offset:0
    ds_read_b64_tr_b16 v[214:215], v27 offset:512
    v_mfma_f32_32x32x16_bf16 v[160:175], v[232:235], v[220:223], v[160:175]
    v_mfma_f32_32x32x16_bf16 v[112:127], v[236:239], v[216:219], v[112:127]
    v_mfma_f32_32x32x16_bf16 v[176:191], v[236:239], v[220:223], v[176:191]
    s_waitcnt lgkmcnt(0)
    v_mfma_f32_32x32x16_bf16 v[64:79], v[200:203], v[192:195], v[64:79]
    ds_read_b128 v[216:219], v13 offset:0
    ds_read_b128 v[220:223], v13 offset:1024
    v_mfma_f32_32x32x16_bf16 v[128:143], v[200:203], v[196:199], v[128:143]
    ds_read_b64_tr_b16 v[224:225], v24 offset:2048
    ds_read_b64_tr_b16 v[226:227], v24 offset:2560
    v_mfma_f32_32x32x16_bf16 v[80:95], v[204:207], v[192:195], v[80:95]
    ds_read_b64_tr_b16 v[228:229], v25 offset:2048
    ds_read_b64_tr_b16 v[230:231], v25 offset:2560
    v_mfma_f32_32x32x16_bf16 v[144:159], v[204:207], v[196:199], v[144:159]
    ds_read_b64_tr_b16 v[232:233], v26 offset:2048
    ds_read_b64_tr_b16 v[234:235], v26 offset:2560
    v_mfma_f32_32x32x16_bf16 v[96:111], v[208:211], v[192:195], v[96:111]
    ds_read_b64_tr_b16 v[236:237], v27 offset:2048
    ds_read_b64_tr_b16 v[238:239], v27 offset:2560
    v_mfma_f32_32x32x16_bf16 v[160:175], v[208:211], v[196:199], v[160:175]
    v_mfma_f32_32x32x16_bf16 v[112:127], v[212:215], v[192:195], v[112:127]
    v_mfma_f32_32x32x16_bf16 v[176:191], v[212:215], v[196:199], v[176:191]
    s_waitcnt lgkmcnt(0)
    v_mfma_f32_32x32x16_bf16 v[64:79], v[224:227], v[216:219], v[64:79]
    ds_read_b128 v[192:195], v14 offset:0
    ds_read_b128 v[196:199], v14 offset:1024
    v_mfma_f32_32x32x16_bf16 v[128:143], v[224:227], v[220:223], v[128:143]
    ds_read_b64_tr_b16 v[200:201], v24 offset:4096
    ds_read_b64_tr_b16 v[202:203], v24 offset:4608
    v_mfma_f32_32x32x16_bf16 v[80:95], v[228:231], v[216:219], v[80:95]
    ds_read_b64_tr_b16 v[204:205], v25 offset:4096
    ds_read_b64_tr_b16 v[206:207], v25 offset:4608
    v_mfma_f32_32x32x16_bf16 v[144:159], v[228:231], v[220:223], v[144:159]
    ds_read_b64_tr_b16 v[208:209], v26 offset:4096
    ds_read_b64_tr_b16 v[210:211], v26 offset:4608
    v_mfma_f32_32x32x16_bf16 v[96:111], v[232:235], v[216:219], v[96:111]
    ds_read_b64_tr_b16 v[212:213], v27 offset:4096
    ds_read_b64_tr_b16 v[214:215], v27 offset:4608
    v_mfma_f32_32x32x16_bf16 v[160:175], v[232:235], v[220:223], v[160:175]
    v_mfma_f32_32x32x16_bf16 v[112:127], v[236:239], v[216:219], v[112:127]
    v_mfma_f32_32x32x16_bf16 v[176:191], v[236:239], v[220:223], v[176:191]
    s_waitcnt lgkmcnt(0)
    v_mfma_f32_32x32x16_bf16 v[64:79], v[200:203], v[192:195], v[64:79]
    ds_read_b128 v[216:219], v15 offset:0
    ds_read_b128 v[220:223], v15 offset:1024
    v_mfma_f32_32x32x16_bf16 v[128:143], v[200:203], v[196:199], v[128:143]
    ds_read_b64_tr_b16 v[224:225], v24 offset:6144
    ds_read_b64_tr_b16 v[226:227], v24 offset:6656
    v_mfma_f32_32x32x16_bf16 v[80:95], v[204:207], v[192:195], v[80:95]
    ds_read_b64_tr_b16 v[228:229], v25 offset:6144
    ds_read_b64_tr_b16 v[230:231], v25 offset:6656
    v_mfma_f32_32x32x16_bf16 v[144:159], v[204:207], v[196:199], v[144:159]
    ds_read_b64_tr_b16 v[232:233], v26 offset:6144
    ds_read_b64_tr_b16 v[234:235], v26 offset:6656
    v_mfma_f32_32x32x16_bf16 v[96:111], v[208:211], v[192:195], v[96:111]
    ds_read_b64_tr_b16 v[236:237], v27 offset:6144
    ds_read_b64_tr_b16 v[238:239], v27 offset:6656
    v_mfma_f32_32x32x16_bf16 v[160:175], v[208:211], v[196:199], v[160:175]
    v_mfma_f32_32x32x16_bf16 v[112:127], v[212:215], v[192:195], v[112:127]
    v_mfma_f32_32x32x16_bf16 v[176:191], v[212:215], v[196:199], v[176:191]
    s_waitcnt lgkmcnt(0)
    s_barrier
    v_mfma_f32_32x32x16_bf16 v[64:79], v[224:227], v[216:219], v[64:79]
    ds_read_b128 v[192:195], v16 offset:0
    ds_read_b128 v[196:199], v16 offset:1024
    v_mfma_f32_32x32x16_bf16 v[128:143], v[224:227], v[220:223], v[128:143]
    ds_read_b64_tr_b16 v[200:201], v28 offset:0
    ds_read_b64_tr_b16 v[202:203], v28 offset:512
    v_mfma_f32_32x32x16_bf16 v[80:95], v[228:231], v[216:219], v[80:95]
    ds_read_b64_tr_b16 v[204:205], v29 offset:0
    ds_read_b64_tr_b16 v[206:207], v29 offset:512
    v_mfma_f32_32x32x16_bf16 v[144:159], v[228:231], v[220:223], v[144:159]
    ds_read_b64_tr_b16 v[208:209], v30 offset:0
    ds_read_b64_tr_b16 v[210:211], v30 offset:512
    v_mfma_f32_32x32x16_bf16 v[96:111], v[232:235], v[216:219], v[96:111]
    ds_read_b64_tr_b16 v[212:213], v31 offset:0
    ds_read_b64_tr_b16 v[214:215], v31 offset:512
    v_mfma_f32_32x32x16_bf16 v[160:175], v[232:235], v[220:223], v[160:175]
    v_mfma_f32_32x32x16_bf16 v[112:127], v[236:239], v[216:219], v[112:127]
    v_mfma_f32_32x32x16_bf16 v[176:191], v[236:239], v[220:223], v[176:191]
    s_waitcnt lgkmcnt(0)
    v_mfma_f32_32x32x16_bf16 v[64:79], v[200:203], v[192:195], v[64:79]
    ds_read_b128 v[216:219], v17 offset:0
    ds_read_b128 v[220:223], v17 offset:1024
    v_mfma_f32_32x32x16_bf16 v[128:143], v[200:203], v[196:199], v[128:143]
    ds_read_b64_tr_b16 v[224:225], v28 offset:2048
    ds_read_b64_tr_b16 v[226:227], v28 offset:2560
    v_mfma_f32_32x32x16_bf16 v[80:95], v[204:207], v[192:195], v[80:95]
    ds_read_b64_tr_b16 v[228:229], v29 offset:2048
    ds_read_b64_tr_b16 v[230:231], v29 offset:2560
    v_mfma_f32_32x32x16_bf16 v[144:159], v[204:207], v[196:199], v[144:159]
    ds_read_b64_tr_b16 v[232:233], v30 offset:2048
    ds_read_b64_tr_b16 v[234:235], v30 offset:2560
    v_mfma_f32_32x32x16_bf16 v[96:111], v[208:211], v[192:195], v[96:111]
    ds_read_b64_tr_b16 v[236:237], v31 offset:2048
    ds_read_b64_tr_b16 v[238:239], v31 offset:2560
    v_mfma_f32_32x32x16_bf16 v[160:175], v[208:211], v[196:199], v[160:175]
    v_mfma_f32_32x32x16_bf16 v[112:127], v[212:215], v[192:195], v[112:127]
    v_mfma_f32_32x32x16_bf16 v[176:191], v[212:215], v[196:199], v[176:191]
    s_waitcnt lgkmcnt(0)
    v_mfma_f32_32x32x16_bf16 v[64:79], v[224:227], v[216:219], v[64:79]
    ds_read_b128 v[192:195], v18 offset:0
    ds_read_b128 v[196:199], v18 offset:1024
    v_mfma_f32_32x32x16_bf16 v[128:143], v[224:227], v[220:223], v[128:143]
    ds_read_b64_tr_b16 v[200:201], v28 offset:4096
    ds_read_b64_tr_b16 v[202:203], v28 offset:4608
    v_mfma_f32_32x32x16_bf16 v[80:95], v[228:231], v[216:219], v[80:95]
    ds_read_b64_tr_b16 v[204:205], v29 offset:4096
    ds_read_b64_tr_b16 v[206:207], v29 offset:4608
    v_mfma_f32_32x32x16_bf16 v[144:159], v[228:231], v[220:223], v[144:159]
    ds_read_b64_tr_b16 v[208:209], v30 offset:4096
    ds_read_b64_tr_b16 v[210:211], v30 offset:4608
    v_mfma_f32_32x32x16_bf16 v[96:111], v[232:235], v[216:219], v[96:111]
    ds_read_b64_tr_b16 v[212:213], v31 offset:4096
    ds_read_b64_tr_b16 v[214:215], v31 offset:4608
    v_mfma_f32_32x32x16_bf16 v[160:175], v[232:235], v[220:223], v[160:175]
    v_mfma_f32_32x32x16_bf16 v[112:127], v[236:239], v[216:219], v[112:127]
    v_mfma_f32_32x32x16_bf16 v[176:191], v[236:239], v[220:223], v[176:191]
    s_waitcnt lgkmcnt(0)
    v_mfma_f32_32x32x16_bf16 v[64:79], v[200:203], v[192:195], v[64:79]
    ds_read_b128 v[216:219], v19 offset:0
    ds_read_b128 v[220:223], v19 offset:1024
    v_mfma_f32_32x32x16_bf16 v[128:143], v[200:203], v[196:199], v[128:143]
    ds_read_b64_tr_b16 v[224:225], v28 offset:6144
    ds_read_b64_tr_b16 v[226:227], v28 offset:6656
    v_mfma_f32_32x32x16_bf16 v[80:95], v[204:207], v[192:195], v[80:95]
    ds_read_b64_tr_b16 v[228:229], v29 offset:6144
    ds_read_b64_tr_b16 v[230:231], v29 offset:6656
    v_mfma_f32_32x32x16_bf16 v[144:159], v[204:207], v[196:199], v[144:159]
    ds_read_b64_tr_b16 v[232:233], v30 offset:6144
    ds_read_b64_tr_b16 v[234:235], v30 offset:6656
    v_mfma_f32_32x32x16_bf16 v[96:111], v[208:211], v[192:195], v[96:111]
    ds_read_b64_tr_b16 v[236:237], v31 offset:6144
    ds_read_b64_tr_b16 v[238:239], v31 offset:6656
    v_mfma_f32_32x32x16_bf16 v[160:175], v[208:211], v[196:199], v[160:175]
    v_mfma_f32_32x32x16_bf16 v[112:127], v[212:215], v[192:195], v[112:127]
    v_mfma_f32_32x32x16_bf16 v[176:191], v[212:215], v[196:199], v[176:191]
    s_waitcnt lgkmcnt(0)
    s_barrier
    v_mfma_f32_32x32x16_bf16 v[64:79], v[224:227], v[216:219], v[64:79]
    ds_read_b128 v[192:195], v8 offset:0
    ds_read_b128 v[196:199], v8 offset:1024
    v_mfma_f32_32x32x16_bf16 v[128:143], v[224:227], v[220:223], v[128:143]
    ds_read_b64_tr_b16 v[200:201], v20 offset:0
    ds_read_b64_tr_b16 v[202:203], v20 offset:512
    v_mfma_f32_32x32x16_bf16 v[80:95], v[228:231], v[216:219], v[80:95]
    ds_read_b64_tr_b16 v[204:205], v21 offset:0
    ds_read_b64_tr_b16 v[206:207], v21 offset:512
    v_mfma_f32_32x32x16_bf16 v[144:159], v[228:231], v[220:223], v[144:159]
    ds_read_b64_tr_b16 v[208:209], v22 offset:0
    ds_read_b64_tr_b16 v[210:211], v22 offset:512
    v_mfma_f32_32x32x16_bf16 v[96:111], v[232:235], v[216:219], v[96:111]
    ds_read_b64_tr_b16 v[212:213], v23 offset:0
    ds_read_b64_tr_b16 v[214:215], v23 offset:512
    v_mfma_f32_32x32x16_bf16 v[160:175], v[232:235], v[220:223], v[160:175]
    v_mfma_f32_32x32x16_bf16 v[112:127], v[236:239], v[216:219], v[112:127]
    v_mfma_f32_32x32x16_bf16 v[176:191], v[236:239], v[220:223], v[176:191]
    s_waitcnt lgkmcnt(0)
    v_mfma_f32_32x32x16_bf16 v[64:79], v[200:203], v[192:195], v[64:79]
    ds_read_b128 v[216:219], v9 offset:0
    ds_read_b128 v[220:223], v9 offset:1024
    v_mfma_f32_32x32x16_bf16 v[128:143], v[200:203], v[196:199], v[128:143]
    ds_read_b64_tr_b16 v[224:225], v20 offset:2048
    ds_read_b64_tr_b16 v[226:227], v20 offset:2560
    v_mfma_f32_32x32x16_bf16 v[80:95], v[204:207], v[192:195], v[80:95]
    ds_read_b64_tr_b16 v[228:229], v21 offset:2048
    ds_read_b64_tr_b16 v[230:231], v21 offset:2560
    v_mfma_f32_32x32x16_bf16 v[144:159], v[204:207], v[196:199], v[144:159]
    ds_read_b64_tr_b16 v[232:233], v22 offset:2048
    ds_read_b64_tr_b16 v[234:235], v22 offset:2560
    v_mfma_f32_32x32x16_bf16 v[96:111], v[208:211], v[192:195], v[96:111]
    ds_read_b64_tr_b16 v[236:237], v23 offset:2048
    ds_read_b64_tr_b16 v[238:239], v23 offset:2560
    v_mfma_f32_32x32x16_bf16 v[160:175], v[208:211], v[196:199], v[160:175]
    v_mfma_f32_32x32x16_bf16 v[112:127], v[212:215], v[192:195], v[112:127]
    v_mfma_f32_32x32x16_bf16 v[176:191], v[212:215], v[196:199], v[176:191]
    s_waitcnt lgkmcnt(0)
    v_mfma_f32_32x32x16_bf16 v[64:79], v[224:227], v[216:219], v[64:79]
    ds_read_b128 v[192:195], v10 offset:0
    ds_read_b128 v[196:199], v10 offset:1024
    v_mfma_f32_32x32x16_bf16 v[128:143], v[224:227], v[220:223], v[128:143]
    ds_read_b64_tr_b16 v[200:201], v20 offset:4096
    ds_read_b64_tr_b16 v[202:203], v20 offset:4608
    v_mfma_f32_32x32x16_bf16 v[80:95], v[228:231], v[216:219], v[80:95]
    ds_read_b64_tr_b16 v[204:205], v21 offset:4096
    ds_read_b64_tr_b16 v[206:207], v21 offset:4608
    v_mfma_f32_32x32x16_bf16 v[144:159], v[228:231], v[220:223], v[144:159]
    ds_read_b64_tr_b16 v[208:209], v22 offset:4096
    ds_read_b64_tr_b16 v[210:211], v22 offset:4608
    v_mfma_f32_32x32x16_bf16 v[96:111], v[232:235], v[216:219], v[96:111]
    ds_read_b64_tr_b16 v[212:213], v23 offset:4096
    ds_read_b64_tr_b16 v[214:215], v23 offset:4608
    v_mfma_f32_32x32x16_bf16 v[160:175], v[232:235], v[220:223], v[160:175]
    v_mfma_f32_32x32x16_bf16 v[112:127], v[236:239], v[216:219], v[112:127]
    v_mfma_f32_32x32x16_bf16 v[176:191], v[236:239], v[220:223], v[176:191]
    s_waitcnt lgkmcnt(0)
    v_mfma_f32_32x32x16_bf16 v[64:79], v[200:203], v[192:195], v[64:79]
    ds_read_b128 v[216:219], v11 offset:0
    ds_read_b128 v[220:223], v11 offset:1024
    v_mfma_f32_32x32x16_bf16 v[128:143], v[200:203], v[196:199], v[128:143]
    ds_read_b64_tr_b16 v[224:225], v20 offset:6144
    ds_read_b64_tr_b16 v[226:227], v20 offset:6656
    v_mfma_f32_32x32x16_bf16 v[80:95], v[204:207], v[192:195], v[80:95]
    ds_read_b64_tr_b16 v[228:229], v21 offset:6144
    ds_read_b64_tr_b16 v[230:231], v21 offset:6656
    v_mfma_f32_32x32x16_bf16 v[144:159], v[204:207], v[196:199], v[144:159]
    ds_read_b64_tr_b16 v[232:233], v22 offset:6144
    ds_read_b64_tr_b16 v[234:235], v22 offset:6656
    v_mfma_f32_32x32x16_bf16 v[96:111], v[208:211], v[192:195], v[96:111]
    ds_read_b64_tr_b16 v[236:237], v23 offset:6144
    ds_read_b64_tr_b16 v[238:239], v23 offset:6656
    v_mfma_f32_32x32x16_bf16 v[160:175], v[208:211], v[196:199], v[160:175]
    v_mfma_f32_32x32x16_bf16 v[112:127], v[212:215], v[192:195], v[112:127]
    v_mfma_f32_32x32x16_bf16 v[176:191], v[212:215], v[196:199], v[176:191]
    s_waitcnt lgkmcnt(0)
    s_barrier
    v_mfma_f32_32x32x16_bf16 v[64:79], v[224:227], v[216:219], v[64:79]
    ds_read_b128 v[192:195], v12 offset:0
    ds_read_b128 v[196:199], v12 offset:1024
    v_mfma_f32_32x32x16_bf16 v[128:143], v[224:227], v[220:223], v[128:143]
    ds_read_b64_tr_b16 v[200:201], v24 offset:0
    ds_read_b64_tr_b16 v[202:203], v24 offset:512
    v_mfma_f32_32x32x16_bf16 v[80:95], v[228:231], v[216:219], v[80:95]
    ds_read_b64_tr_b16 v[204:205], v25 offset:0
    ds_read_b64_tr_b16 v[206:207], v25 offset:512
    v_mfma_f32_32x32x16_bf16 v[144:159], v[228:231], v[220:223], v[144:159]
    ds_read_b64_tr_b16 v[208:209], v26 offset:0
    ds_read_b64_tr_b16 v[210:211], v26 offset:512
    v_mfma_f32_32x32x16_bf16 v[96:111], v[232:235], v[216:219], v[96:111]
    ds_read_b64_tr_b16 v[212:213], v27 offset:0
    ds_read_b64_tr_b16 v[214:215], v27 offset:512
    v_mfma_f32_32x32x16_bf16 v[160:175], v[232:235], v[220:223], v[160:175]
    v_mfma_f32_32x32x16_bf16 v[112:127], v[236:239], v[216:219], v[112:127]
    v_mfma_f32_32x32x16_bf16 v[176:191], v[236:239], v[220:223], v[176:191]
    s_waitcnt lgkmcnt(0)
    v_mfma_f32_32x32x16_bf16 v[64:79], v[200:203], v[192:195], v[64:79]
    ds_read_b128 v[216:219], v13 offset:0
    ds_read_b128 v[220:223], v13 offset:1024
    v_mfma_f32_32x32x16_bf16 v[128:143], v[200:203], v[196:199], v[128:143]
    ds_read_b64_tr_b16 v[224:225], v24 offset:2048
    ds_read_b64_tr_b16 v[226:227], v24 offset:2560
    v_mfma_f32_32x32x16_bf16 v[80:95], v[204:207], v[192:195], v[80:95]
    ds_read_b64_tr_b16 v[228:229], v25 offset:2048
    ds_read_b64_tr_b16 v[230:231], v25 offset:2560
    v_mfma_f32_32x32x16_bf16 v[144:159], v[204:207], v[196:199], v[144:159]
    ds_read_b64_tr_b16 v[232:233], v26 offset:2048
    ds_read_b64_tr_b16 v[234:235], v26 offset:2560
    v_mfma_f32_32x32x16_bf16 v[96:111], v[208:211], v[192:195], v[96:111]
    ds_read_b64_tr_b16 v[236:237], v27 offset:2048
    ds_read_b64_tr_b16 v[238:239], v27 offset:2560
    v_mfma_f32_32x32x16_bf16 v[160:175], v[208:211], v[196:199], v[160:175]
    v_mfma_f32_32x32x16_bf16 v[112:127], v[212:215], v[192:195], v[112:127]
    v_mfma_f32_32x32x16_bf16 v[176:191], v[212:215], v[196:199], v[176:191]
    s_waitcnt lgkmcnt(0)
    v_mfma_f32_32x32x16_bf16 v[64:79], v[224:227], v[216:219], v[64:79]
    ds_read_b128 v[192:195], v14 offset:0
    ds_read_b128 v[196:199], v14 offset:1024
    v_mfma_f32_32x32x16_bf16 v[128:143], v[224:227], v[220:223], v[128:143]
    ds_read_b64_tr_b16 v[200:201], v24 offset:4096
    ds_read_b64_tr_b16 v[202:203], v24 offset:4608
    v_mfma_f32_32x32x16_bf16 v[80:95], v[228:231], v[216:219], v[80:95]
    ds_read_b64_tr_b16 v[204:205], v25 offset:4096
    ds_read_b64_tr_b16 v[206:207], v25 offset:4608
    v_mfma_f32_32x32x16_bf16 v[144:159], v[228:231], v[220:223], v[144:159]
    ds_read_b64_tr_b16 v[208:209], v26 offset:4096
    ds_read_b64_tr_b16 v[210:211], v26 offset:4608
    v_mfma_f32_32x32x16_bf16 v[96:111], v[232:235], v[216:219], v[96:111]
    ds_read_b64_tr_b16 v[212:213], v27 offset:4096
    ds_read_b64_tr_b16 v[214:215], v27 offset:4608
    v_mfma_f32_32x32x16_bf16 v[160:175], v[232:235], v[220:223], v[160:175]
    v_mfma_f32_32x32x16_bf16 v[112:127], v[236:239], v[216:219], v[112:127]
    v_mfma_f32_32x32x16_bf16 v[176:191], v[236:239], v[220:223], v[176:191]
    s_waitcnt lgkmcnt(0)
    v_mfma_f32_32x32x16_bf16 v[64:79], v[200:203], v[192:195], v[64:79]
    ds_read_b128 v[216:219], v15 offset:0
    ds_read_b128 v[220:223], v15 offset:1024
    v_mfma_f32_32x32x16_bf16 v[128:143], v[200:203], v[196:199], v[128:143]
    ds_read_b64_tr_b16 v[224:225], v24 offset:6144
    ds_read_b64_tr_b16 v[226:227], v24 offset:6656
    v_mfma_f32_32x32x16_bf16 v[80:95], v[204:207], v[192:195], v[80:95]
    ds_read_b64_tr_b16 v[228:229], v25 offset:6144
    ds_read_b64_tr_b16 v[230:231], v25 offset:6656
    v_mfma_f32_32x32x16_bf16 v[144:159], v[204:207], v[196:199], v[144:159]
    ds_read_b64_tr_b16 v[232:233], v26 offset:6144
    ds_read_b64_tr_b16 v[234:235], v26 offset:6656
    v_mfma_f32_32x32x16_bf16 v[96:111], v[208:211], v[192:195], v[96:111]
    ds_read_b64_tr_b16 v[236:237], v27 offset:6144
    ds_read_b64_tr_b16 v[238:239], v27 offset:6656
    v_mfma_f32_32x32x16_bf16 v[160:175], v[208:211], v[196:199], v[160:175]
    v_mfma_f32_32x32x16_bf16 v[112:127], v[212:215], v[192:195], v[112:127]
    v_mfma_f32_32x32x16_bf16 v[176:191], v[212:215], v[196:199], v[176:191]
    s_waitcnt lgkmcnt(0)
    s_barrier
    v_mfma_f32_32x32x16_bf16 v[64:79], v[224:227], v[216:219], v[64:79]
    ds_read_b128 v[192:195], v16 offset:0
    ds_read_b128 v[196:199], v16 offset:1024
    v_mfma_f32_32x32x16_bf16 v[128:143], v[224:227], v[220:223], v[128:143]
    ds_read_b64_tr_b16 v[200:201], v28 offset:0
    ds_read_b64_tr_b16 v[202:203], v28 offset:512
    v_mfma_f32_32x32x16_bf16 v[80:95], v[228:231], v[216:219], v[80:95]
    ds_read_b64_tr_b16 v[204:205], v29 offset:0
    ds_read_b64_tr_b16 v[206:207], v29 offset:512
    v_mfma_f32_32x32x16_bf16 v[144:159], v[228:231], v[220:223], v[144:159]
    ds_read_b64_tr_b16 v[208:209], v30 offset:0
    ds_read_b64_tr_b16 v[210:211], v30 offset:512
    v_mfma_f32_32x32x16_bf16 v[96:111], v[232:235], v[216:219], v[96:111]
    ds_read_b64_tr_b16 v[212:213], v31 offset:0
    ds_read_b64_tr_b16 v[214:215], v31 offset:512
    v_mfma_f32_32x32x16_bf16 v[160:175], v[232:235], v[220:223], v[160:175]
    v_mfma_f32_32x32x16_bf16 v[112:127], v[236:239], v[216:219], v[112:127]
    v_mfma_f32_32x32x16_bf16 v[176:191], v[236:239], v[220:223], v[176:191]
    s_waitcnt lgkmcnt(0)
    v_mfma_f32_32x32x16_bf16 v[64:79], v[200:203], v[192:195], v[64:79]
    ds_read_b128 v[216:219], v17 offset:0
    ds_read_b128 v[220:223], v17 offset:1024
    v_mfma_f32_32x32x16_bf16 v[128:143], v[200:203], v[196:199], v[128:143]
    ds_read_b64_tr_b16 v[224:225], v28 offset:2048
    ds_read_b64_tr_b16 v[226:227], v28 offset:2560
    v_mfma_f32_32x32x16_bf16 v[80:95], v[204:207], v[192:195], v[80:95]
    ds_read_b64_tr_b16 v[228:229], v29 offset:2048
    ds_read_b64_tr_b16 v[230:231], v29 offset:2560
    v_mfma_f32_32x32x16_bf16 v[144:159], v[204:207], v[196:199], v[144:159]
    ds_read_b64_tr_b16 v[232:233], v30 offset:2048
    ds_read_b64_tr_b16 v[234:235], v30 offset:2560
    v_mfma_f32_32x32x16_bf16 v[96:111], v[208:211], v[192:195], v[96:111]
    ds_read_b64_tr_b16 v[236:237], v31 offset:2048
    ds_read_b64_tr_b16 v[238:239], v31 offset:2560
    v_mfma_f32_32x32x16_bf16 v[160:175], v[208:211], v[196:199], v[160:175]
    v_mfma_f32_32x32x16_bf16 v[112:127], v[212:215], v[192:195], v[112:127]
    v_mfma_f32_32x32x16_bf16 v[176:191], v[212:215], v[196:199], v[176:191]
    s_waitcnt lgkmcnt(0)
    v_mfma_f32_32x32x16_bf16 v[64:79], v[224:227], v[216:219], v[64:79]
    ds_read_b128 v[192:195], v18 offset:0
    ds_read_b128 v[196:199], v18 offset:1024
    v_mfma_f32_32x32x16_bf16 v[128:143], v[224:227], v[220:223], v[128:143]
    ds_read_b64_tr_b16 v[200:201], v28 offset:4096
    ds_read_b64_tr_b16 v[202:203], v28 offset:4608
    v_mfma_f32_32x32x16_bf16 v[80:95], v[228:231], v[216:219], v[80:95]
    ds_read_b64_tr_b16 v[204:205], v29 offset:4096
    ds_read_b64_tr_b16 v[206:207], v29 offset:4608
    v_mfma_f32_32x32x16_bf16 v[144:159], v[228:231], v[220:223], v[144:159]
    ds_read_b64_tr_b16 v[208:209], v30 offset:4096
    ds_read_b64_tr_b16 v[210:211], v30 offset:4608
    v_mfma_f32_32x32x16_bf16 v[96:111], v[232:235], v[216:219], v[96:111]
    ds_read_b64_tr_b16 v[212:213], v31 offset:4096
    ds_read_b64_tr_b16 v[214:215], v31 offset:4608
    v_mfma_f32_32x32x16_bf16 v[160:175], v[232:235], v[220:223], v[160:175]
    v_mfma_f32_32x32x16_bf16 v[112:127], v[236:239], v[216:219], v[112:127]
    v_mfma_f32_32x32x16_bf16 v[176:191], v[236:239], v[220:223], v[176:191]
    s_waitcnt lgkmcnt(0)
    v_mfma_f32_32x32x16_bf16 v[64:79], v[200:203], v[192:195], v[64:79]
    ds_read_b128 v[216:219], v19 offset:0
    ds_read_b128 v[220:223], v19 offset:1024
    v_mfma_f32_32x32x16_bf16 v[128:143], v[200:203], v[196:199], v[128:143]
    ds_read_b64_tr_b16 v[224:225], v28 offset:6144
    ds_read_b64_tr_b16 v[226:227], v28 offset:6656
    v_mfma_f32_32x32x16_bf16 v[80:95], v[204:207], v[192:195], v[80:95]
    ds_read_b64_tr_b16 v[228:229], v29 offset:6144
    ds_read_b64_tr_b16 v[230:231], v29 offset:6656
    v_mfma_f32_32x32x16_bf16 v[144:159], v[204:207], v[196:199], v[144:159]
    ds_read_b64_tr_b16 v[232:233], v30 offset:6144
    ds_read_b64_tr_b16 v[234:235], v30 offset:6656
    v_mfma_f32_32x32x16_bf16 v[96:111], v[208:211], v[192:195], v[96:111]
    ds_read_b64_tr_b16 v[236:237], v31 offset:6144
    ds_read_b64_tr_b16 v[238:239], v31 offset:6656
    v_mfma_f32_32x32x16_bf16 v[160:175], v[208:211], v[196:199], v[160:175]
    v_mfma_f32_32x32x16_bf16 v[112:127], v[212:215], v[192:195], v[112:127]
    v_mfma_f32_32x32x16_bf16 v[176:191], v[212:215], v[196:199], v[176:191]
    s_waitcnt lgkmcnt(0)
    s_barrier
    v_mfma_f32_32x32x16_bf16 v[64:79], v[224:227], v[216:219], v[64:79]
    ds_read_b128 v[192:195], v8 offset:0
    ds_read_b128 v[196:199], v8 offset:1024
    v_mfma_f32_32x32x16_bf16 v[128:143], v[224:227], v[220:223], v[128:143]
    ds_read_b64_tr_b16 v[200:201], v20 offset:0
    ds_read_b64_tr_b16 v[202:203], v20 offset:512
    v_mfma_f32_32x32x16_bf16 v[80:95], v[228:231], v[216:219], v[80:95]
    ds_read_b64_tr_b16 v[204:205], v21 offset:0
    ds_read_b64_tr_b16 v[206:207], v21 offset:512
    v_mfma_f32_32x32x16_bf16 v[144:159], v[228:231], v[220:223], v[144:159]
    ds_read_b64_tr_b16 v[208:209], v22 offset:0
    ds_read_b64_tr_b16 v[210:211], v22 offset:512
    v_mfma_f32_32x32x16_bf16 v[96:111], v[232:235], v[216:219], v[96:111]
    ds_read_b64_tr_b16 v[212:213], v23 offset:0
    ds_read_b64_tr_b16 v[214:215], v23 offset:512
    v_mfma_f32_32x32x16_bf16 v[160:175], v[232:235], v[220:223], v[160:175]
    v_mfma_f32_32x32x16_bf16 v[112:127], v[236:239], v[216:219], v[112:127]
    v_mfma_f32_32x32x16_bf16 v[176:191], v[236:239], v[220:223], v[176:191]
    s_waitcnt lgkmcnt(0)
    s_mov_b32 s56, s76
    s_mov_b32 s57, s77
    s_mov_b32 s58, 1835008
    s_mov_b32 s59, 0x20000
    s_lshr_b32 s46, s2, 3
    s_mul_i32 s46, s46, 57344
    s_mul_i32 s47, s3, 14336
    s_add_u32 s46, s46, s47
    v_lshlrev_b32 v244, 7, v1
    buffer_load_dword v245, v244, s[56:59], s46 offen
    s_add_u32 s46, s46, 8192
    s_mov_b32 exec_hi, 0xffff
    buffer_load_dword v246, v244, s[56:59], s46 offen
    s_mov_b64 exec, -1
    v_mfma_f32_32x32x16_bf16 v[64:79], v[200:203], v[192:195], v[64:79]
    ds_read_b128 v[216:219], v9 offset:0
    ds_read_b128 v[220:223], v9 offset:1024
    v_mfma_f32_32x32x16_bf16 v[128:143], v[200:203], v[196:199], v[128:143]
    ds_read_b64_tr_b16 v[224:225], v20 offset:2048
    ds_read_b64_tr_b16 v[226:227], v20 offset:2560
    v_mfma_f32_32x32x16_bf16 v[80:95], v[204:207], v[192:195], v[80:95]
    ds_read_b64_tr_b16 v[228:229], v21 offset:2048
    ds_read_b64_tr_b16 v[230:231], v21 offset:2560
    v_mfma_f32_32x32x16_bf16 v[144:159], v[204:207], v[196:199], v[144:159]
    ds_read_b64_tr_b16 v[232:233], v22 offset:2048
    ds_read_b64_tr_b16 v[234:235], v22 offset:2560
    v_mfma_f32_32x32x16_bf16 v[96:111], v[208:211], v[192:195], v[96:111]
    ds_read_b64_tr_b16 v[236:237], v23 offset:2048
    ds_read_b64_tr_b16 v[238:239], v23 offset:2560
    v_mfma_f32_32x32x16_bf16 v[160:175], v[208:211], v[196:199], v[160:175]
    v_mfma_f32_32x32x16_bf16 v[112:127], v[212:215], v[192:195], v[112:127]
    v_mfma_f32_32x32x16_bf16 v[176:191], v[212:215], v[196:199], v[176:191]
    s_waitcnt lgkmcnt(0)
    v_mfma_f32_32x32x16_bf16 v[64:79], v[224:227], v[216:219], v[64:79]
    ds_read_b128 v[192:195], v10 offset:0
    ds_read_b128 v[196:199], v10 offset:1024
    v_mfma_f32_32x32x16_bf16 v[128:143], v[224:227], v[220:223], v[128:143]
    ds_read_b64_tr_b16 v[200:201], v20 offset:4096
    ds_read_b64_tr_b16 v[202:203], v20 offset:4608
    v_mfma_f32_32x32x16_bf16 v[80:95], v[228:231], v[216:219], v[80:95]
    ds_read_b64_tr_b16 v[204:205], v21 offset:4096
    ds_read_b64_tr_b16 v[206:207], v21 offset:4608
    v_mfma_f32_32x32x16_bf16 v[144:159], v[228:231], v[220:223], v[144:159]
    ds_read_b64_tr_b16 v[208:209], v22 offset:4096
    ds_read_b64_tr_b16 v[210:211], v22 offset:4608
    v_mfma_f32_32x32x16_bf16 v[96:111], v[232:235], v[216:219], v[96:111]
    ds_read_b64_tr_b16 v[212:213], v23 offset:4096
    ds_read_b64_tr_b16 v[214:215], v23 offset:4608
    v_mfma_f32_32x32x16_bf16 v[160:175], v[232:235], v[220:223], v[160:175]
    v_mfma_f32_32x32x16_bf16 v[112:127], v[236:239], v[216:219], v[112:127]
    v_mfma_f32_32x32x16_bf16 v[176:191], v[236:239], v[220:223], v[176:191]
    s_waitcnt lgkmcnt(0)
    v_mfma_f32_32x32x16_bf16 v[64:79], v[200:203], v[192:195], v[64:79]
    ds_read_b128 v[216:219], v11 offset:0
    ds_read_b128 v[220:223], v11 offset:1024
    v_mfma_f32_32x32x16_bf16 v[128:143], v[200:203], v[196:199], v[128:143]
    ds_read_b64_tr_b16 v[224:225], v20 offset:6144
    ds_read_b64_tr_b16 v[226:227], v20 offset:6656
    v_mfma_f32_32x32x16_bf16 v[80:95], v[204:207], v[192:195], v[80:95]
    ds_read_b64_tr_b16 v[228:229], v21 offset:6144
    ds_read_b64_tr_b16 v[230:231], v21 offset:6656
    v_mfma_f32_32x32x16_bf16 v[144:159], v[204:207], v[196:199], v[144:159]
    ds_read_b64_tr_b16 v[232:233], v22 offset:6144
    ds_read_b64_tr_b16 v[234:235], v22 offset:6656
    v_mfma_f32_32x32x16_bf16 v[96:111], v[208:211], v[192:195], v[96:111]
    ds_read_b64_tr_b16 v[236:237], v23 offset:6144
    ds_read_b64_tr_b16 v[238:239], v23 offset:6656
    v_mfma_f32_32x32x16_bf16 v[160:175], v[208:211], v[196:199], v[160:175]
    v_mfma_f32_32x32x16_bf16 v[112:127], v[212:215], v[192:195], v[112:127]
    v_mfma_f32_32x32x16_bf16 v[176:191], v[212:215], v[196:199], v[176:191]
    s_waitcnt lgkmcnt(0)
    s_barrier
    v_mfma_f32_32x32x16_bf16 v[64:79], v[224:227], v[216:219], v[64:79]
    ds_read_b128 v[192:195], v12 offset:0
    ds_read_b128 v[196:199], v12 offset:1024
    v_mfma_f32_32x32x16_bf16 v[128:143], v[224:227], v[220:223], v[128:143]
    ds_read_b64_tr_b16 v[200:201], v24 offset:0
    ds_read_b64_tr_b16 v[202:203], v24 offset:512
    v_mfma_f32_32x32x16_bf16 v[80:95], v[228:231], v[216:219], v[80:95]
    ds_read_b64_tr_b16 v[204:205], v25 offset:0
    ds_read_b64_tr_b16 v[206:207], v25 offset:512
    v_mfma_f32_32x32x16_bf16 v[144:159], v[228:231], v[220:223], v[144:159]
    ds_read_b64_tr_b16 v[208:209], v26 offset:0
    ds_read_b64_tr_b16 v[210:211], v26 offset:512
    v_mfma_f32_32x32x16_bf16 v[96:111], v[232:235], v[216:219], v[96:111]
    ds_read_b64_tr_b16 v[212:213], v27 offset:0
    ds_read_b64_tr_b16 v[214:215], v27 offset:512
    v_mfma_f32_32x32x16_bf16 v[160:175], v[232:235], v[220:223], v[160:175]
    v_mfma_f32_32x32x16_bf16 v[112:127], v[236:239], v[216:219], v[112:127]
    v_mfma_f32_32x32x16_bf16 v[176:191], v[236:239], v[220:223], v[176:191]
    s_waitcnt lgkmcnt(0)
    v_mfma_f32_32x32x16_bf16 v[64:79], v[200:203], v[192:195], v[64:79]
    ds_read_b128 v[216:219], v13 offset:0
    ds_read_b128 v[220:223], v13 offset:1024
    v_mfma_f32_32x32x16_bf16 v[128:143], v[200:203], v[196:199], v[128:143]
    ds_read_b64_tr_b16 v[224:225], v24 offset:2048
    ds_read_b64_tr_b16 v[226:227], v24 offset:2560
    v_mfma_f32_32x32x16_bf16 v[80:95], v[204:207], v[192:195], v[80:95]
    ds_read_b64_tr_b16 v[228:229], v25 offset:2048
    ds_read_b64_tr_b16 v[230:231], v25 offset:2560
    v_mfma_f32_32x32x16_bf16 v[144:159], v[204:207], v[196:199], v[144:159]
    ds_read_b64_tr_b16 v[232:233], v26 offset:2048
    ds_read_b64_tr_b16 v[234:235], v26 offset:2560
    v_mfma_f32_32x32x16_bf16 v[96:111], v[208:211], v[192:195], v[96:111]
    ds_read_b64_tr_b16 v[236:237], v27 offset:2048
    ds_read_b64_tr_b16 v[238:239], v27 offset:2560
    v_mfma_f32_32x32x16_bf16 v[160:175], v[208:211], v[196:199], v[160:175]
    v_mfma_f32_32x32x16_bf16 v[112:127], v[212:215], v[192:195], v[112:127]
    v_mfma_f32_32x32x16_bf16 v[176:191], v[212:215], v[196:199], v[176:191]
    s_waitcnt lgkmcnt(0)
    v_mfma_f32_32x32x16_bf16 v[64:79], v[224:227], v[216:219], v[64:79]
    ds_read_b128 v[192:195], v14 offset:0
    ds_read_b128 v[196:199], v14 offset:1024
    v_mfma_f32_32x32x16_bf16 v[128:143], v[224:227], v[220:223], v[128:143]
    ds_read_b64_tr_b16 v[200:201], v24 offset:4096
    ds_read_b64_tr_b16 v[202:203], v24 offset:4608
    v_mfma_f32_32x32x16_bf16 v[80:95], v[228:231], v[216:219], v[80:95]
    ds_read_b64_tr_b16 v[204:205], v25 offset:4096
    ds_read_b64_tr_b16 v[206:207], v25 offset:4608
    v_mfma_f32_32x32x16_bf16 v[144:159], v[228:231], v[220:223], v[144:159]
    ds_read_b64_tr_b16 v[208:209], v26 offset:4096
    ds_read_b64_tr_b16 v[210:211], v26 offset:4608
    v_mfma_f32_32x32x16_bf16 v[96:111], v[232:235], v[216:219], v[96:111]
    ds_read_b64_tr_b16 v[212:213], v27 offset:4096
    ds_read_b64_tr_b16 v[214:215], v27 offset:4608
    v_mfma_f32_32x32x16_bf16 v[160:175], v[232:235], v[220:223], v[160:175]
    v_mfma_f32_32x32x16_bf16 v[112:127], v[236:239], v[216:219], v[112:127]
    v_mfma_f32_32x32x16_bf16 v[176:191], v[236:239], v[220:223], v[176:191]
    s_waitcnt lgkmcnt(0)
    v_mfma_f32_32x32x16_bf16 v[64:79], v[200:203], v[192:195], v[64:79]
    ds_read_b128 v[216:219], v15 offset:0
    ds_read_b128 v[220:223], v15 offset:1024
    v_mfma_f32_32x32x16_bf16 v[128:143], v[200:203], v[196:199], v[128:143]
    ds_read_b64_tr_b16 v[224:225], v24 offset:6144
    ds_read_b64_tr_b16 v[226:227], v24 offset:6656
    v_mfma_f32_32x32x16_bf16 v[80:95], v[204:207], v[192:195], v[80:95]
    ds_read_b64_tr_b16 v[228:229], v25 offset:6144
    ds_read_b64_tr_b16 v[230:231], v25 offset:6656
    v_mfma_f32_32x32x16_bf16 v[144:159], v[204:207], v[196:199], v[144:159]
    ds_read_b64_tr_b16 v[232:233], v26 offset:6144
    ds_read_b64_tr_b16 v[234:235], v26 offset:6656
    v_mfma_f32_32x32x16_bf16 v[96:111], v[208:211], v[192:195], v[96:111]
    ds_read_b64_tr_b16 v[236:237], v27 offset:6144
    ds_read_b64_tr_b16 v[238:239], v27 offset:6656
    v_mfma_f32_32x32x16_bf16 v[160:175], v[208:211], v[196:199], v[160:175]
    v_mfma_f32_32x32x16_bf16 v[112:127], v[212:215], v[192:195], v[112:127]
    v_mfma_f32_32x32x16_bf16 v[176:191], v[212:215], v[196:199], v[176:191]
    s_waitcnt lgkmcnt(0)
    v_mfma_f32_32x32x16_bf16 v[64:79], v[224:227], v[216:219], v[64:79]
    v_mfma_f32_32x32x16_bf16 v[128:143], v[224:227], v[220:223], v[128:143]
    v_mfma_f32_32x32x16_bf16 v[80:95], v[228:231], v[216:219], v[80:95]
    v_mfma_f32_32x32x16_bf16 v[144:159], v[228:231], v[220:223], v[144:159]
    v_mfma_f32_32x32x16_bf16 v[96:111], v[232:235], v[216:219], v[96:111]
    v_mfma_f32_32x32x16_bf16 v[160:175], v[232:235], v[220:223], v[160:175]
    v_mfma_f32_32x32x16_bf16 v[112:127], v[236:239], v[216:219], v[112:127]
    v_mfma_f32_32x32x16_bf16 v[176:191], v[236:239], v[220:223], v[176:191]
    s_barrier
    s_add_u32 s20, s82, s6
    s_addc_u32 s21, s83, 0
    s_add_u32 s20, s20, 12582912
    s_addc_u32 s21, s21, 0
    s_mov_b32 s22, 7340032
    s_mov_b32 s23, 0x20000
    s_lshl_b32 s35, s33, 8
    s_add_u32 s35, s35, 147456
    v_lshlrev_b32 v6, 2, v5
    v_add_u32 v6, s35, v6
    ds_read_b32 v48, v6 offset:0
    ds_read_b32 v50, v6 offset:512
    ds_read_b32 v49, v6 offset:128
    ds_read_b32 v51, v6 offset:640
    s_lshl_b32 s35, s34, 9
    s_add_u32 s35, s35, 149504
    v_lshlrev_b32 v7, 4, v4
    v_add_u32 v7, s35, v7
    s_lshl_b32 s37, s90, 2
    s_lshl_b32 s38, s33, 1
    s_add_u32 s37, s37, s38
    s_mul_i32 s37, s37, 112
    s_lshl_b32 s38, s91, 3
    s_lshl_b32 s39, s34, 2
    s_add_u32 s38, s38, s39
    s_add_u32 s37, s37, s38
    s_lshl_b32 s37, s37, 10
    v_lshlrev_b32 v54, 4, v1
    v_mov_b32 v58, 1.0
    v_mov_b32 v59, 1.0
    ds_read_b128 v[8:11], v7 offset:0
    ds_read_b128 v[12:15], v7 offset:32
    ds_read_b128 v[16:19], v7 offset:64
    ds_read_b128 v[20:23], v7 offset:96
    ds_read_b128 v[24:27], v7 offset:128
    ds_read_b128 v[28:31], v7 offset:160
    ds_read_b128 v[32:35], v7 offset:192
    ds_read_b128 v[36:39], v7 offset:224
    ds_read_b128 v[192:195], v7 offset:256
    ds_read_b128 v[196:199], v7 offset:288
    ds_read_b128 v[200:203], v7 offset:320
    ds_read_b128 v[204:207], v7 offset:352
    ds_read_b128 v[208:211], v7 offset:384
    ds_read_b128 v[212:215], v7 offset:416
    ds_read_b128 v[216:219], v7 offset:448
    ds_read_b128 v[220:223], v7 offset:480
    s_waitcnt lgkmcnt(12)
    v_mul_f32 v52, 0xbfb8aa3b, v50
    v_mul_f32 v53, 0xbfb8aa3b, v51
    v_pk_fma_f32 v[64:65], v[48:49], v[8:9], v[64:65] op_sel:[0,0,0] op_sel_hi:[0,1,1] neg_lo:[1,0,0] neg_hi:[1,0,0]
    v_pk_fma_f32 v[66:67], v[48:49], v[10:11], v[66:67] op_sel:[0,0,0] op_sel_hi:[0,1,1] neg_lo:[1,0,0] neg_hi:[1,0,0]
    v_pk_fma_f32 v[68:69], v[48:49], v[12:13], v[68:69] op_sel:[0,0,0] op_sel_hi:[0,1,1] neg_lo:[1,0,0] neg_hi:[1,0,0]
    v_pk_fma_f32 v[70:71], v[48:49], v[14:15], v[70:71] op_sel:[0,0,0] op_sel_hi:[0,1,1] neg_lo:[1,0,0] neg_hi:[1,0,0]
    v_pk_fma_f32 v[72:73], v[48:49], v[16:17], v[72:73] op_sel:[0,0,0] op_sel_hi:[0,1,1] neg_lo:[1,0,0] neg_hi:[1,0,0]
    v_pk_fma_f32 v[74:75], v[48:49], v[18:19], v[74:75] op_sel:[0,0,0] op_sel_hi:[0,1,1] neg_lo:[1,0,0] neg_hi:[1,0,0]
    v_pk_fma_f32 v[76:77], v[48:49], v[20:21], v[76:77] op_sel:[0,0,0] op_sel_hi:[0,1,1] neg_lo:[1,0,0] neg_hi:[1,0,0]
    v_pk_fma_f32 v[78:79], v[48:49], v[22:23], v[78:79] op_sel:[0,0,0] op_sel_hi:[0,1,1] neg_lo:[1,0,0] neg_hi:[1,0,0]
    v_pk_mul_f32 v[64:65], v[52:53], v[64:65] op_sel:[0,0] op_sel_hi:[0,1]
    v_pk_mul_f32 v[66:67], v[52:53], v[66:67] op_sel:[0,0] op_sel_hi:[0,1]
    v_pk_mul_f32 v[68:69], v[52:53], v[68:69] op_sel:[0,0] op_sel_hi:[0,1]
    v_pk_mul_f32 v[70:71], v[52:53], v[70:71] op_sel:[0,0] op_sel_hi:[0,1]
    v_exp_f32 v64, v64
    v_exp_f32 v65, v65
    v_exp_f32 v66, v66
    v_exp_f32 v67, v67
    v_exp_f32 v68, v68
    v_exp_f32 v69, v69
    v_exp_f32 v70, v70
    v_exp_f32 v71, v71
    v_pk_mul_f32 v[72:73], v[50:51], v[72:73] op_sel:[0,0] op_sel_hi:[0,1]
    v_pk_mul_f32 v[74:75], v[50:51], v[74:75] op_sel:[0,0] op_sel_hi:[0,1]
    v_pk_mul_f32 v[76:77], v[50:51], v[76:77] op_sel:[0,0] op_sel_hi:[0,1]
    v_pk_mul_f32 v[78:79], v[50:51], v[78:79] op_sel:[0,0] op_sel_hi:[0,1]
    v_pk_add_f32 v[64:65], v[58:59], v[64:65]
    v_pk_add_f32 v[66:67], v[58:59], v[66:67]
    v_pk_add_f32 v[68:69], v[58:59], v[68:69]
    v_pk_add_f32 v[70:71], v[58:59], v[70:71]
    v_rcp_f32 v64, v64
    v_rcp_f32 v65, v65
    v_rcp_f32 v66, v66
    v_rcp_f32 v67, v67
    v_rcp_f32 v68, v68
    v_rcp_f32 v69, v69
    v_rcp_f32 v70, v70
    v_rcp_f32 v71, v71
    v_pk_mul_f32 v[64:65], v[64:65], v[72:73]
    v_pk_mul_f32 v[66:67], v[66:67], v[74:75]
    v_pk_mul_f32 v[68:69], v[68:69], v[76:77]
    v_pk_mul_f32 v[70:71], v[70:71], v[78:79]
    v_cvt_pk_bf16_f32 v72, v64, v65
    v_cvt_pk_bf16_f32 v73, v66, v67
    v_cvt_pk_bf16_f32 v74, v68, v69
    v_cvt_pk_bf16_f32 v75, v70, v71
    s_add_u32 s38, s37, 0
    buffer_store_dwordx4 v[72:75], v54, s[20:23], s38 offen sc1
    v_pk_fma_f32 v[128:129], v[48:49], v[8:9], v[128:129] op_sel:[1,0,0] op_sel_hi:[1,1,1] neg_lo:[1,0,0] neg_hi:[1,0,0]
    v_pk_fma_f32 v[130:131], v[48:49], v[10:11], v[130:131] op_sel:[1,0,0] op_sel_hi:[1,1,1] neg_lo:[1,0,0] neg_hi:[1,0,0]
    v_pk_fma_f32 v[132:133], v[48:49], v[12:13], v[132:133] op_sel:[1,0,0] op_sel_hi:[1,1,1] neg_lo:[1,0,0] neg_hi:[1,0,0]
    v_pk_fma_f32 v[134:135], v[48:49], v[14:15], v[134:135] op_sel:[1,0,0] op_sel_hi:[1,1,1] neg_lo:[1,0,0] neg_hi:[1,0,0]
    v_pk_fma_f32 v[136:137], v[48:49], v[16:17], v[136:137] op_sel:[1,0,0] op_sel_hi:[1,1,1] neg_lo:[1,0,0] neg_hi:[1,0,0]
    v_pk_fma_f32 v[138:139], v[48:49], v[18:19], v[138:139] op_sel:[1,0,0] op_sel_hi:[1,1,1] neg_lo:[1,0,0] neg_hi:[1,0,0]
    v_pk_fma_f32 v[140:141], v[48:49], v[20:21], v[140:141] op_sel:[1,0,0] op_sel_hi:[1,1,1] neg_lo:[1,0,0] neg_hi:[1,0,0]
    v_pk_fma_f32 v[142:143], v[48:49], v[22:23], v[142:143] op_sel:[1,0,0] op_sel_hi:[1,1,1] neg_lo:[1,0,0] neg_hi:[1,0,0]
    v_pk_mul_f32 v[128:129], v[52:53], v[128:129] op_sel:[1,0] op_sel_hi:[1,1]
    v_pk_mul_f32 v[130:131], v[52:53], v[130:131] op_sel:[1,0] op_sel_hi:[1,1]
    v_pk_mul_f32 v[132:133], v[52:53], v[132:133] op_sel:[1,0] op_sel_hi:[1,1]
    v_pk_mul_f32 v[134:135], v[52:53], v[134:135] op_sel:[1,0] op_sel_hi:[1,1]
    v_exp_f32 v128, v128
    v_exp_f32 v129, v129
    v_exp_f32 v130, v130
    v_exp_f32 v131, v131
    v_exp_f32 v132, v132
    v_exp_f32 v133, v133
    v_exp_f32 v134, v134
    v_exp_f32 v135, v135
    v_pk_mul_f32 v[136:137], v[50:51], v[136:137] op_sel:[1,0] op_sel_hi:[1,1]
    v_pk_mul_f32 v[138:139], v[50:51], v[138:139] op_sel:[1,0] op_sel_hi:[1,1]
    v_pk_mul_f32 v[140:141], v[50:51], v[140:141] op_sel:[1,0] op_sel_hi:[1,1]
    v_pk_mul_f32 v[142:143], v[50:51], v[142:143] op_sel:[1,0] op_sel_hi:[1,1]
    v_pk_add_f32 v[128:129], v[58:59], v[128:129]
    v_pk_add_f32 v[130:131], v[58:59], v[130:131]
    v_pk_add_f32 v[132:133], v[58:59], v[132:133]
    v_pk_add_f32 v[134:135], v[58:59], v[134:135]
    v_rcp_f32 v128, v128
    v_rcp_f32 v129, v129
    v_rcp_f32 v130, v130
    v_rcp_f32 v131, v131
    v_rcp_f32 v132, v132
    v_rcp_f32 v133, v133
    v_rcp_f32 v134, v134
    v_rcp_f32 v135, v135
    v_pk_mul_f32 v[128:129], v[128:129], v[136:137]
    v_pk_mul_f32 v[130:131], v[130:131], v[138:139]
    v_pk_mul_f32 v[132:133], v[132:133], v[140:141]
    v_pk_mul_f32 v[134:135], v[134:135], v[142:143]
    v_cvt_pk_bf16_f32 v136, v128, v129
    v_cvt_pk_bf16_f32 v137, v130, v131
    v_cvt_pk_bf16_f32 v138, v132, v133
    v_cvt_pk_bf16_f32 v139, v134, v135
    s_add_u32 s38, s37, 114688
    buffer_store_dwordx4 v[136:139], v54, s[20:23], s38 offen sc1
    s_waitcnt lgkmcnt(8)
    v_pk_fma_f32 v[80:81], v[48:49], v[24:25], v[80:81] op_sel:[0,0,0] op_sel_hi:[0,1,1] neg_lo:[1,0,0] neg_hi:[1,0,0]
    v_pk_fma_f32 v[82:83], v[48:49], v[26:27], v[82:83] op_sel:[0,0,0] op_sel_hi:[0,1,1] neg_lo:[1,0,0] neg_hi:[1,0,0]
    v_pk_fma_f32 v[84:85], v[48:49], v[28:29], v[84:85] op_sel:[0,0,0] op_sel_hi:[0,1,1] neg_lo:[1,0,0] neg_hi:[1,0,0]
    v_pk_fma_f32 v[86:87], v[48:49], v[30:31], v[86:87] op_sel:[0,0,0] op_sel_hi:[0,1,1] neg_lo:[1,0,0] neg_hi:[1,0,0]
    v_pk_fma_f32 v[88:89], v[48:49], v[32:33], v[88:89] op_sel:[0,0,0] op_sel_hi:[0,1,1] neg_lo:[1,0,0] neg_hi:[1,0,0]
    v_pk_fma_f32 v[90:91], v[48:49], v[34:35], v[90:91] op_sel:[0,0,0] op_sel_hi:[0,1,1] neg_lo:[1,0,0] neg_hi:[1,0,0]
    v_pk_fma_f32 v[92:93], v[48:49], v[36:37], v[92:93] op_sel:[0,0,0] op_sel_hi:[0,1,1] neg_lo:[1,0,0] neg_hi:[1,0,0]
    v_pk_fma_f32 v[94:95], v[48:49], v[38:39], v[94:95] op_sel:[0,0,0] op_sel_hi:[0,1,1] neg_lo:[1,0,0] neg_hi:[1,0,0]
    v_pk_mul_f32 v[80:81], v[52:53], v[80:81] op_sel:[0,0] op_sel_hi:[0,1]
    v_pk_mul_f32 v[82:83], v[52:53], v[82:83] op_sel:[0,0] op_sel_hi:[0,1]
    v_pk_mul_f32 v[84:85], v[52:53], v[84:85] op_sel:[0,0] op_sel_hi:[0,1]
    v_pk_mul_f32 v[86:87], v[52:53], v[86:87] op_sel:[0,0] op_sel_hi:[0,1]
    v_exp_f32 v80, v80
    v_exp_f32 v81, v81
    v_exp_f32 v82, v82
    v_exp_f32 v83, v83
    v_exp_f32 v84, v84
    v_exp_f32 v85, v85
    v_exp_f32 v86, v86
    v_exp_f32 v87, v87
    v_pk_mul_f32 v[88:89], v[50:51], v[88:89] op_sel:[0,0] op_sel_hi:[0,1]
    v_pk_mul_f32 v[90:91], v[50:51], v[90:91] op_sel:[0,0] op_sel_hi:[0,1]
    v_pk_mul_f32 v[92:93], v[50:51], v[92:93] op_sel:[0,0] op_sel_hi:[0,1]
    v_pk_mul_f32 v[94:95], v[50:51], v[94:95] op_sel:[0,0] op_sel_hi:[0,1]
    v_pk_add_f32 v[80:81], v[58:59], v[80:81]
    v_pk_add_f32 v[82:83], v[58:59], v[82:83]
    v_pk_add_f32 v[84:85], v[58:59], v[84:85]
    v_pk_add_f32 v[86:87], v[58:59], v[86:87]
    v_rcp_f32 v80, v80
    v_rcp_f32 v81, v81
    v_rcp_f32 v82, v82
    v_rcp_f32 v83, v83
    v_rcp_f32 v84, v84
    v_rcp_f32 v85, v85
    v_rcp_f32 v86, v86
    v_rcp_f32 v87, v87
    v_pk_mul_f32 v[80:81], v[80:81], v[88:89]
    v_pk_mul_f32 v[82:83], v[82:83], v[90:91]
    v_pk_mul_f32 v[84:85], v[84:85], v[92:93]
    v_pk_mul_f32 v[86:87], v[86:87], v[94:95]
    v_cvt_pk_bf16_f32 v88, v80, v81
    v_cvt_pk_bf16_f32 v89, v82, v83
    v_cvt_pk_bf16_f32 v90, v84, v85
    v_cvt_pk_bf16_f32 v91, v86, v87
    s_add_u32 s38, s37, 1024
    buffer_store_dwordx4 v[88:91], v54, s[20:23], s38 offen sc1
    v_pk_fma_f32 v[144:145], v[48:49], v[24:25], v[144:145] op_sel:[1,0,0] op_sel_hi:[1,1,1] neg_lo:[1,0,0] neg_hi:[1,0,0]
    v_pk_fma_f32 v[146:147], v[48:49], v[26:27], v[146:147] op_sel:[1,0,0] op_sel_hi:[1,1,1] neg_lo:[1,0,0] neg_hi:[1,0,0]
    v_pk_fma_f32 v[148:149], v[48:49], v[28:29], v[148:149] op_sel:[1,0,0] op_sel_hi:[1,1,1] neg_lo:[1,0,0] neg_hi:[1,0,0]
    v_pk_fma_f32 v[150:151], v[48:49], v[30:31], v[150:151] op_sel:[1,0,0] op_sel_hi:[1,1,1] neg_lo:[1,0,0] neg_hi:[1,0,0]
    v_pk_fma_f32 v[152:153], v[48:49], v[32:33], v[152:153] op_sel:[1,0,0] op_sel_hi:[1,1,1] neg_lo:[1,0,0] neg_hi:[1,0,0]
    v_pk_fma_f32 v[154:155], v[48:49], v[34:35], v[154:155] op_sel:[1,0,0] op_sel_hi:[1,1,1] neg_lo:[1,0,0] neg_hi:[1,0,0]
    v_pk_fma_f32 v[156:157], v[48:49], v[36:37], v[156:157] op_sel:[1,0,0] op_sel_hi:[1,1,1] neg_lo:[1,0,0] neg_hi:[1,0,0]
    v_pk_fma_f32 v[158:159], v[48:49], v[38:39], v[158:159] op_sel:[1,0,0] op_sel_hi:[1,1,1] neg_lo:[1,0,0] neg_hi:[1,0,0]
    v_pk_mul_f32 v[144:145], v[52:53], v[144:145] op_sel:[1,0] op_sel_hi:[1,1]
    v_pk_mul_f32 v[146:147], v[52:53], v[146:147] op_sel:[1,0] op_sel_hi:[1,1]
    v_pk_mul_f32 v[148:149], v[52:53], v[148:149] op_sel:[1,0] op_sel_hi:[1,1]
    v_pk_mul_f32 v[150:151], v[52:53], v[150:151] op_sel:[1,0] op_sel_hi:[1,1]
    v_exp_f32 v144, v144
    v_exp_f32 v145, v145
    v_exp_f32 v146, v146
    v_exp_f32 v147, v147
    v_exp_f32 v148, v148
    v_exp_f32 v149, v149
    v_exp_f32 v150, v150
    v_exp_f32 v151, v151
    v_pk_mul_f32 v[152:153], v[50:51], v[152:153] op_sel:[1,0] op_sel_hi:[1,1]
    v_pk_mul_f32 v[154:155], v[50:51], v[154:155] op_sel:[1,0] op_sel_hi:[1,1]
    v_pk_mul_f32 v[156:157], v[50:51], v[156:157] op_sel:[1,0] op_sel_hi:[1,1]
    v_pk_mul_f32 v[158:159], v[50:51], v[158:159] op_sel:[1,0] op_sel_hi:[1,1]
    v_pk_add_f32 v[144:145], v[58:59], v[144:145]
    v_pk_add_f32 v[146:147], v[58:59], v[146:147]
    v_pk_add_f32 v[148:149], v[58:59], v[148:149]
    v_pk_add_f32 v[150:151], v[58:59], v[150:151]
    v_rcp_f32 v144, v144
    v_rcp_f32 v145, v145
    v_rcp_f32 v146, v146
    v_rcp_f32 v147, v147
    v_rcp_f32 v148, v148
    v_rcp_f32 v149, v149
    v_rcp_f32 v150, v150
    v_rcp_f32 v151, v151
    v_pk_mul_f32 v[144:145], v[144:145], v[152:153]
    v_pk_mul_f32 v[146:147], v[146:147], v[154:155]
    v_pk_mul_f32 v[148:149], v[148:149], v[156:157]
    v_pk_mul_f32 v[150:151], v[150:151], v[158:159]
    v_cvt_pk_bf16_f32 v152, v144, v145
    v_cvt_pk_bf16_f32 v153, v146, v147
    v_cvt_pk_bf16_f32 v154, v148, v149
    v_cvt_pk_bf16_f32 v155, v150, v151
    s_add_u32 s38, s37, 115712
    buffer_store_dwordx4 v[152:155], v54, s[20:23], s38 offen sc1
    s_waitcnt lgkmcnt(4)
    v_pk_fma_f32 v[96:97], v[48:49], v[192:193], v[96:97] op_sel:[0,0,0] op_sel_hi:[0,1,1] neg_lo:[1,0,0] neg_hi:[1,0,0]
    v_pk_fma_f32 v[98:99], v[48:49], v[194:195], v[98:99] op_sel:[0,0,0] op_sel_hi:[0,1,1] neg_lo:[1,0,0] neg_hi:[1,0,0]
    v_pk_fma_f32 v[100:101], v[48:49], v[196:197], v[100:101] op_sel:[0,0,0] op_sel_hi:[0,1,1] neg_lo:[1,0,0] neg_hi:[1,0,0]
    v_pk_fma_f32 v[102:103], v[48:49], v[198:199], v[102:103] op_sel:[0,0,0] op_sel_hi:[0,1,1] neg_lo:[1,0,0] neg_hi:[1,0,0]
    v_pk_fma_f32 v[104:105], v[48:49], v[200:201], v[104:105] op_sel:[0,0,0] op_sel_hi:[0,1,1] neg_lo:[1,0,0] neg_hi:[1,0,0]
    v_pk_fma_f32 v[106:107], v[48:49], v[202:203], v[106:107] op_sel:[0,0,0] op_sel_hi:[0,1,1] neg_lo:[1,0,0] neg_hi:[1,0,0]
    v_pk_fma_f32 v[108:109], v[48:49], v[204:205], v[108:109] op_sel:[0,0,0] op_sel_hi:[0,1,1] neg_lo:[1,0,0] neg_hi:[1,0,0]
    v_pk_fma_f32 v[110:111], v[48:49], v[206:207], v[110:111] op_sel:[0,0,0] op_sel_hi:[0,1,1] neg_lo:[1,0,0] neg_hi:[1,0,0]
    v_pk_mul_f32 v[96:97], v[52:53], v[96:97] op_sel:[0,0] op_sel_hi:[0,1]
    v_pk_mul_f32 v[98:99], v[52:53], v[98:99] op_sel:[0,0] op_sel_hi:[0,1]
    v_pk_mul_f32 v[100:101], v[52:53], v[100:101] op_sel:[0,0] op_sel_hi:[0,1]
    v_pk_mul_f32 v[102:103], v[52:53], v[102:103] op_sel:[0,0] op_sel_hi:[0,1]
    v_exp_f32 v96, v96
    v_exp_f32 v97, v97
    v_exp_f32 v98, v98
    v_exp_f32 v99, v99
    v_exp_f32 v100, v100
    v_exp_f32 v101, v101
    v_exp_f32 v102, v102
    v_exp_f32 v103, v103
    v_pk_mul_f32 v[104:105], v[50:51], v[104:105] op_sel:[0,0] op_sel_hi:[0,1]
    v_pk_mul_f32 v[106:107], v[50:51], v[106:107] op_sel:[0,0] op_sel_hi:[0,1]
    v_pk_mul_f32 v[108:109], v[50:51], v[108:109] op_sel:[0,0] op_sel_hi:[0,1]
    v_pk_mul_f32 v[110:111], v[50:51], v[110:111] op_sel:[0,0] op_sel_hi:[0,1]
    v_pk_add_f32 v[96:97], v[58:59], v[96:97]
    v_pk_add_f32 v[98:99], v[58:59], v[98:99]
    v_pk_add_f32 v[100:101], v[58:59], v[100:101]
    v_pk_add_f32 v[102:103], v[58:59], v[102:103]
    v_rcp_f32 v96, v96
    v_rcp_f32 v97, v97
    v_rcp_f32 v98, v98
    v_rcp_f32 v99, v99
    v_rcp_f32 v100, v100
    v_rcp_f32 v101, v101
    v_rcp_f32 v102, v102
    v_rcp_f32 v103, v103
    v_pk_mul_f32 v[96:97], v[96:97], v[104:105]
    v_pk_mul_f32 v[98:99], v[98:99], v[106:107]
    v_pk_mul_f32 v[100:101], v[100:101], v[108:109]
    v_pk_mul_f32 v[102:103], v[102:103], v[110:111]
    v_cvt_pk_bf16_f32 v104, v96, v97
    v_cvt_pk_bf16_f32 v105, v98, v99
    v_cvt_pk_bf16_f32 v106, v100, v101
    v_cvt_pk_bf16_f32 v107, v102, v103
    s_add_u32 s38, s37, 2048
    buffer_store_dwordx4 v[104:107], v54, s[20:23], s38 offen sc1
    v_pk_fma_f32 v[160:161], v[48:49], v[192:193], v[160:161] op_sel:[1,0,0] op_sel_hi:[1,1,1] neg_lo:[1,0,0] neg_hi:[1,0,0]
    v_pk_fma_f32 v[162:163], v[48:49], v[194:195], v[162:163] op_sel:[1,0,0] op_sel_hi:[1,1,1] neg_lo:[1,0,0] neg_hi:[1,0,0]
    v_pk_fma_f32 v[164:165], v[48:49], v[196:197], v[164:165] op_sel:[1,0,0] op_sel_hi:[1,1,1] neg_lo:[1,0,0] neg_hi:[1,0,0]
    v_pk_fma_f32 v[166:167], v[48:49], v[198:199], v[166:167] op_sel:[1,0,0] op_sel_hi:[1,1,1] neg_lo:[1,0,0] neg_hi:[1,0,0]
    v_pk_fma_f32 v[168:169], v[48:49], v[200:201], v[168:169] op_sel:[1,0,0] op_sel_hi:[1,1,1] neg_lo:[1,0,0] neg_hi:[1,0,0]
    v_pk_fma_f32 v[170:171], v[48:49], v[202:203], v[170:171] op_sel:[1,0,0] op_sel_hi:[1,1,1] neg_lo:[1,0,0] neg_hi:[1,0,0]
    v_pk_fma_f32 v[172:173], v[48:49], v[204:205], v[172:173] op_sel:[1,0,0] op_sel_hi:[1,1,1] neg_lo:[1,0,0] neg_hi:[1,0,0]
    v_pk_fma_f32 v[174:175], v[48:49], v[206:207], v[174:175] op_sel:[1,0,0] op_sel_hi:[1,1,1] neg_lo:[1,0,0] neg_hi:[1,0,0]
    v_pk_mul_f32 v[160:161], v[52:53], v[160:161] op_sel:[1,0] op_sel_hi:[1,1]
    v_pk_mul_f32 v[162:163], v[52:53], v[162:163] op_sel:[1,0] op_sel_hi:[1,1]
    v_pk_mul_f32 v[164:165], v[52:53], v[164:165] op_sel:[1,0] op_sel_hi:[1,1]
    v_pk_mul_f32 v[166:167], v[52:53], v[166:167] op_sel:[1,0] op_sel_hi:[1,1]
    v_exp_f32 v160, v160
    v_exp_f32 v161, v161
    v_exp_f32 v162, v162
    v_exp_f32 v163, v163
    v_exp_f32 v164, v164
    v_exp_f32 v165, v165
    v_exp_f32 v166, v166
    v_exp_f32 v167, v167
    v_pk_mul_f32 v[168:169], v[50:51], v[168:169] op_sel:[1,0] op_sel_hi:[1,1]
    v_pk_mul_f32 v[170:171], v[50:51], v[170:171] op_sel:[1,0] op_sel_hi:[1,1]
    v_pk_mul_f32 v[172:173], v[50:51], v[172:173] op_sel:[1,0] op_sel_hi:[1,1]
    v_pk_mul_f32 v[174:175], v[50:51], v[174:175] op_sel:[1,0] op_sel_hi:[1,1]
    v_pk_add_f32 v[160:161], v[58:59], v[160:161]
    v_pk_add_f32 v[162:163], v[58:59], v[162:163]
    v_pk_add_f32 v[164:165], v[58:59], v[164:165]
    v_pk_add_f32 v[166:167], v[58:59], v[166:167]
    v_rcp_f32 v160, v160
    v_rcp_f32 v161, v161
    v_rcp_f32 v162, v162
    v_rcp_f32 v163, v163
    v_rcp_f32 v164, v164
    v_rcp_f32 v165, v165
    v_rcp_f32 v166, v166
    v_rcp_f32 v167, v167
    v_pk_mul_f32 v[160:161], v[160:161], v[168:169]
    v_pk_mul_f32 v[162:163], v[162:163], v[170:171]
    v_pk_mul_f32 v[164:165], v[164:165], v[172:173]
    v_pk_mul_f32 v[166:167], v[166:167], v[174:175]
    v_cvt_pk_bf16_f32 v168, v160, v161
    v_cvt_pk_bf16_f32 v169, v162, v163
    v_cvt_pk_bf16_f32 v170, v164, v165
    v_cvt_pk_bf16_f32 v171, v166, v167
    s_add_u32 s38, s37, 116736
    buffer_store_dwordx4 v[168:171], v54, s[20:23], s38 offen sc1
    s_waitcnt lgkmcnt(0)
    v_pk_fma_f32 v[112:113], v[48:49], v[208:209], v[112:113] op_sel:[0,0,0] op_sel_hi:[0,1,1] neg_lo:[1,0,0] neg_hi:[1,0,0]
    v_pk_fma_f32 v[114:115], v[48:49], v[210:211], v[114:115] op_sel:[0,0,0] op_sel_hi:[0,1,1] neg_lo:[1,0,0] neg_hi:[1,0,0]
    v_pk_fma_f32 v[116:117], v[48:49], v[212:213], v[116:117] op_sel:[0,0,0] op_sel_hi:[0,1,1] neg_lo:[1,0,0] neg_hi:[1,0,0]
    v_pk_fma_f32 v[118:119], v[48:49], v[214:215], v[118:119] op_sel:[0,0,0] op_sel_hi:[0,1,1] neg_lo:[1,0,0] neg_hi:[1,0,0]
    v_pk_fma_f32 v[120:121], v[48:49], v[216:217], v[120:121] op_sel:[0,0,0] op_sel_hi:[0,1,1] neg_lo:[1,0,0] neg_hi:[1,0,0]
    v_pk_fma_f32 v[122:123], v[48:49], v[218:219], v[122:123] op_sel:[0,0,0] op_sel_hi:[0,1,1] neg_lo:[1,0,0] neg_hi:[1,0,0]
    v_pk_fma_f32 v[124:125], v[48:49], v[220:221], v[124:125] op_sel:[0,0,0] op_sel_hi:[0,1,1] neg_lo:[1,0,0] neg_hi:[1,0,0]
    v_pk_fma_f32 v[126:127], v[48:49], v[222:223], v[126:127] op_sel:[0,0,0] op_sel_hi:[0,1,1] neg_lo:[1,0,0] neg_hi:[1,0,0]
    v_pk_mul_f32 v[112:113], v[52:53], v[112:113] op_sel:[0,0] op_sel_hi:[0,1]
    v_pk_mul_f32 v[114:115], v[52:53], v[114:115] op_sel:[0,0] op_sel_hi:[0,1]
    v_pk_mul_f32 v[116:117], v[52:53], v[116:117] op_sel:[0,0] op_sel_hi:[0,1]
    v_pk_mul_f32 v[118:119], v[52:53], v[118:119] op_sel:[0,0] op_sel_hi:[0,1]
    v_exp_f32 v112, v112
    v_exp_f32 v113, v113
    v_exp_f32 v114, v114
    v_exp_f32 v115, v115
    v_exp_f32 v116, v116
    v_exp_f32 v117, v117
    v_exp_f32 v118, v118
    v_exp_f32 v119, v119
    v_pk_mul_f32 v[120:121], v[50:51], v[120:121] op_sel:[0,0] op_sel_hi:[0,1]
    v_pk_mul_f32 v[122:123], v[50:51], v[122:123] op_sel:[0,0] op_sel_hi:[0,1]
    v_pk_mul_f32 v[124:125], v[50:51], v[124:125] op_sel:[0,0] op_sel_hi:[0,1]
    v_pk_mul_f32 v[126:127], v[50:51], v[126:127] op_sel:[0,0] op_sel_hi:[0,1]
    v_pk_add_f32 v[112:113], v[58:59], v[112:113]
    v_pk_add_f32 v[114:115], v[58:59], v[114:115]
    v_pk_add_f32 v[116:117], v[58:59], v[116:117]
    v_pk_add_f32 v[118:119], v[58:59], v[118:119]
    v_rcp_f32 v112, v112
    v_rcp_f32 v113, v113
    v_rcp_f32 v114, v114
    v_rcp_f32 v115, v115
    v_rcp_f32 v116, v116
    v_rcp_f32 v117, v117
    v_rcp_f32 v118, v118
    v_rcp_f32 v119, v119
    v_pk_mul_f32 v[112:113], v[112:113], v[120:121]
    v_pk_mul_f32 v[114:115], v[114:115], v[122:123]
    v_pk_mul_f32 v[116:117], v[116:117], v[124:125]
    v_pk_mul_f32 v[118:119], v[118:119], v[126:127]
    v_cvt_pk_bf16_f32 v120, v112, v113
    v_cvt_pk_bf16_f32 v121, v114, v115
    v_cvt_pk_bf16_f32 v122, v116, v117
    v_cvt_pk_bf16_f32 v123, v118, v119
    s_add_u32 s38, s37, 3072
    buffer_store_dwordx4 v[120:123], v54, s[20:23], s38 offen sc1
    v_pk_fma_f32 v[176:177], v[48:49], v[208:209], v[176:177] op_sel:[1,0,0] op_sel_hi:[1,1,1] neg_lo:[1,0,0] neg_hi:[1,0,0]
    v_pk_fma_f32 v[178:179], v[48:49], v[210:211], v[178:179] op_sel:[1,0,0] op_sel_hi:[1,1,1] neg_lo:[1,0,0] neg_hi:[1,0,0]
    v_pk_fma_f32 v[180:181], v[48:49], v[212:213], v[180:181] op_sel:[1,0,0] op_sel_hi:[1,1,1] neg_lo:[1,0,0] neg_hi:[1,0,0]
    v_pk_fma_f32 v[182:183], v[48:49], v[214:215], v[182:183] op_sel:[1,0,0] op_sel_hi:[1,1,1] neg_lo:[1,0,0] neg_hi:[1,0,0]
    v_pk_fma_f32 v[184:185], v[48:49], v[216:217], v[184:185] op_sel:[1,0,0] op_sel_hi:[1,1,1] neg_lo:[1,0,0] neg_hi:[1,0,0]
    v_pk_fma_f32 v[186:187], v[48:49], v[218:219], v[186:187] op_sel:[1,0,0] op_sel_hi:[1,1,1] neg_lo:[1,0,0] neg_hi:[1,0,0]
    v_pk_fma_f32 v[188:189], v[48:49], v[220:221], v[188:189] op_sel:[1,0,0] op_sel_hi:[1,1,1] neg_lo:[1,0,0] neg_hi:[1,0,0]
    v_pk_fma_f32 v[190:191], v[48:49], v[222:223], v[190:191] op_sel:[1,0,0] op_sel_hi:[1,1,1] neg_lo:[1,0,0] neg_hi:[1,0,0]
    v_pk_mul_f32 v[176:177], v[52:53], v[176:177] op_sel:[1,0] op_sel_hi:[1,1]
    v_pk_mul_f32 v[178:179], v[52:53], v[178:179] op_sel:[1,0] op_sel_hi:[1,1]
    v_pk_mul_f32 v[180:181], v[52:53], v[180:181] op_sel:[1,0] op_sel_hi:[1,1]
    v_pk_mul_f32 v[182:183], v[52:53], v[182:183] op_sel:[1,0] op_sel_hi:[1,1]
    v_exp_f32 v176, v176
    v_exp_f32 v177, v177
    v_exp_f32 v178, v178
    v_exp_f32 v179, v179
    v_exp_f32 v180, v180
    v_exp_f32 v181, v181
    v_exp_f32 v182, v182
    v_exp_f32 v183, v183
    v_pk_mul_f32 v[184:185], v[50:51], v[184:185] op_sel:[1,0] op_sel_hi:[1,1]
    v_pk_mul_f32 v[186:187], v[50:51], v[186:187] op_sel:[1,0] op_sel_hi:[1,1]
    v_pk_mul_f32 v[188:189], v[50:51], v[188:189] op_sel:[1,0] op_sel_hi:[1,1]
    v_pk_mul_f32 v[190:191], v[50:51], v[190:191] op_sel:[1,0] op_sel_hi:[1,1]
    v_pk_add_f32 v[176:177], v[58:59], v[176:177]
    v_pk_add_f32 v[178:179], v[58:59], v[178:179]
    v_pk_add_f32 v[180:181], v[58:59], v[180:181]
    v_pk_add_f32 v[182:183], v[58:59], v[182:183]
    v_rcp_f32 v176, v176
    v_rcp_f32 v177, v177
    v_rcp_f32 v178, v178
    v_rcp_f32 v179, v179
    v_rcp_f32 v180, v180
    v_rcp_f32 v181, v181
    v_rcp_f32 v182, v182
    v_rcp_f32 v183, v183
    v_pk_mul_f32 v[176:177], v[176:177], v[184:185]
    v_pk_mul_f32 v[178:179], v[178:179], v[186:187]
    v_pk_mul_f32 v[180:181], v[180:181], v[188:189]
    v_pk_mul_f32 v[182:183], v[182:183], v[190:191]
    v_cvt_pk_bf16_f32 v184, v176, v177
    v_cvt_pk_bf16_f32 v185, v178, v179
    v_cvt_pk_bf16_f32 v186, v180, v181
    v_cvt_pk_bf16_f32 v187, v182, v183
    s_add_u32 s38, s37, 117760
    buffer_store_dwordx4 v[184:187], v54, s[20:23], s38 offen sc1
    s_waitcnt vmcnt(0)
    s_barrier
    s_cmp_lg_u32 s3, 0
    s_cbranch_scc1 W0S14
    s_lshl_b32 s31, s90, 4
    s_add_u32 s31, s31, s91
    s_add_u32 s29, s5, 0
    s_mul_i32 s29, s29, 163840
    s_add_u32 s29, s29, 67207168
    s_lshl_b32 s28, s31, 7
    s_add_u32 s29, s29, s28
    v_mov_b32 v6, s29
    v_mov_b32 v7, s4
    s_mov_b64 exec, 1
    global_store_dword v6, v7, s[82:83] sc1
    s_mov_b64 exec, -1
W0S14:
C_P5:
    v_lshrrev_b32 v2, 4, v1
    v_and_b32 v3, 15, v1
    v_lshrrev_b32 v3, 2, v3
    v_lshrrev_b32 v4, 5, v1
    v_and_b32 v5, 31, v1
    s_add_u32 s24, s82, s6
    s_addc_u32 s25, s83, 0
    s_mov_b32 s26, 2097152
    s_mov_b32 s27, 0x20000
    s_and_b32 s33, s3, 1
    s_lshr_b32 s34, s3, 1
    s_lshl_b32 s35, s88, 6
    s_lshl_b32 s36, s33, 5
    s_add_u32 s35, s35, s36
    s_lshl_b32 s35, s35, 10
    s_lshl_b32 s36, s89, 7
    s_lshl_b32 s37, s34, 6
    s_add_u32 s36, s36, s37
    s_add_u32 s35, s35, s36
    s_lshl_b32 s41, s88, 3
    s_add_u32 s41, s41, s89
    s_lshl_b32 s41, s41, 13
    s_lshl_b32 s36, s34, 12
    s_add_u32 s41, s41, s36
    s_lshl_b32 s36, s33, 10
    s_add_u32 s41, s41, s36
    v_lshlrev_b32 v6, 4, v5
    v_lshlrev_b32 v7, 3, v4
    v_add_u32 v6, v6, v7
    buffer_load_dwordx2 v[48:49], v6, s[24:27], s41 offen offset:0 sc1
    buffer_load_dwordx2 v[50:51], v6, s[24:27], s41 offen offset:512 sc1
    buffer_load_dwordx2 v[52:53], v6, s[24:27], s41 offen offset:2048 sc1
    buffer_load_dwordx2 v[54:55], v6, s[24:27], s41 offen offset:2560 sc1
    s_lshl_b32 s36, s33, 13
    v_lshlrev_b32 v7, 4, v1
    v_add_u32 v7, s36, v7
    v_add_u32 v8, 0, v7
    v_add_u32 v9, 65536, v7
    v_add_u32 v10, 131072, v7
    v_lshlrev_b32 v7, 2, v4
    v_add_u32 v7, v7, v3
    v_lshlrev_b32 v7, 7, v7
    v_and_b32 v16, 3, v1
    v_lshlrev_b32 v16, 3, v16
    v_add_u32 v7, v7, v16
    v_lshrrev_b32 v16, 1, v3
    v_lshlrev_b32 v16, 6, v16
    s_lshl_b32 s36, s34, 6
    v_xor_b32 v16, s36, v16
    v_add_u32 v7, v7, v16
    v_and_b32 v16, 1, v2
    v_lshlrev_b32 v16, 5, v16
    v_add_u32 v7, v7, v16
    v_add_u32 v12, 0, v7
    v_add_u32 v13, 65536, v7
    v_add_u32 v14, 131072, v7
    s_cmp_lg_u32 s5, 0
    s_cbranch_scc1 PFQ_D15
    s_cmp_eq_u32 s3, 0
    s_cbranch_scc1 PFQ_D15
    s_mov_b32 s56, s66
    s_mov_b32 s57, s67
    s_mov_b32 s58, 1572864
    s_mov_b32 s59, 0x20000
    s_lshr_b32 s46, s2, 3
    s_lshl_b32 s46, s46, 2
    s_add_u32 s46, s46, s3
    s_lshl_b32 s46, s46, 2
    s_mul_i32 s46, s46, 3072
    s_and_b32 s47, s2, 1
    s_lshl_b32 s47, s47, 9
    s_add_u32 s46, s46, s47
    v_lshrrev_b32 v244, 4, v1
    v_lshlrev_b32 v244, 10, v244
    v_lshrrev_b32 v245, 2, v1
    v_and_b32 v245, 3, v245
    v_mul_u32_u24 v245, 3072, v245
    v_add_u32 v244, v244, v245
    v_and_b32 v245, 3, v1
    v_lshlrev_b32 v245, 7, v245
    v_add_u32 v244, v244, v245
    s_mov_b32 exec_hi, 0xffff
    buffer_load_dword v246, v244, s[56:59], s46 offen
    s_mov_b64 exec, -1
    s_cmp_lg_u32 s3, 3
    s_cbranch_scc1 PFQ_D15
    s_mov_b32 s56, s66
    s_mov_b32 s57, s67
    s_mov_b32 s58, 1572864
    s_mov_b32 s59, 0x20000
    s_lshr_b32 s46, s2, 3
    s_lshl_b32 s46, s46, 2
    s_add_u32 s46, s46, 0
    s_lshl_b32 s46, s46, 2
    s_mul_i32 s46, s46, 3072
    s_and_b32 s47, s2, 1
    s_lshl_b32 s47, s47, 9
    s_add_u32 s46, s46, s47
    v_lshrrev_b32 v244, 4, v1
    v_lshlrev_b32 v244, 10, v244
    v_lshrrev_b32 v245, 2, v1
    v_and_b32 v245, 3, v245
    v_mul_u32_u24 v245, 3072, v245
    v_add_u32 v244, v244, v245
    v_and_b32 v245, 3, v1
    v_lshlrev_b32 v245, 7, v245
    v_add_u32 v244, v244, v245
    s_mov_b32 exec_hi, 0xffff
    buffer_load_dword v246, v244, s[56:59], s46 offen
    s_mov_b64 exec, -1
PFQ_D15:
    s_cmp_lg_u32 s3, 0
    s_cbranch_scc1 W0S16
    s_lshr_b32 s31, s88, 1
    s_lshl_b32 s31, s31, 4
    s_add_u32 s29, s5, 0
    s_mul_i32 s29, s29, 163840
    s_add_u32 s29, s29, 67207168
    s_lshl_b32 s28, s31, 7
    s_add_u32 s29, s29, s28
    v_min_u32 v6, 13, v1
    v_lshlrev_b32 v6, 7, v6
    v_add_u32 v6, s29, v6
    s_mov_b32 s30, 20000
POLL17:
    global_load_dword v7, v6, s[82:83] sc1
    s_waitcnt vmcnt(0)
    v_cmp_ne_u32 vcc, s4, v7
    s_nop 4
    s_cbranch_vccz POLL17D
    s_sub_u32 s30, s30, 1
    s_cmp_lg_u32 s30, 0
    s_cbranch_scc1 POLL17
POLL17D:
W0S16:
    s_barrier
    s_waitcnt vmcnt(0)
    v_lshlrev_b32 v64, 16, v48
    v_and_b32 v65, 0xffff0000, v48
    v_lshlrev_b32 v66, 16, v49
    v_and_b32 v67, 0xffff0000, v49
    v_lshlrev_b32 v68, 16, v50
    v_and_b32 v69, 0xffff0000, v50
    v_lshlrev_b32 v70, 16, v51
    v_and_b32 v71, 0xffff0000, v51
    v_lshlrev_b32 v72, 16, v52
    v_and_b32 v73, 0xffff0000, v52
    v_lshlrev_b32 v74, 16, v53
    v_and_b32 v75, 0xffff0000, v53
    v_lshlrev_b32 v76, 16, v54
    v_and_b32 v77, 0xffff0000, v54
    v_lshlrev_b32 v78, 16, v55
    v_and_b32 v79, 0xffff0000, v55
    v_mov_b32 v80, 0
    v_mov_b32 v81, 0
    v_mov_b32 v82, 0
    v_mov_b32 v83, 0
    v_mov_b32 v84, 0
    v_mov_b32 v85, 0
    v_mov_b32 v86, 0
    v_mov_b32 v87, 0
    v_mov_b32 v88, 0
    v_mov_b32 v89, 0
    v_mov_b32 v90, 0
    v_mov_b32 v91, 0
    v_mov_b32 v92, 0
    v_mov_b32 v93, 0
    v_mov_b32 v94, 0
    v_mov_b32 v95, 0
    s_barrier
    ds_read_b128 v[96:99], v9 offset:32768
    ds_read_b64_tr_b16 v[100:101], v12 offset:0
    ds_read_b64_tr_b16 v[102:103], v12 offset:1024
    ds_read_b128 v[104:107], v9 offset:33792
    ds_read_b64_tr_b16 v[108:109], v12 offset:2048
    ds_read_b64_tr_b16 v[110:111], v12 offset:3072
    ds_read_b128 v[112:115], v9 offset:34816
    ds_read_b64_tr_b16 v[116:117], v12 offset:4096
    ds_read_b64_tr_b16 v[118:119], v12 offset:5120
    s_waitcnt lgkmcnt(6)
    v_mfma_f32_32x32x16_bf16 v[64:79], v[100:103], v[96:99], v[64:79]
    ds_read_b128 v[96:99], v9 offset:35840
    ds_read_b64_tr_b16 v[100:101], v12 offset:6144
    ds_read_b64_tr_b16 v[102:103], v12 offset:7168
    s_waitcnt lgkmcnt(6)
    v_mfma_f32_32x32x16_bf16 v[80:95], v[108:111], v[104:107], v[80:95]
    ds_read_b128 v[104:107], v9 offset:36864
    ds_read_b64_tr_b16 v[108:109], v12 offset:8192
    ds_read_b64_tr_b16 v[110:111], v12 offset:9216
    s_waitcnt lgkmcnt(6)
    v_mfma_f32_32x32x16_bf16 v[64:79], v[116:119], v[112:115], v[64:79]
    ds_read_b128 v[112:115], v9 offset:37888
    ds_read_b64_tr_b16 v[116:117], v12 offset:10240
    ds_read_b64_tr_b16 v[118:119], v12 offset:11264
    s_waitcnt lgkmcnt(6)
    v_mfma_f32_32x32x16_bf16 v[80:95], v[100:103], v[96:99], v[80:95]
    ds_read_b128 v[96:99], v9 offset:38912
    ds_read_b64_tr_b16 v[100:101], v12 offset:12288
    ds_read_b64_tr_b16 v[102:103], v12 offset:13312
    s_waitcnt lgkmcnt(6)
    v_mfma_f32_32x32x16_bf16 v[64:79], v[108:111], v[104:107], v[64:79]
    ds_read_b128 v[104:107], v9 offset:39936
    ds_read_b64_tr_b16 v[108:109], v12 offset:14336
    ds_read_b64_tr_b16 v[110:111], v12 offset:15360
    s_waitcnt lgkmcnt(6)
    v_mfma_f32_32x32x16_bf16 v[80:95], v[116:119], v[112:115], v[80:95]
    s_waitcnt lgkmcnt(0)
    s_barrier
    ds_read_b128 v[112:115], v9 offset:49152
    ds_read_b64_tr_b16 v[116:117], v12 offset:16384
    ds_read_b64_tr_b16 v[118:119], v12 offset:17408
    v_mfma_f32_32x32x16_bf16 v[64:79], v[100:103], v[96:99], v[64:79]
    ds_read_b128 v[96:99], v9 offset:50176
    ds_read_b64_tr_b16 v[100:101], v12 offset:18432
    ds_read_b64_tr_b16 v[102:103], v12 offset:19456
    s_waitcnt lgkmcnt(6)
    v_mfma_f32_32x32x16_bf16 v[80:95], v[108:111], v[104:107], v[80:95]
    ds_read_b128 v[104:107], v9 offset:51200
    ds_read_b64_tr_b16 v[108:109], v12 offset:20480
    ds_read_b64_tr_b16 v[110:111], v12 offset:21504
    s_waitcnt lgkmcnt(6)
    v_mfma_f32_32x32x16_bf16 v[64:79], v[116:119], v[112:115], v[64:79]
    ds_read_b128 v[112:115], v9 offset:52224
    ds_read_b64_tr_b16 v[116:117], v12 offset:22528
    ds_read_b64_tr_b16 v[118:119], v12 offset:23552
    s_waitcnt lgkmcnt(6)
    v_mfma_f32_32x32x16_bf16 v[80:95], v[100:103], v[96:99], v[80:95]
    ds_read_b128 v[96:99], v9 offset:53248
    ds_read_b64_tr_b16 v[100:101], v12 offset:24576
    ds_read_b64_tr_b16 v[102:103], v12 offset:25600
    s_waitcnt lgkmcnt(6)
    v_mfma_f32_32x32x16_bf16 v[64:79], v[108:111], v[104:107], v[64:79]
    ds_read_b128 v[104:107], v9 offset:54272
    ds_read_b64_tr_b16 v[108:109], v12 offset:26624
    ds_read_b64_tr_b16 v[110:111], v12 offset:27648
    s_waitcnt lgkmcnt(6)
    v_mfma_f32_32x32x16_bf16 v[80:95], v[116:119], v[112:115], v[80:95]
    ds_read_b128 v[112:115], v9 offset:55296
    ds_read_b64_tr_b16 v[116:117], v12 offset:28672
    ds_read_b64_tr_b16 v[118:119], v12 offset:29696
    s_waitcnt lgkmcnt(6)
    v_mfma_f32_32x32x16_bf16 v[64:79], v[100:103], v[96:99], v[64:79]
    ds_read_b128 v[96:99], v9 offset:56320
    ds_read_b64_tr_b16 v[100:101], v12 offset:30720
    ds_read_b64_tr_b16 v[102:103], v12 offset:31744
    s_waitcnt lgkmcnt(6)
    v_mfma_f32_32x32x16_bf16 v[80:95], v[108:111], v[104:107], v[80:95]
    s_waitcnt lgkmcnt(0)
    s_barrier
    ds_read_b128 v[104:107], v10 offset:0
    ds_read_b64_tr_b16 v[108:109], v12 offset:32768
    ds_read_b64_tr_b16 v[110:111], v12 offset:33792
    v_mfma_f32_32x32x16_bf16 v[64:79], v[116:119], v[112:115], v[64:79]
    ds_read_b128 v[112:115], v10 offset:1024
    ds_read_b64_tr_b16 v[116:117], v12 offset:34816
    ds_read_b64_tr_b16 v[118:119], v12 offset:35840
    s_waitcnt lgkmcnt(6)
    v_mfma_f32_32x32x16_bf16 v[80:95], v[100:103], v[96:99], v[80:95]
    ds_read_b128 v[96:99], v10 offset:2048
    ds_read_b64_tr_b16 v[100:101], v12 offset:36864
    ds_read_b64_tr_b16 v[102:103], v12 offset:37888
    s_waitcnt lgkmcnt(6)
    v_mfma_f32_32x32x16_bf16 v[64:79], v[108:111], v[104:107], v[64:79]
    ds_read_b128 v[104:107], v10 offset:3072
    ds_read_b64_tr_b16 v[108:109], v12 offset:38912
    ds_read_b64_tr_b16 v[110:111], v12 offset:39936
    s_waitcnt lgkmcnt(6)
    v_mfma_f32_32x32x16_bf16 v[80:95], v[116:119], v[112:115], v[80:95]
    ds_read_b128 v[112:115], v10 offset:4096
    ds_read_b64_tr_b16 v[116:117], v12 offset:40960
    ds_read_b64_tr_b16 v[118:119], v12 offset:41984
    s_waitcnt lgkmcnt(6)
    v_mfma_f32_32x32x16_bf16 v[64:79], v[100:103], v[96:99], v[64:79]
    ds_read_b128 v[96:99], v10 offset:5120
    ds_read_b64_tr_b16 v[100:101], v12 offset:43008
    ds_read_b64_tr_b16 v[102:103], v12 offset:44032
    s_waitcnt lgkmcnt(6)
    v_mfma_f32_32x32x16_bf16 v[80:95], v[108:111], v[104:107], v[80:95]
    ds_read_b128 v[104:107], v10 offset:6144
    ds_read_b64_tr_b16 v[108:109], v12 offset:45056
    ds_read_b64_tr_b16 v[110:111], v12 offset:46080
    s_waitcnt lgkmcnt(6)
    v_mfma_f32_32x32x16_bf16 v[64:79], v[116:119], v[112:115], v[64:79]
    ds_read_b128 v[112:115], v10 offset:7168
    ds_read_b64_tr_b16 v[116:117], v12 offset:47104
    ds_read_b64_tr_b16 v[118:119], v12 offset:48128
    s_waitcnt lgkmcnt(6)
    v_mfma_f32_32x32x16_bf16 v[80:95], v[100:103], v[96:99], v[80:95]
    s_waitcnt lgkmcnt(0)
    s_barrier
    ds_read_b128 v[96:99], v8 offset:0
    ds_read_b64_tr_b16 v[100:101], v12 offset:49152
    ds_read_b64_tr_b16 v[102:103], v12 offset:50176
    v_mfma_f32_32x32x16_bf16 v[64:79], v[108:111], v[104:107], v[64:79]
    ds_read_b128 v[104:107], v8 offset:1024
    ds_read_b64_tr_b16 v[108:109], v12 offset:51200
    ds_read_b64_tr_b16 v[110:111], v12 offset:52224
    s_waitcnt lgkmcnt(6)
    v_mfma_f32_32x32x16_bf16 v[80:95], v[116:119], v[112:115], v[80:95]
    ds_read_b128 v[112:115], v8 offset:2048
    ds_read_b64_tr_b16 v[116:117], v12 offset:53248
    ds_read_b64_tr_b16 v[118:119], v12 offset:54272
    s_waitcnt lgkmcnt(6)
    v_mfma_f32_32x32x16_bf16 v[64:79], v[100:103], v[96:99], v[64:79]
    ds_read_b128 v[96:99], v8 offset:3072
    ds_read_b64_tr_b16 v[100:101], v12 offset:55296
    ds_read_b64_tr_b16 v[102:103], v12 offset:56320
    s_waitcnt lgkmcnt(6)
    v_mfma_f32_32x32x16_bf16 v[80:95], v[108:111], v[104:107], v[80:95]
    ds_read_b128 v[104:107], v8 offset:4096
    ds_read_b64_tr_b16 v[108:109], v12 offset:57344
    ds_read_b64_tr_b16 v[110:111], v12 offset:58368
    s_waitcnt lgkmcnt(6)
    v_mfma_f32_32x32x16_bf16 v[64:79], v[116:119], v[112:115], v[64:79]
    ds_read_b128 v[112:115], v8 offset:5120
    ds_read_b64_tr_b16 v[116:117], v12 offset:59392
    ds_read_b64_tr_b16 v[118:119], v12 offset:60416
    s_waitcnt lgkmcnt(6)
    v_mfma_f32_32x32x16_bf16 v[80:95], v[100:103], v[96:99], v[80:95]
    ds_read_b128 v[96:99], v8 offset:6144
    ds_read_b64_tr_b16 v[100:101], v12 offset:61440
    ds_read_b64_tr_b16 v[102:103], v12 offset:62464
    s_waitcnt lgkmcnt(6)
    v_mfma_f32_32x32x16_bf16 v[64:79], v[108:111], v[104:107], v[64:79]
    ds_read_b128 v[104:107], v8 offset:7168
    ds_read_b64_tr_b16 v[108:109], v12 offset:63488
    ds_read_b64_tr_b16 v[110:111], v12 offset:64512
    s_waitcnt lgkmcnt(6)
    v_mfma_f32_32x32x16_bf16 v[80:95], v[116:119], v[112:115], v[80:95]
    s_waitcnt lgkmcnt(0)
    s_barrier
    ds_read_b128 v[112:115], v9 offset:32768
    ds_read_b64_tr_b16 v[116:117], v13 offset:0
    ds_read_b64_tr_b16 v[118:119], v13 offset:1024
    v_mfma_f32_32x32x16_bf16 v[64:79], v[100:103], v[96:99], v[64:79]
    ds_read_b128 v[96:99], v9 offset:33792
    ds_read_b64_tr_b16 v[100:101], v13 offset:2048
    ds_read_b64_tr_b16 v[102:103], v13 offset:3072
    s_waitcnt lgkmcnt(6)
    v_mfma_f32_32x32x16_bf16 v[80:95], v[108:111], v[104:107], v[80:95]
    ds_read_b128 v[104:107], v9 offset:34816
    ds_read_b64_tr_b16 v[108:109], v13 offset:4096
    ds_read_b64_tr_b16 v[110:111], v13 offset:5120
    s_waitcnt lgkmcnt(6)
    v_mfma_f32_32x32x16_bf16 v[64:79], v[116:119], v[112:115], v[64:79]
    ds_read_b128 v[112:115], v9 offset:35840
    ds_read_b64_tr_b16 v[116:117], v13 offset:6144
    ds_read_b64_tr_b16 v[118:119], v13 offset:7168
    s_waitcnt lgkmcnt(6)
    v_mfma_f32_32x32x16_bf16 v[80:95], v[100:103], v[96:99], v[80:95]
    ds_read_b128 v[96:99], v9 offset:36864
    ds_read_b64_tr_b16 v[100:101], v13 offset:8192
    ds_read_b64_tr_b16 v[102:103], v13 offset:9216
    s_waitcnt lgkmcnt(6)
    v_mfma_f32_32x32x16_bf16 v[64:79], v[108:111], v[104:107], v[64:79]
    ds_read_b128 v[104:107], v9 offset:37888
    ds_read_b64_tr_b16 v[108:109], v13 offset:10240
    ds_read_b64_tr_b16 v[110:111], v13 offset:11264
    s_waitcnt lgkmcnt(6)
    v_mfma_f32_32x32x16_bf16 v[80:95], v[116:119], v[112:115], v[80:95]
    ds_read_b128 v[112:115], v9 offset:38912
    ds_read_b64_tr_b16 v[116:117], v13 offset:12288
    ds_read_b64_tr_b16 v[118:119], v13 offset:13312
    s_waitcnt lgkmcnt(6)
    v_mfma_f32_32x32x16_bf16 v[64:79], v[100:103], v[96:99], v[64:79]
    ds_read_b128 v[96:99], v9 offset:39936
    ds_read_b64_tr_b16 v[100:101], v13 offset:14336
    ds_read_b64_tr_b16 v[102:103], v13 offset:15360
    s_waitcnt lgkmcnt(6)
    v_mfma_f32_32x32x16_bf16 v[80:95], v[108:111], v[104:107], v[80:95]
    s_waitcnt lgkmcnt(0)
    s_barrier
    ds_read_b128 v[104:107], v8 offset:16384
    ds_read_b64_tr_b16 v[108:109], v13 offset:16384
    ds_read_b64_tr_b16 v[110:111], v13 offset:17408
    v_mfma_f32_32x32x16_bf16 v[64:79], v[116:119], v[112:115], v[64:79]
    ds_read_b128 v[112:115], v8 offset:17408
    ds_read_b64_tr_b16 v[116:117], v13 offset:18432
    ds_read_b64_tr_b16 v[118:119], v13 offset:19456
    s_waitcnt lgkmcnt(6)
    v_mfma_f32_32x32x16_bf16 v[80:95], v[100:103], v[96:99], v[80:95]
    ds_read_b128 v[96:99], v8 offset:18432
    ds_read_b64_tr_b16 v[100:101], v13 offset:20480
    ds_read_b64_tr_b16 v[102:103], v13 offset:21504
    s_waitcnt lgkmcnt(6)
    v_mfma_f32_32x32x16_bf16 v[64:79], v[108:111], v[104:107], v[64:79]
    ds_read_b128 v[104:107], v8 offset:19456
    ds_read_b64_tr_b16 v[108:109], v13 offset:22528
    ds_read_b64_tr_b16 v[110:111], v13 offset:23552
    s_waitcnt lgkmcnt(6)
    v_mfma_f32_32x32x16_bf16 v[80:95], v[116:119], v[112:115], v[80:95]
    ds_read_b128 v[112:115], v8 offset:20480
    ds_read_b64_tr_b16 v[116:117], v13 offset:24576
    ds_read_b64_tr_b16 v[118:119], v13 offset:25600
    s_waitcnt lgkmcnt(6)
    v_mfma_f32_32x32x16_bf16 v[64:79], v[100:103], v[96:99], v[64:79]
    ds_read_b128 v[96:99], v8 offset:21504
    ds_read_b64_tr_b16 v[100:101], v13 offset:26624
    ds_read_b64_tr_b16 v[102:103], v13 offset:27648
    s_waitcnt lgkmcnt(6)
    v_mfma_f32_32x32x16_bf16 v[80:95], v[108:111], v[104:107], v[80:95]
    ds_read_b128 v[104:107], v8 offset:22528
    ds_read_b64_tr_b16 v[108:109], v13 offset:28672
    ds_read_b64_tr_b16 v[110:111], v13 offset:29696
    s_waitcnt lgkmcnt(6)
    v_mfma_f32_32x32x16_bf16 v[64:79], v[116:119], v[112:115], v[64:79]
    ds_read_b128 v[112:115], v8 offset:23552
    ds_read_b64_tr_b16 v[116:117], v13 offset:30720
    ds_read_b64_tr_b16 v[118:119], v13 offset:31744
    s_waitcnt lgkmcnt(6)
    v_mfma_f32_32x32x16_bf16 v[80:95], v[100:103], v[96:99], v[80:95]
    s_waitcnt lgkmcnt(0)
    s_barrier
    ds_read_b128 v[96:99], v8 offset:32768
    ds_read_b64_tr_b16 v[100:101], v13 offset:49152
    ds_read_b64_tr_b16 v[102:103], v13 offset:50176
    v_mfma_f32_32x32x16_bf16 v[64:79], v[108:111], v[104:107], v[64:79]
    ds_read_b128 v[104:107], v8 offset:33792
    ds_read_b64_tr_b16 v[108:109], v13 offset:51200
    ds_read_b64_tr_b16 v[110:111], v13 offset:52224
    s_waitcnt lgkmcnt(6)
    v_mfma_f32_32x32x16_bf16 v[80:95], v[116:119], v[112:115], v[80:95]
    ds_read_b128 v[112:115], v8 offset:34816
    ds_read_b64_tr_b16 v[116:117], v13 offset:53248
    ds_read_b64_tr_b16 v[118:119], v13 offset:54272
    s_waitcnt lgkmcnt(6)
    v_mfma_f32_32x32x16_bf16 v[64:79], v[100:103], v[96:99], v[64:79]
    ds_read_b128 v[96:99], v8 offset:35840
    ds_read_b64_tr_b16 v[100:101], v13 offset:55296
    ds_read_b64_tr_b16 v[102:103], v13 offset:56320
    s_waitcnt lgkmcnt(6)
    v_mfma_f32_32x32x16_bf16 v[80:95], v[108:111], v[104:107], v[80:95]
    ds_read_b128 v[104:107], v8 offset:36864
    ds_read_b64_tr_b16 v[108:109], v13 offset:57344
    ds_read_b64_tr_b16 v[110:111], v13 offset:58368
    s_waitcnt lgkmcnt(6)
    v_mfma_f32_32x32x16_bf16 v[64:79], v[116:119], v[112:115], v[64:79]
    ds_read_b128 v[112:115], v8 offset:37888
    ds_read_b64_tr_b16 v[116:117], v13 offset:59392
    ds_read_b64_tr_b16 v[118:119], v13 offset:60416
    s_waitcnt lgkmcnt(6)
    v_mfma_f32_32x32x16_bf16 v[80:95], v[100:103], v[96:99], v[80:95]
    ds_read_b128 v[96:99], v8 offset:38912
    ds_read_b64_tr_b16 v[100:101], v13 offset:61440
    ds_read_b64_tr_b16 v[102:103], v13 offset:62464
    s_waitcnt lgkmcnt(6)
    v_mfma_f32_32x32x16_bf16 v[64:79], v[108:111], v[104:107], v[64:79]
    ds_read_b128 v[104:107], v8 offset:39936
    ds_read_b64_tr_b16 v[108:109], v13 offset:63488
    ds_read_b64_tr_b16 v[110:111], v13 offset:64512
    s_waitcnt lgkmcnt(6)
    v_mfma_f32_32x32x16_bf16 v[80:95], v[116:119], v[112:115], v[80:95]
    s_waitcnt lgkmcnt(0)
    s_barrier
    ds_read_b128 v[112:115], v8 offset:49152
    ds_read_b64_tr_b16 v[116:117], v14 offset:0
    ds_read_b64_tr_b16 v[118:119], v14 offset:1024
    v_mfma_f32_32x32x16_bf16 v[64:79], v[100:103], v[96:99], v[64:79]
    ds_read_b128 v[96:99], v8 offset:50176
    ds_read_b64_tr_b16 v[100:101], v14 offset:2048
    ds_read_b64_tr_b16 v[102:103], v14 offset:3072
    s_waitcnt lgkmcnt(6)
    v_mfma_f32_32x32x16_bf16 v[80:95], v[108:111], v[104:107], v[80:95]
    ds_read_b128 v[104:107], v8 offset:51200
    ds_read_b64_tr_b16 v[108:109], v14 offset:4096
    ds_read_b64_tr_b16 v[110:111], v14 offset:5120
    s_waitcnt lgkmcnt(6)
    v_mfma_f32_32x32x16_bf16 v[64:79], v[116:119], v[112:115], v[64:79]
    ds_read_b128 v[112:115], v8 offset:52224
    ds_read_b64_tr_b16 v[116:117], v14 offset:6144
    ds_read_b64_tr_b16 v[118:119], v14 offset:7168
    s_waitcnt lgkmcnt(6)
    v_mfma_f32_32x32x16_bf16 v[80:95], v[100:103], v[96:99], v[80:95]
    ds_read_b128 v[96:99], v8 offset:53248
    ds_read_b64_tr_b16 v[100:101], v14 offset:8192
    ds_read_b64_tr_b16 v[102:103], v14 offset:9216
    s_waitcnt lgkmcnt(6)
    v_mfma_f32_32x32x16_bf16 v[64:79], v[108:111], v[104:107], v[64:79]
    ds_read_b128 v[104:107], v8 offset:54272
    ds_read_b64_tr_b16 v[108:109], v14 offset:10240
    ds_read_b64_tr_b16 v[110:111], v14 offset:11264
    s_waitcnt lgkmcnt(6)
    v_mfma_f32_32x32x16_bf16 v[80:95], v[116:119], v[112:115], v[80:95]
    ds_read_b128 v[112:115], v8 offset:55296
    ds_read_b64_tr_b16 v[116:117], v14 offset:12288
    ds_read_b64_tr_b16 v[118:119], v14 offset:13312
    s_waitcnt lgkmcnt(6)
    v_mfma_f32_32x32x16_bf16 v[64:79], v[100:103], v[96:99], v[64:79]
    ds_read_b128 v[96:99], v8 offset:56320
    ds_read_b64_tr_b16 v[100:101], v14 offset:14336
    ds_read_b64_tr_b16 v[102:103], v14 offset:15360
    s_waitcnt lgkmcnt(6)
    v_mfma_f32_32x32x16_bf16 v[80:95], v[108:111], v[104:107], v[80:95]
    s_waitcnt lgkmcnt(0)
    s_barrier
    ds_read_b128 v[104:107], v9 offset:0
    ds_read_b64_tr_b16 v[108:109], v12 offset:0
    ds_read_b64_tr_b16 v[110:111], v12 offset:1024
    v_mfma_f32_32x32x16_bf16 v[64:79], v[116:119], v[112:115], v[64:79]
    ds_read_b128 v[112:115], v9 offset:1024
    ds_read_b64_tr_b16 v[116:117], v12 offset:2048
    ds_read_b64_tr_b16 v[118:119], v12 offset:3072
    s_waitcnt lgkmcnt(6)
    v_mfma_f32_32x32x16_bf16 v[80:95], v[100:103], v[96:99], v[80:95]
    ds_read_b128 v[96:99], v9 offset:2048
    ds_read_b64_tr_b16 v[100:101], v12 offset:4096
    ds_read_b64_tr_b16 v[102:103], v12 offset:5120
    s_waitcnt lgkmcnt(6)
    v_mfma_f32_32x32x16_bf16 v[64:79], v[108:111], v[104:107], v[64:79]
    ds_read_b128 v[104:107], v9 offset:3072
    ds_read_b64_tr_b16 v[108:109], v12 offset:6144
    ds_read_b64_tr_b16 v[110:111], v12 offset:7168
    s_waitcnt lgkmcnt(6)
    v_mfma_f32_32x32x16_bf16 v[80:95], v[116:119], v[112:115], v[80:95]
    ds_read_b128 v[112:115], v9 offset:4096
    ds_read_b64_tr_b16 v[116:117], v12 offset:8192
    ds_read_b64_tr_b16 v[118:119], v12 offset:9216
    s_waitcnt lgkmcnt(6)
    v_mfma_f32_32x32x16_bf16 v[64:79], v[100:103], v[96:99], v[64:79]
    ds_read_b128 v[96:99], v9 offset:5120
    ds_read_b64_tr_b16 v[100:101], v12 offset:10240
    ds_read_b64_tr_b16 v[102:103], v12 offset:11264
    s_waitcnt lgkmcnt(6)
    v_mfma_f32_32x32x16_bf16 v[80:95], v[108:111], v[104:107], v[80:95]
    ds_read_b128 v[104:107], v9 offset:6144
    ds_read_b64_tr_b16 v[108:109], v12 offset:12288
    ds_read_b64_tr_b16 v[110:111], v12 offset:13312
    s_waitcnt lgkmcnt(6)
    v_mfma_f32_32x32x16_bf16 v[64:79], v[116:119], v[112:115], v[64:79]
    ds_read_b128 v[112:115], v9 offset:7168
    ds_read_b64_tr_b16 v[116:117], v12 offset:14336
    ds_read_b64_tr_b16 v[118:119], v12 offset:15360
    s_waitcnt lgkmcnt(6)
    v_mfma_f32_32x32x16_bf16 v[80:95], v[100:103], v[96:99], v[80:95]
    s_waitcnt lgkmcnt(0)
    s_barrier
    ds_read_b128 v[96:99], v9 offset:16384
    ds_read_b64_tr_b16 v[100:101], v13 offset:32768
    ds_read_b64_tr_b16 v[102:103], v13 offset:33792
    v_mfma_f32_32x32x16_bf16 v[64:79], v[108:111], v[104:107], v[64:79]
    ds_read_b128 v[104:107], v9 offset:17408
    ds_read_b64_tr_b16 v[108:109], v13 offset:34816
    ds_read_b64_tr_b16 v[110:111], v13 offset:35840
    s_waitcnt lgkmcnt(6)
    v_mfma_f32_32x32x16_bf16 v[80:95], v[116:119], v[112:115], v[80:95]
    ds_read_b128 v[112:115], v9 offset:18432
    ds_read_b64_tr_b16 v[116:117], v13 offset:36864
    ds_read_b64_tr_b16 v[118:119], v13 offset:37888
    s_waitcnt lgkmcnt(6)
    v_mfma_f32_32x32x16_bf16 v[64:79], v[100:103], v[96:99], v[64:79]
    ds_read_b128 v[96:99], v9 offset:19456
    ds_read_b64_tr_b16 v[100:101], v13 offset:38912
    ds_read_b64_tr_b16 v[102:103], v13 offset:39936
    s_waitcnt lgkmcnt(6)
    v_mfma_f32_32x32x16_bf16 v[80:95], v[108:111], v[104:107], v[80:95]
    ds_read_b128 v[104:107], v9 offset:20480
    ds_read_b64_tr_b16 v[108:109], v13 offset:40960
    ds_read_b64_tr_b16 v[110:111], v13 offset:41984
    s_waitcnt lgkmcnt(6)
    v_mfma_f32_32x32x16_bf16 v[64:79], v[116:119], v[112:115], v[64:79]
    ds_read_b128 v[112:115], v9 offset:21504
    ds_read_b64_tr_b16 v[116:117], v13 offset:43008
    ds_read_b64_tr_b16 v[118:119], v13 offset:44032
    s_waitcnt lgkmcnt(6)
    v_mfma_f32_32x32x16_bf16 v[80:95], v[100:103], v[96:99], v[80:95]
    ds_read_b128 v[96:99], v9 offset:22528
    ds_read_b64_tr_b16 v[100:101], v13 offset:45056
    ds_read_b64_tr_b16 v[102:103], v13 offset:46080
    s_waitcnt lgkmcnt(6)
    v_mfma_f32_32x32x16_bf16 v[64:79], v[108:111], v[104:107], v[64:79]
    ds_read_b128 v[104:107], v9 offset:23552
    ds_read_b64_tr_b16 v[108:109], v13 offset:47104
    ds_read_b64_tr_b16 v[110:111], v13 offset:48128
    s_waitcnt lgkmcnt(6)
    v_mfma_f32_32x32x16_bf16 v[80:95], v[116:119], v[112:115], v[80:95]
    s_waitcnt lgkmcnt(0)
    s_barrier
    ds_read_b128 v[112:115], v9 offset:49152
    ds_read_b64_tr_b16 v[116:117], v12 offset:16384
    ds_read_b64_tr_b16 v[118:119], v12 offset:17408
    v_mfma_f32_32x32x16_bf16 v[64:79], v[100:103], v[96:99], v[64:79]
    ds_read_b128 v[96:99], v9 offset:50176
    ds_read_b64_tr_b16 v[100:101], v12 offset:18432
    ds_read_b64_tr_b16 v[102:103], v12 offset:19456
    s_waitcnt lgkmcnt(6)
    v_mfma_f32_32x32x16_bf16 v[80:95], v[108:111], v[104:107], v[80:95]
    ds_read_b128 v[104:107], v9 offset:51200
    ds_read_b64_tr_b16 v[108:109], v12 offset:20480
    ds_read_b64_tr_b16 v[110:111], v12 offset:21504
    s_waitcnt lgkmcnt(6)
    v_mfma_f32_32x32x16_bf16 v[64:79], v[116:119], v[112:115], v[64:79]
    ds_read_b128 v[112:115], v9 offset:52224
    ds_read_b64_tr_b16 v[116:117], v12 offset:22528
    ds_read_b64_tr_b16 v[118:119], v12 offset:23552
    s_waitcnt lgkmcnt(6)
    v_mfma_f32_32x32x16_bf16 v[80:95], v[100:103], v[96:99], v[80:95]
    ds_read_b128 v[96:99], v9 offset:53248
    ds_read_b64_tr_b16 v[100:101], v12 offset:24576
    ds_read_b64_tr_b16 v[102:103], v12 offset:25600
    s_waitcnt lgkmcnt(6)
    v_mfma_f32_32x32x16_bf16 v[64:79], v[108:111], v[104:107], v[64:79]
    ds_read_b128 v[104:107], v9 offset:54272
    ds_read_b64_tr_b16 v[108:109], v12 offset:26624
    ds_read_b64_tr_b16 v[110:111], v12 offset:27648
    s_waitcnt lgkmcnt(6)
    v_mfma_f32_32x32x16_bf16 v[80:95], v[116:119], v[112:115], v[80:95]
    ds_read_b128 v[112:115], v9 offset:55296
    ds_read_b64_tr_b16 v[116:117], v12 offset:28672
    ds_read_b64_tr_b16 v[118:119], v12 offset:29696
    s_waitcnt lgkmcnt(6)
    v_mfma_f32_32x32x16_bf16 v[64:79], v[100:103], v[96:99], v[64:79]
    ds_read_b128 v[96:99], v9 offset:56320
    ds_read_b64_tr_b16 v[100:101], v12 offset:30720
    ds_read_b64_tr_b16 v[102:103], v12 offset:31744
    s_waitcnt lgkmcnt(6)
    v_mfma_f32_32x32x16_bf16 v[80:95], v[108:111], v[104:107], v[80:95]
    s_waitcnt lgkmcnt(0)
    s_barrier
    ds_read_b128 v[104:107], v10 offset:0
    ds_read_b64_tr_b16 v[108:109], v12 offset:32768
    ds_read_b64_tr_b16 v[110:111], v12 offset:33792
    v_mfma_f32_32x32x16_bf16 v[64:79], v[116:119], v[112:115], v[64:79]
    ds_read_b128 v[112:115], v10 offset:1024
    ds_read_b64_tr_b16 v[116:117], v12 offset:34816
    ds_read_b64_tr_b16 v[118:119], v12 offset:35840
    s_waitcnt lgkmcnt(6)
    v_mfma_f32_32x32x16_bf16 v[80:95], v[100:103], v[96:99], v[80:95]
    ds_read_b128 v[96:99], v10 offset:2048
    ds_read_b64_tr_b16 v[100:101], v12 offset:36864
    ds_read_b64_tr_b16 v[102:103], v12 offset:37888
    s_waitcnt lgkmcnt(6)
    v_mfma_f32_32x32x16_bf16 v[64:79], v[108:111], v[104:107], v[64:79]
    ds_read_b128 v[104:107], v10 offset:3072
    ds_read_b64_tr_b16 v[108:109], v12 offset:38912
    ds_read_b64_tr_b16 v[110:111], v12 offset:39936
    s_waitcnt lgkmcnt(6)
    v_mfma_f32_32x32x16_bf16 v[80:95], v[116:119], v[112:115], v[80:95]
    ds_read_b128 v[112:115], v10 offset:4096
    ds_read_b64_tr_b16 v[116:117], v12 offset:40960
    ds_read_b64_tr_b16 v[118:119], v12 offset:41984
    s_waitcnt lgkmcnt(6)
    v_mfma_f32_32x32x16_bf16 v[64:79], v[100:103], v[96:99], v[64:79]
    ds_read_b128 v[96:99], v10 offset:5120
    ds_read_b64_tr_b16 v[100:101], v12 offset:43008
    ds_read_b64_tr_b16 v[102:103], v12 offset:44032
    s_waitcnt lgkmcnt(6)
    v_mfma_f32_32x32x16_bf16 v[80:95], v[108:111], v[104:107], v[80:95]
    ds_read_b128 v[104:107], v10 offset:6144
    ds_read_b64_tr_b16 v[108:109], v12 offset:45056
    ds_read_b64_tr_b16 v[110:111], v12 offset:46080
    s_waitcnt lgkmcnt(6)
    v_mfma_f32_32x32x16_bf16 v[64:79], v[116:119], v[112:115], v[64:79]
    ds_read_b128 v[112:115], v10 offset:7168
    ds_read_b64_tr_b16 v[116:117], v12 offset:47104
    ds_read_b64_tr_b16 v[118:119], v12 offset:48128
    s_waitcnt lgkmcnt(6)
    v_mfma_f32_32x32x16_bf16 v[80:95], v[100:103], v[96:99], v[80:95]
    s_waitcnt lgkmcnt(0)
    s_barrier
    ds_read_b128 v[96:99], v8 offset:0
    ds_read_b64_tr_b16 v[100:101], v12 offset:49152
    ds_read_b64_tr_b16 v[102:103], v12 offset:50176
    v_mfma_f32_32x32x16_bf16 v[64:79], v[108:111], v[104:107], v[64:79]
    ds_read_b128 v[104:107], v8 offset:1024
    ds_read_b64_tr_b16 v[108:109], v12 offset:51200
    ds_read_b64_tr_b16 v[110:111], v12 offset:52224
    s_waitcnt lgkmcnt(6)
    v_mfma_f32_32x32x16_bf16 v[80:95], v[116:119], v[112:115], v[80:95]
    ds_read_b128 v[112:115], v8 offset:2048
    ds_read_b64_tr_b16 v[116:117], v12 offset:53248
    ds_read_b64_tr_b16 v[118:119], v12 offset:54272
    s_waitcnt lgkmcnt(6)
    v_mfma_f32_32x32x16_bf16 v[64:79], v[100:103], v[96:99], v[64:79]
    ds_read_b128 v[96:99], v8 offset:3072
    ds_read_b64_tr_b16 v[100:101], v12 offset:55296
    ds_read_b64_tr_b16 v[102:103], v12 offset:56320
    s_waitcnt lgkmcnt(6)
    v_mfma_f32_32x32x16_bf16 v[80:95], v[108:111], v[104:107], v[80:95]
    ds_read_b128 v[104:107], v8 offset:4096
    ds_read_b64_tr_b16 v[108:109], v12 offset:57344
    ds_read_b64_tr_b16 v[110:111], v12 offset:58368
    s_waitcnt lgkmcnt(6)
    v_mfma_f32_32x32x16_bf16 v[64:79], v[116:119], v[112:115], v[64:79]
    ds_read_b128 v[112:115], v8 offset:5120
    ds_read_b64_tr_b16 v[116:117], v12 offset:59392
    ds_read_b64_tr_b16 v[118:119], v12 offset:60416
    s_waitcnt lgkmcnt(6)
    v_mfma_f32_32x32x16_bf16 v[80:95], v[100:103], v[96:99], v[80:95]
    ds_read_b128 v[96:99], v8 offset:6144
    ds_read_b64_tr_b16 v[100:101], v12 offset:61440
    ds_read_b64_tr_b16 v[102:103], v12 offset:62464
    s_waitcnt lgkmcnt(6)
    v_mfma_f32_32x32x16_bf16 v[64:79], v[108:111], v[104:107], v[64:79]
    ds_read_b128 v[104:107], v8 offset:7168
    ds_read_b64_tr_b16 v[108:109], v12 offset:63488
    ds_read_b64_tr_b16 v[110:111], v12 offset:64512
    s_waitcnt lgkmcnt(6)
    v_mfma_f32_32x32x16_bf16 v[80:95], v[116:119], v[112:115], v[80:95]
    s_waitcnt lgkmcnt(0)
    s_barrier
    ds_read_b128 v[112:115], v9 offset:32768
    ds_read_b64_tr_b16 v[116:117], v13 offset:0
    ds_read_b64_tr_b16 v[118:119], v13 offset:1024
    v_mfma_f32_32x32x16_bf16 v[64:79], v[100:103], v[96:99], v[64:79]
    ds_read_b128 v[96:99], v9 offset:33792
    ds_read_b64_tr_b16 v[100:101], v13 offset:2048
    ds_read_b64_tr_b16 v[102:103], v13 offset:3072
    s_waitcnt lgkmcnt(6)
    v_mfma_f32_32x32x16_bf16 v[80:95], v[108:111], v[104:107], v[80:95]
    ds_read_b128 v[104:107], v9 offset:34816
    ds_read_b64_tr_b16 v[108:109], v13 offset:4096
    ds_read_b64_tr_b16 v[110:111], v13 offset:5120
    s_waitcnt lgkmcnt(6)
    v_mfma_f32_32x32x16_bf16 v[64:79], v[116:119], v[112:115], v[64:79]
    ds_read_b128 v[112:115], v9 offset:35840
    ds_read_b64_tr_b16 v[116:117], v13 offset:6144
    ds_read_b64_tr_b16 v[118:119], v13 offset:7168
    s_waitcnt lgkmcnt(6)
    v_mfma_f32_32x32x16_bf16 v[80:95], v[100:103], v[96:99], v[80:95]
    ds_read_b128 v[96:99], v9 offset:36864
    ds_read_b64_tr_b16 v[100:101], v13 offset:8192
    ds_read_b64_tr_b16 v[102:103], v13 offset:9216
    s_waitcnt lgkmcnt(6)
    v_mfma_f32_32x32x16_bf16 v[64:79], v[108:111], v[104:107], v[64:79]
    ds_read_b128 v[104:107], v9 offset:37888
    ds_read_b64_tr_b16 v[108:109], v13 offset:10240
    ds_read_b64_tr_b16 v[110:111], v13 offset:11264
    s_waitcnt lgkmcnt(6)
    v_mfma_f32_32x32x16_bf16 v[80:95], v[116:119], v[112:115], v[80:95]
    ds_read_b128 v[112:115], v9 offset:38912
    ds_read_b64_tr_b16 v[116:117], v13 offset:12288
    ds_read_b64_tr_b16 v[118:119], v13 offset:13312
    s_waitcnt lgkmcnt(6)
    v_mfma_f32_32x32x16_bf16 v[64:79], v[100:103], v[96:99], v[64:79]
    ds_read_b128 v[96:99], v9 offset:39936
    ds_read_b64_tr_b16 v[100:101], v13 offset:14336
    ds_read_b64_tr_b16 v[102:103], v13 offset:15360
    s_waitcnt lgkmcnt(6)
    v_mfma_f32_32x32x16_bf16 v[80:95], v[108:111], v[104:107], v[80:95]
    s_waitcnt lgkmcnt(3)
    v_mfma_f32_32x32x16_bf16 v[64:79], v[116:119], v[112:115], v[64:79]
    s_waitcnt lgkmcnt(0)
    v_mfma_f32_32x32x16_bf16 v[80:95], v[100:103], v[96:99], v[80:95]
    s_add_u32 s20, s82, 2097152
    s_addc_u32 s21, s83, 0
    s_cmp_eq_u32 s5, 1
    s_cselect_b32 s20, s78, s20
    s_cselect_b32 s21, s79, s21
    s_mov_b32 s22, 2097152
    s_mov_b32 s23, 0x20000
    s_add_u32 s24, s82, s6
    s_addc_u32 s25, s83, 0
    s_add_u32 s24, s24, 22020096
    s_addc_u32 s25, s25, 0
    s_mov_b32 s26, 262144
    s_mov_b32 s27, 0x20000
    v_add_f32 v64, v64, v80
    v_add_f32 v65, v65, v81
    v_add_f32 v66, v66, v82
    v_add_f32 v67, v67, v83
    v_add_f32 v68, v68, v84
    v_add_f32 v69, v69, v85
    v_add_f32 v70, v70, v86
    v_add_f32 v71, v71, v87
    v_add_f32 v72, v72, v88
    v_add_f32 v73, v73, v89
    v_add_f32 v74, v74, v90
    v_add_f32 v75, v75, v91
    v_add_f32 v76, v76, v92
    v_add_f32 v77, v77, v93
    v_add_f32 v78, v78, v94
    v_add_f32 v79, v79, v95
    v_cvt_pk_bf16_f32 v48, v64, v65
    v_cvt_pk_bf16_f32 v49, v66, v67
    v_cvt_pk_bf16_f32 v50, v68, v69
    v_cvt_pk_bf16_f32 v51, v70, v71
    v_cvt_pk_bf16_f32 v52, v72, v73
    v_cvt_pk_bf16_f32 v53, v74, v75
    v_cvt_pk_bf16_f32 v54, v76, v77
    v_cvt_pk_bf16_f32 v55, v78, v79
    v_permlane32_swap_b32 v48, v50
    v_permlane32_swap_b32 v49, v51
    v_permlane32_swap_b32 v52, v54
    v_permlane32_swap_b32 v53, v55
    s_cmp_eq_u32 s5, 0
    s_cselect_b32 s42, 16, 1024
    s_cselect_b32 s43, 512, 16
    s_cselect_b32 s44, s41, s35
    s_cselect_b32 s45, 2048, 32
    v_mul_u32_u24 v6, s42, v5
    v_mul_u32_u24 v7, s43, v4
    v_add_u32 v6, v6, v7
    s_cbranch_scc1 P5ST_L0
    buffer_store_dwordx4 v[48:51], v6, s[20:23], s44 offen
    s_add_u32 s44, s44, s45
    buffer_store_dwordx4 v[52:55], v6, s[20:23], s44 offen
    s_endpgm
P5ST_L0:
    buffer_store_dwordx4 v[48:51], v6, s[20:23], s44 offen sc1
    s_add_u32 s44, s44, s45
    buffer_store_dwordx4 v[52:55], v6, s[20:23], s44 offen sc1
    v_pk_add_f32 v[96:97], v[64:65], v[66:67]
    v_pk_mul_f32 v[98:99], v[64:65], v[64:65]
    v_pk_fma_f32 v[98:99], v[66:67], v[66:67], v[98:99]
    v_pk_add_f32 v[96:97], v[96:97], v[68:69]
    v_pk_fma_f32 v[98:99], v[68:69], v[68:69], v[98:99]
    v_pk_add_f32 v[96:97], v[96:97], v[70:71]
    v_pk_fma_f32 v[98:99], v[70:71], v[70:71], v[98:99]
    v_pk_add_f32 v[96:97], v[96:97], v[72:73]
    v_pk_fma_f32 v[98:99], v[72:73], v[72:73], v[98:99]
    v_pk_add_f32 v[96:97], v[96:97], v[74:75]
    v_pk_fma_f32 v[98:99], v[74:75], v[74:75], v[98:99]
    v_pk_add_f32 v[96:97], v[96:97], v[76:77]
    v_pk_fma_f32 v[98:99], v[76:77], v[76:77], v[98:99]
    v_pk_add_f32 v[96:97], v[96:97], v[78:79]
    v_pk_fma_f32 v[98:99], v[78:79], v[78:79], v[98:99]
    v_add_f32 v100, v96, v97
    v_add_f32 v101, v98, v99
    v_mov_b32 v102, v100
    v_mov_b32 v103, v101
    s_nop 0
    v_permlane32_swap_b32 v100, v102
    v_permlane32_swap_b32 v101, v103
    v_add_f32 v100, v100, v102
    v_add_f32 v101, v101, v103
    s_lshl_b32 s36, s88, 1
    s_add_u32 s36, s36, s33
    s_lshl_b32 s36, s36, 12
    s_lshl_b32 s37, s89, 1
    s_add_u32 s37, s37, s34
    s_lshl_b32 s37, s37, 8
    s_add_u32 s36, s36, s37
    v_lshlrev_b32 v6, 3, v5
    s_mov_b64 exec, 0xffffffff
    buffer_store_dwordx2 v[100:101], v6, s[24:27], s36 offen sc1
    s_mov_b64 exec, -1
    s_waitcnt vmcnt(0)
    s_cmp_eq_u32 s5, 1
    s_cbranch_scc1 C_FIN
    s_barrier
    s_cmp_lg_u32 s3, 0
    s_cbranch_scc1 W0S18
    s_lshl_b32 s31, s88, 3
    s_add_u32 s31, s31, s89
    s_add_u32 s29, s5, 0
    s_mul_i32 s29, s29, 163840
    s_add_u32 s29, s29, 67239936
    s_lshl_b32 s28, s31, 7
    s_add_u32 s29, s29, s28
    v_mov_b32 v6, s29
    v_mov_b32 v7, s4
    s_mov_b64 exec, 1
    global_store_dword v6, v7, s[82:83] sc1
    s_mov_b64 exec, -1
W0S18:
    s_mov_b32 s5, 1
    s_mov_b32 s6, 33554432
    s_branch C_P1
C_FIN:
    s_endpgm
H_P1B:
    s_add_u32 s8, s82, 2097152
    s_addc_u32 s9, s83, 0
    s_cmp_eq_u32 s5, 0
    s_cselect_b32 s8, s64, s8
    s_cselect_b32 s9, s65, s9
    s_mov_b32 s10, 2097152
    s_mov_b32 s11, 0x20000
    s_add_u32 s24, s82, 22020096
    s_addc_u32 s25, s83, 0
    s_mov_b32 s26, 262144
    s_mov_b32 s27, 0x20000
    s_barrier
    s_add_u32 m0, s38, 0
    s_add_u32 s40, s36, 0
    buffer_load_dwordx4 v8, s[8:11], s40 offen sc1 lds
    s_add_u32 m0, s38, 1024
    s_add_u32 s40, s36, 1024
    buffer_load_dwordx4 v9, s[8:11], s40 offen sc1 lds
    s_add_u32 m0, s38, 8192
    s_add_u32 s40, s36, 8192
    buffer_load_dwordx4 v8, s[8:11], s40 offen sc1 lds
    s_add_u32 m0, s38, 9216
    s_add_u32 s40, s36, 9216
    buffer_load_dwordx4 v9, s[8:11], s40 offen sc1 lds
    s_add_u32 m0, s38, 16384
    s_add_u32 s40, s36, 16384
    buffer_load_dwordx4 v8, s[8:11], s40 offen sc1 lds
    s_add_u32 m0, s38, 17408
    s_add_u32 s40, s36, 17408
    buffer_load_dwordx4 v9, s[8:11], s40 offen sc1 lds
    s_add_u32 m0, s38, 24576
    s_add_u32 s40, s36, 24576
    buffer_load_dwordx4 v8, s[8:11], s40 offen sc1 lds
    s_add_u32 m0, s38, 25600
    s_add_u32 s40, s36, 25600
    buffer_load_dwordx4 v9, s[8:11], s40 offen sc1 lds
    s_add_u32 m0, s38, 32768
    s_add_u32 s40, s36, 32768
    buffer_load_dwordx4 v8, s[8:11], s40 offen sc1 lds
    s_add_u32 m0, s38, 33792
    s_add_u32 s40, s36, 33792
    buffer_load_dwordx4 v9, s[8:11], s40 offen sc1 lds
    s_add_u32 m0, s38, 40960
    s_add_u32 s40, s36, 40960
    buffer_load_dwordx4 v8, s[8:11], s40 offen sc1 lds
    s_add_u32 m0, s38, 41984
    s_add_u32 s40, s36, 41984
    buffer_load_dwordx4 v9, s[8:11], s40 offen sc1 lds
    s_setprio 2
    s_waitcnt vmcnt(10)
    s_barrier
    s_waitcnt vmcnt(8)
    s_barrier
    s_add_u32 m0, s38, 0
    s_add_u32 s40, s36, 49152
    buffer_load_dwordx4 v8, s[8:11], s40 offen sc1 lds
    s_add_u32 m0, s38, 1024
    s_add_u32 s40, s36, 50176
    buffer_load_dwordx4 v9, s[8:11], s40 offen sc1 lds
    s_add_u32 m0, s39, 0
    s_add_u32 s40, s37, 786432
    buffer_load_dwordx4 v10, s[12:15], s40 offen lds
    s_add_u32 m0, s39, 1024
    s_add_u32 s40, s37, 811008
    buffer_load_dwordx4 v10, s[12:15], s40 offen lds
    s_add_u32 m0, s39, 8192
    s_add_u32 s40, s37, 787456
    buffer_load_dwordx4 v10, s[12:15], s40 offen lds
    s_add_u32 m0, s39, 9216
    s_add_u32 s40, s37, 812032
    buffer_load_dwordx4 v10, s[12:15], s40 offen lds
    s_add_u32 m0, s39, 16384
    s_add_u32 s40, s37, 788480
    buffer_load_dwordx4 v10, s[12:15], s40 offen lds
    s_add_u32 m0, s39, 17408
    s_add_u32 s40, s37, 813056
    buffer_load_dwordx4 v10, s[12:15], s40 offen lds
    s_waitcnt vmcnt(14)
    s_barrier
    s_add_u32 m0, s38, 8192
    s_add_u32 s40, s36, 57344
    buffer_load_dwordx4 v8, s[8:11], s40 offen sc1 lds
    s_add_u32 m0, s38, 9216
    s_add_u32 s40, s36, 58368
    buffer_load_dwordx4 v9, s[8:11], s40 offen sc1 lds
    s_add_u32 m0, s39, 24576
    s_add_u32 s40, s37, 983040
    buffer_load_dwordx4 v10, s[12:15], s40 offen lds
    s_add_u32 m0, s39, 25600
    s_add_u32 s40, s37, 1007616
    buffer_load_dwordx4 v10, s[12:15], s40 offen lds
    s_add_u32 m0, s39, 32768
    s_add_u32 s40, s37, 984064
    buffer_load_dwordx4 v10, s[12:15], s40 offen lds
    s_add_u32 m0, s39, 33792
    s_add_u32 s40, s37, 1008640
    buffer_load_dwordx4 v10, s[12:15], s40 offen lds
    s_add_u32 m0, s39, 40960
    s_add_u32 s40, s37, 985088
    buffer_load_dwordx4 v10, s[12:15], s40 offen lds
    s_add_u32 m0, s39, 41984
    s_add_u32 s40, s37, 1009664
    buffer_load_dwordx4 v10, s[12:15], s40 offen lds
    s_waitcnt vmcnt(20)
    s_barrier
    s_add_u32 m0, s39, 49152
    s_add_u32 s40, s37, 1179648
    buffer_load_dwordx4 v10, s[12:15], s40 offen lds
    s_add_u32 m0, s39, 50176
    s_add_u32 s40, s37, 1204224
    buffer_load_dwordx4 v10, s[12:15], s40 offen lds
    s_add_u32 m0, s39, 57344
    s_add_u32 s40, s37, 1180672
    buffer_load_dwordx4 v10, s[12:15], s40 offen lds
    s_add_u32 m0, s39, 58368
    s_add_u32 s40, s37, 1205248
    buffer_load_dwordx4 v10, s[12:15], s40 offen lds
    s_add_u32 m0, s39, 65536
    s_add_u32 s40, s37, 1181696
    buffer_load_dwordx4 v10, s[12:15], s40 offen lds
    s_add_u32 m0, s39, 66560
    s_add_u32 s40, s37, 1206272
    buffer_load_dwordx4 v10, s[12:15], s40 offen lds
    s_waitcnt vmcnt(14)
    s_barrier
    s_add_u32 m0, s39, 73728
    s_add_u32 s40, s37, 1376256
    buffer_load_dwordx4 v10, s[12:15], s40 offen lds
    s_add_u32 m0, s39, 74752
    s_add_u32 s40, s37, 1400832
    buffer_load_dwordx4 v10, s[12:15], s40 offen lds
    s_add_u32 m0, s39, 81920
    s_add_u32 s40, s37, 1377280
    buffer_load_dwordx4 v10, s[12:15], s40 offen lds
    s_add_u32 m0, s39, 82944
    s_add_u32 s40, s37, 1401856
    buffer_load_dwordx4 v10, s[12:15], s40 offen lds
    s_add_u32 m0, s39, 90112
    s_add_u32 s40, s37, 1378304
    buffer_load_dwordx4 v10, s[12:15], s40 offen lds
    s_add_u32 m0, s39, 91136
    s_add_u32 s40, s37, 1402880
    buffer_load_dwordx4 v10, s[12:15], s40 offen lds
    s_mul_i32 s45, s85, 2
    s_and_b32 s46, s33, 1
    s_add_u32 s45, s45, s46
    s_lshl_b32 s45, s45, 12
    v_lshlrev_b32 v15, 11, v4
    v_lshlrev_b32 v14, 3, v5
    v_add_u32 v15, v15, v14
    buffer_load_dwordx2 v[128:129], v15, s[24:27], s45 offen offset:0 sc1
    buffer_load_dwordx2 v[130:131], v15, s[24:27], s45 offen offset:256 sc1
    buffer_load_dwordx2 v[132:133], v15, s[24:27], s45 offen offset:512 sc1
    buffer_load_dwordx2 v[134:135], v15, s[24:27], s45 offen offset:768 sc1
    buffer_load_dwordx2 v[136:137], v15, s[24:27], s45 offen offset:1024 sc1
    buffer_load_dwordx2 v[138:139], v15, s[24:27], s45 offen offset:1280 sc1
    buffer_load_dwordx2 v[140:141], v15, s[24:27], s45 offen offset:1536 sc1
    buffer_load_dwordx2 v[142:143], v15, s[24:27], s45 offen offset:1792 sc1
    s_waitcnt vmcnt(20)
    s_barrier
    s_waitcnt vmcnt(14)
    s_barrier
    s_waitcnt vmcnt(8)
    s_barrier
    s_waitcnt vmcnt(0)
    v_add_f32 v128, v128, v130
    v_add_f32 v129, v129, v131
    v_add_f32 v128, v128, v132
    v_add_f32 v129, v129, v133
    v_add_f32 v128, v128, v134
    v_add_f32 v129, v129, v135
    v_add_f32 v128, v128, v136
    v_add_f32 v129, v129, v137
    v_add_f32 v128, v128, v138
    v_add_f32 v129, v129, v139
    v_add_f32 v128, v128, v140
    v_add_f32 v129, v129, v141
    v_add_f32 v128, v128, v142
    v_add_f32 v129, v129, v143
    v_mov_b32 v130, v128
    v_mov_b32 v131, v129
    s_nop 0
    v_permlane32_swap_b32 v128, v130
    v_permlane32_swap_b32 v129, v131
    v_add_f32 v128, v128, v130
    v_add_f32 v129, v129, v131
    s_and_b32 s46, s33, 1
    s_lshl_b32 s46, s46, 7
    s_add_u32 s46, s46, 147456
    v_lshlrev_b32 v6, 2, v5
    v_add_u32 v6, s46, v6
    v_mul_f32 v128, 0x3b000000, v128
    v_mul_f32 v129, 0x3b000000, v129
    v_fma_f32 v129, -v128, v128, v129
    v_max_f32 v129, 0, v129
    v_add_f32 v129, 0x3727c5ac, v129
    v_rsq_f32 v129, v129
    ds_write_b32 v6, v128 offset:0
    ds_write_b32 v6, v129 offset:512
    s_waitcnt lgkmcnt(0)
    s_setprio 0
    s_barrier
H_P1_END:
    s_barrier
    s_barrier
    s_add_u32 s8, s82, s6
    s_addc_u32 s9, s83, 0
    s_add_u32 s8, s8, 4194304
    s_addc_u32 s9, s9, 0
    s_mov_b32 s10, 6291456
    s_mov_b32 s11, 0x20000
    s_lshl_b32 s32, s87, 3
    s_add_u32 s32, s32, s3
    v_lshlrev_b32 v2, 4, v1
    s_lshl_b32 s33, s86, 16
    s_lshl_b32 s34, s32, 10
    s_add_u32 s34, s34, s33
    buffer_load_dwordx4 v[8:11], v2, s[8:11], s34 offen sc1
    s_lshl_b32 s35, s3, 10
    s_add_u32 s36, s33, s35
    s_add_u32 s37, s36, 2097152
    s_add_u32 s38, s36, 4194304
    v_mov_b32 v6, v2
    s_add_u32 m0, s35, 0
    s_add_u32 s40, s37, 0
    buffer_load_dwordx4 v6, s[8:11], s40 offen sc1 lds
    s_add_u32 m0, s35, 65536
    s_add_u32 s40, s38, 0
    buffer_load_dwordx4 v6, s[8:11], s40 offen sc1 lds
    s_add_u32 m0, s35, 8192
    s_add_u32 s40, s37, 8192
    buffer_load_dwordx4 v6, s[8:11], s40 offen sc1 lds
    s_add_u32 m0, s35, 73728
    s_add_u32 s40, s38, 8192
    buffer_load_dwordx4 v6, s[8:11], s40 offen sc1 lds
    s_add_u32 s20, s82, s6
    s_addc_u32 s21, s83, 0
    s_add_u32 s20, s20, 10485760
    s_addc_u32 s21, s21, 0
    s_mov_b32 s22, 2097152
    s_mov_b32 s23, 0x20000
    v_lshrrev_b32 v4, 5, v1
    v_lshlrev_b32 v4, 8, v4
    v_and_b32 v5, 15, v1
    v_lshlrev_b32 v5, 4, v5
    v_add_u32 v3, v4, v5
    v_add_u32 v3, 65536, v3
    s_mov_b32 s44, 0x0000ffff
    s_mov_b32 s45, 0x0000ffff
    v_mov_b32 v20, 0x3f803f80
    v_mov_b32 v21, 0x3f803f80
    v_mov_b32 v22, 0x3f803f80
    v_mov_b32 v23, 0x3f803f80
    v_mov_b32 v24, 0x3f803f80
    v_mov_b32 v25, 0x3f803f80
    v_mov_b32 v26, 0x3f803f80
    v_mov_b32 v27, 0x3f803f80
    v_mov_b32 v28, 0x3f803f80
    v_mov_b32 v29, 0x3f803f80
    v_mov_b32 v30, 0x3f803f80
    v_mov_b32 v31, 0x3f803f80
    v_mov_b32 v32, 0x3f803f80
    v_mov_b32 v33, 0x3f803f80
    v_mov_b32 v34, 0x3f803f80
    v_mov_b32 v35, 0x3f803f80
    v_mov_b32 v80, 0
    v_mov_b32 v81, 0
    v_mov_b32 v82, 0
    v_mov_b32 v83, 0
    v_mov_b32 v84, 0
    v_mov_b32 v85, 0
    v_mov_b32 v86, 0
    v_mov_b32 v87, 0
    v_mov_b32 v88, 0
    v_mov_b32 v89, 0
    v_mov_b32 v90, 0
    v_mov_b32 v91, 0
    v_mov_b32 v92, 0
    v_mov_b32 v93, 0
    v_mov_b32 v94, 0
    v_mov_b32 v95, 0
    s_mov_b32 s12, s68
    s_mov_b32 s13, s69
    s_mov_b32 s14, 524288
    s_mov_b32 s15, 0x20000
    v_lshrrev_b32 v4, 3, v1
    v_and_b32 v7, 7, v1
    v_lshlrev_b32 v4, 10, v4
    v_lshrrev_b32 v5, 4, v1
    v_and_b32 v5, 1, v5
    v_lshlrev_b32 v5, 2, v5
    v_xor_b32 v5, v5, v7
    v_lshlrev_b32 v5, 4, v5
    v_add_u32 v7, v4, v5
    s_mov_b32 s16, s72
    s_mov_b32 s17, s73
    s_mov_b32 s18, 1835008
    s_mov_b32 s19, 0x20000
    s_cmp_ge_u32 s3, 4
    s_cselect_b32 s16, s74, s16
    s_cselect_b32 s17, s75, s17
    v_lshrrev_b32 v4, 1, v1
    s_mov_b32 s56, 3584
    v_mul_lo_u32 v4, v4, s56
    v_and_b32 v5, 1, v1
    v_lshlrev_b32 v5, 7, v5
    v_add_u32 v4, v4, v5
    s_and_b32 s56, s90, 3
    s_lshl_b32 s56, s56, 2
    s_and_b32 s57, s3, 3
    s_add_u32 s56, s56, s57
    s_mul_i32 s56, s56, 114688
    s_lshl_b32 s57, s91, 8
    s_add_u32 s56, s56, s57
    s_and_b32 s51, s3, 3
    s_lshr_b32 s52, s3, 2
    s_lshl_b32 s53, s51, 12
    s_lshl_b32 s54, s52, 16
    s_add_u32 s53, s53, s54
    s_lshl_b32 s54, s51, 15
    s_lshl_b32 s55, s52, 18
    s_add_u32 s54, s54, s55
    s_lshl_b32 s55, s89, 7
    s_add_u32 s54, s54, s55
    s_waitcnt vmcnt(2)
    s_barrier
    ds_read_b128 v[12:15], v2 offset:0
    ds_read_b128 v[16:19], v2 offset:1024
    s_mov_b64 exec, s[44:45]
    ds_read_b128 v[20:23], v3 offset:0
    ds_read_b128 v[24:27], v3 offset:512
    s_mov_b64 exec, -1
    s_waitcnt lgkmcnt(0)
    v_mfma_f32_32x32x16_bf16 v[48:63], v[12:15], v[8:11], 0
    v_mfma_f32_32x32x16_bf16 v[64:79], v[16:19], v[8:11], 0
    ds_read_b128 v[12:15], v2 offset:2048
    s_mov_b32 s49, 0
    s_setprio 0
P2H_LOOP:
    s_cmp_lt_u32 s49, 7
    s_cbranch_scc1 P2H_DISP
P2H_L3:
    s_setprio 1
    s_nop 4
    v_exp_f32 v48, v48
    v_exp_f32 v49, v49
    v_exp_f32 v50, v50
    v_exp_f32 v51, v51
    v_exp_f32 v52, v52
    v_exp_f32 v53, v53
    v_exp_f32 v54, v54
    v_exp_f32 v55, v55
    v_exp_f32 v56, v56
    v_cvt_pk_bf16_f32 v112, v48, v49
    v_cvt_pk_bf16_f32 v113, v50, v51
    v_cvt_pk_bf16_f32 v114, v52, v53
    v_cvt_pk_bf16_f32 v115, v54, v55
    v_exp_f32 v57, v57
    v_exp_f32 v58, v58
    s_waitcnt lgkmcnt(0)
    v_mfma_f32_32x32x16_bf16 v[80:95], v[20:23], v[112:115], v[80:95]
    v_exp_f32 v59, v59
    v_exp_f32 v60, v60
    v_exp_f32 v61, v61
    v_exp_f32 v62, v62
    v_exp_f32 v63, v63
    s_mov_b64 exec, s[44:45]
    ds_read_b128 v[28:31], v3 offset:1024
    ds_read_b128 v[32:35], v3 offset:1536
    s_mov_b64 exec, -1
    v_cvt_pk_bf16_f32 v116, v56, v57
    v_cvt_pk_bf16_f32 v117, v58, v59
    v_cvt_pk_bf16_f32 v118, v60, v61
    v_cvt_pk_bf16_f32 v119, v62, v63
    v_mfma_f32_32x32x16_bf16 v[48:63], v[12:15], v[8:11], 0
    ds_read_b128 v[16:19], v2 offset:3072
    v_mfma_f32_32x32x16_bf16 v[80:95], v[24:27], v[116:119], v[80:95]
    v_exp_f32 v64, v64
    v_exp_f32 v65, v65
    v_exp_f32 v66, v66
    v_exp_f32 v67, v67
    v_exp_f32 v68, v68
    v_exp_f32 v69, v69
    v_exp_f32 v70, v70
    v_exp_f32 v71, v71
    v_exp_f32 v72, v72
    v_cvt_pk_bf16_f32 v112, v64, v65
    v_cvt_pk_bf16_f32 v113, v66, v67
    v_cvt_pk_bf16_f32 v114, v68, v69
    v_cvt_pk_bf16_f32 v115, v70, v71
    v_exp_f32 v73, v73
    v_exp_f32 v74, v74
    s_waitcnt lgkmcnt(0)
    v_mfma_f32_32x32x16_bf16 v[80:95], v[28:31], v[112:115], v[80:95]
    v_exp_f32 v75, v75
    v_exp_f32 v76, v76
    v_exp_f32 v77, v77
    v_exp_f32 v78, v78
    v_exp_f32 v79, v79
    s_mov_b64 exec, s[44:45]
    ds_read_b128 v[20:23], v3 offset:2048
    ds_read_b128 v[24:27], v3 offset:2560
    s_mov_b64 exec, -1
    v_cvt_pk_bf16_f32 v116, v72, v73
    v_cvt_pk_bf16_f32 v117, v74, v75
    v_cvt_pk_bf16_f32 v118, v76, v77
    v_cvt_pk_bf16_f32 v119, v78, v79
    v_mfma_f32_32x32x16_bf16 v[64:79], v[16:19], v[8:11], 0
    ds_read_b128 v[12:15], v2 offset:4096
    v_mfma_f32_32x32x16_bf16 v[80:95], v[32:35], v[116:119], v[80:95]
    v_exp_f32 v48, v48
    v_exp_f32 v49, v49
    v_exp_f32 v50, v50
    v_exp_f32 v51, v51
    v_exp_f32 v52, v52
    v_exp_f32 v53, v53
    v_exp_f32 v54, v54
    v_exp_f32 v55, v55
    v_exp_f32 v56, v56
    v_cvt_pk_bf16_f32 v112, v48, v49
    v_cvt_pk_bf16_f32 v113, v50, v51
    v_cvt_pk_bf16_f32 v114, v52, v53
    v_cvt_pk_bf16_f32 v115, v54, v55
    v_exp_f32 v57, v57
    v_exp_f32 v58, v58
    s_waitcnt lgkmcnt(0)
    v_mfma_f32_32x32x16_bf16 v[80:95], v[20:23], v[112:115], v[80:95]
    v_exp_f32 v59, v59
    v_exp_f32 v60, v60
    v_exp_f32 v61, v61
    v_exp_f32 v62, v62
    v_exp_f32 v63, v63
    s_mov_b64 exec, s[44:45]
    ds_read_b128 v[28:31], v3 offset:3072
    ds_read_b128 v[32:35], v3 offset:3584
    s_mov_b64 exec, -1
    v_cvt_pk_bf16_f32 v116, v56, v57
    v_cvt_pk_bf16_f32 v117, v58, v59
    v_cvt_pk_bf16_f32 v118, v60, v61
    v_cvt_pk_bf16_f32 v119, v62, v63
    v_mfma_f32_32x32x16_bf16 v[48:63], v[12:15], v[8:11], 0
    ds_read_b128 v[16:19], v2 offset:5120
    v_mfma_f32_32x32x16_bf16 v[80:95], v[24:27], v[116:119], v[80:95]
    s_setprio 0
    v_exp_f32 v64, v64
    v_exp_f32 v65, v65
    v_exp_f32 v66, v66
    v_exp_f32 v67, v67
    v_exp_f32 v68, v68
    v_exp_f32 v69, v69
    v_exp_f32 v70, v70
    v_exp_f32 v71, v71
    v_exp_f32 v72, v72
    v_cvt_pk_bf16_f32 v112, v64, v65
    v_cvt_pk_bf16_f32 v113, v66, v67
    v_cvt_pk_bf16_f32 v114, v68, v69
    v_cvt_pk_bf16_f32 v115, v70, v71
    v_exp_f32 v73, v73
    v_exp_f32 v74, v74
    s_waitcnt lgkmcnt(0)
    v_mfma_f32_32x32x16_bf16 v[80:95], v[28:31], v[112:115], v[80:95]
    v_exp_f32 v75, v75
    v_exp_f32 v76, v76
    v_exp_f32 v77, v77
    v_exp_f32 v78, v78
    v_exp_f32 v79, v79
    s_mov_b64 exec, s[44:45]
    ds_read_b128 v[20:23], v3 offset:4096
    ds_read_b128 v[24:27], v3 offset:4608
    s_mov_b64 exec, -1
    v_cvt_pk_bf16_f32 v116, v72, v73
    v_cvt_pk_bf16_f32 v117, v74, v75
    v_cvt_pk_bf16_f32 v118, v76, v77
    v_cvt_pk_bf16_f32 v119, v78, v79
    v_mfma_f32_32x32x16_bf16 v[64:79], v[16:19], v[8:11], 0
    ds_read_b128 v[12:15], v2 offset:6144
    v_mfma_f32_32x32x16_bf16 v[80:95], v[32:35], v[116:119], v[80:95]
    s_setprio 1
    v_exp_f32 v48, v48
    v_exp_f32 v49, v49
    v_exp_f32 v50, v50
    v_exp_f32 v51, v51
    v_exp_f32 v52, v52
    v_exp_f32 v53, v53
    v_exp_f32 v54, v54
    v_exp_f32 v55, v55
    v_exp_f32 v56, v56
    v_cvt_pk_bf16_f32 v112, v48, v49
    v_cvt_pk_bf16_f32 v113, v50, v51
    v_cvt_pk_bf16_f32 v114, v52, v53
    v_cvt_pk_bf16_f32 v115, v54, v55
    v_exp_f32 v57, v57
    v_exp_f32 v58, v58
    s_waitcnt lgkmcnt(0)
    v_mfma_f32_32x32x16_bf16 v[80:95], v[20:23], v[112:115], v[80:95]
    v_exp_f32 v59, v59
    v_exp_f32 v60, v60
    v_exp_f32 v61, v61
    v_exp_f32 v62, v62
    v_exp_f32 v63, v63
    s_mov_b64 exec, s[44:45]
    ds_read_b128 v[28:31], v3 offset:5120
    ds_read_b128 v[32:35], v3 offset:5632
    s_mov_b64 exec, -1
    v_cvt_pk_bf16_f32 v116, v56, v57
    v_cvt_pk_bf16_f32 v117, v58, v59
    v_cvt_pk_bf16_f32 v118, v60, v61
    v_cvt_pk_bf16_f32 v119, v62, v63
    v_mfma_f32_32x32x16_bf16 v[48:63], v[12:15], v[8:11], 0
    ds_read_b128 v[16:19], v2 offset:7168
    v_mfma_f32_32x32x16_bf16 v[80:95], v[24:27], v[116:119], v[80:95]
    s_cmp_lg_u32 s49, 0
    s_cbranch_scc1 P2H_EKV
    s_waitcnt vmcnt(4)
    s_barrier
P2H_EKV:
    v_exp_f32 v64, v64
    v_exp_f32 v65, v65
    v_exp_f32 v66, v66
    v_exp_f32 v67, v67
    v_exp_f32 v68, v68
    v_exp_f32 v69, v69
    v_exp_f32 v70, v70
    v_exp_f32 v71, v71
    v_exp_f32 v72, v72
    v_cvt_pk_bf16_f32 v112, v64, v65
    v_cvt_pk_bf16_f32 v113, v66, v67
    v_cvt_pk_bf16_f32 v114, v68, v69
    v_cvt_pk_bf16_f32 v115, v70, v71
    v_exp_f32 v73, v73
    v_exp_f32 v74, v74
    s_waitcnt lgkmcnt(0)
    v_mfma_f32_32x32x16_bf16 v[80:95], v[28:31], v[112:115], v[80:95]
    v_exp_f32 v75, v75
    v_exp_f32 v76, v76
    v_exp_f32 v77, v77
    v_exp_f32 v78, v78
    v_exp_f32 v79, v79
    s_mov_b64 exec, s[44:45]
    ds_read_b128 v[20:23], v3 offset:6144
    ds_read_b128 v[24:27], v3 offset:6656
    s_mov_b64 exec, -1
    v_cvt_pk_bf16_f32 v116, v72, v73
    v_cvt_pk_bf16_f32 v117, v74, v75
    v_cvt_pk_bf16_f32 v118, v76, v77
    v_cvt_pk_bf16_f32 v119, v78, v79
    v_mfma_f32_32x32x16_bf16 v[64:79], v[16:19], v[8:11], 0
    ds_read_b128 v[12:15], v2 offset:8192
    v_mfma_f32_32x32x16_bf16 v[80:95], v[32:35], v[116:119], v[80:95]
    v_exp_f32 v48, v48
    v_exp_f32 v49, v49
    v_exp_f32 v50, v50
    v_exp_f32 v51, v51
    v_exp_f32 v52, v52
    v_exp_f32 v53, v53
    v_exp_f32 v54, v54
    v_exp_f32 v55, v55
    v_exp_f32 v56, v56
    v_cvt_pk_bf16_f32 v112, v48, v49
    v_cvt_pk_bf16_f32 v113, v50, v51
    v_cvt_pk_bf16_f32 v114, v52, v53
    v_cvt_pk_bf16_f32 v115, v54, v55
    v_exp_f32 v57, v57
    v_exp_f32 v58, v58
    s_waitcnt lgkmcnt(0)
    v_mfma_f32_32x32x16_bf16 v[80:95], v[20:23], v[112:115], v[80:95]
    v_exp_f32 v59, v59
    v_exp_f32 v60, v60
    v_exp_f32 v61, v61
    v_exp_f32 v62, v62
    v_exp_f32 v63, v63
    s_mov_b64 exec, s[44:45]
    ds_read_b128 v[28:31], v3 offset:7168
    ds_read_b128 v[32:35], v3 offset:7680
    s_mov_b64 exec, -1
    v_cvt_pk_bf16_f32 v116, v56, v57
    v_cvt_pk_bf16_f32 v117, v58, v59
    v_cvt_pk_bf16_f32 v118, v60, v61
    v_cvt_pk_bf16_f32 v119, v62, v63
    v_mfma_f32_32x32x16_bf16 v[48:63], v[12:15], v[8:11], 0
    ds_read_b128 v[16:19], v2 offset:9216
    v_mfma_f32_32x32x16_bf16 v[80:95], v[24:27], v[116:119], v[80:95]
    s_setprio 0
    v_exp_f32 v64, v64
    v_exp_f32 v65, v65
    v_exp_f32 v66, v66
    v_exp_f32 v67, v67
    v_exp_f32 v68, v68
    v_exp_f32 v69, v69
    v_exp_f32 v70, v70
    v_exp_f32 v71, v71
    v_exp_f32 v72, v72
    v_cvt_pk_bf16_f32 v112, v64, v65
    v_cvt_pk_bf16_f32 v113, v66, v67
    v_cvt_pk_bf16_f32 v114, v68, v69
    v_cvt_pk_bf16_f32 v115, v70, v71
    v_exp_f32 v73, v73
    v_exp_f32 v74, v74
    s_waitcnt lgkmcnt(0)
    v_mfma_f32_32x32x16_bf16 v[80:95], v[28:31], v[112:115], v[80:95]
    v_exp_f32 v75, v75
    v_exp_f32 v76, v76
    v_exp_f32 v77, v77
    v_exp_f32 v78, v78
    v_exp_f32 v79, v79
    s_mov_b64 exec, s[44:45]
    ds_read_b128 v[20:23], v3 offset:8192
    ds_read_b128 v[24:27], v3 offset:8704
    s_mov_b64 exec, -1
    v_cvt_pk_bf16_f32 v116, v72, v73
    v_cvt_pk_bf16_f32 v117, v74, v75
    v_cvt_pk_bf16_f32 v118, v76, v77
    v_cvt_pk_bf16_f32 v119, v78, v79
    v_mfma_f32_32x32x16_bf16 v[64:79], v[16:19], v[8:11], 0
    ds_read_b128 v[12:15], v2 offset:10240
    v_mfma_f32_32x32x16_bf16 v[80:95], v[32:35], v[116:119], v[80:95]
    v_add_u32 v2, 8192, v2
    v_add_u32 v3, 8192, v3
    s_add_u32 s49, s49, 1
    s_cmp_lt_u32 s49, 8
    s_cbranch_scc1 P2H_LOOP
    s_branch P2H_DONE
P2H_DISP:
    s_cmp_eq_u32 s49, 1
    s_cbranch_scc1 P2H_H1
    s_cmp_eq_u32 s49, 2
    s_cbranch_scc1 P2H_H2
    s_cmp_eq_u32 s49, 3
    s_cbranch_scc1 P2H_H3
    s_cmp_eq_u32 s49, 4
    s_cbranch_scc1 P2H_H4
    s_cmp_eq_u32 s49, 5
    s_cbranch_scc1 P2H_H5
    s_cmp_eq_u32 s49, 6
    s_cbranch_scc1 P2H_H6
P2H_H0:
    s_add_u32 m0, s35, 16384
    s_add_u32 s40, s37, 16384
    buffer_load_dwordx4 v6, s[8:11], s40 offen sc1 lds
    s_add_u32 m0, s35, 81920
    s_add_u32 s40, s38, 16384
    buffer_load_dwordx4 v6, s[8:11], s40 offen sc1 lds
    s_add_u32 m0, s35, 24576
    s_add_u32 s40, s37, 24576
    buffer_load_dwordx4 v6, s[8:11], s40 offen sc1 lds
    s_add_u32 m0, s35, 90112
    s_add_u32 s40, s38, 24576
    buffer_load_dwordx4 v6, s[8:11], s40 offen sc1 lds
    s_branch P2H_L3
P2H_H1:
    s_waitcnt vmcnt(0)
    s_barrier
    s_add_u32 m0, s35, 32768
    s_add_u32 s40, s37, 32768
    buffer_load_dwordx4 v6, s[8:11], s40 offen sc1 lds
    s_add_u32 m0, s35, 98304
    s_add_u32 s40, s38, 32768
    buffer_load_dwordx4 v6, s[8:11], s40 offen sc1 lds
    s_add_u32 m0, s35, 40960
    s_add_u32 s40, s37, 40960
    buffer_load_dwordx4 v6, s[8:11], s40 offen sc1 lds
    s_add_u32 m0, s35, 106496
    s_add_u32 s40, s38, 40960
    buffer_load_dwordx4 v6, s[8:11], s40 offen sc1 lds
    s_branch P2H_L3
P2H_H2:
    s_add_u32 m0, s35, 49152
    s_add_u32 s40, s37, 49152
    buffer_load_dwordx4 v6, s[8:11], s40 offen sc1 lds
    s_add_u32 m0, s35, 114688
    s_add_u32 s40, s38, 49152
    buffer_load_dwordx4 v6, s[8:11], s40 offen sc1 lds
    s_add_u32 m0, s35, 57344
    s_add_u32 s40, s37, 57344
    buffer_load_dwordx4 v6, s[8:11], s40 offen sc1 lds
    s_add_u32 m0, s35, 122880
    s_add_u32 s40, s38, 57344
    buffer_load_dwordx4 v6, s[8:11], s40 offen sc1 lds
    s_branch P2H_L3
P2H_H3:
    s_waitcnt vmcnt(4)
    s_barrier
    s_branch P2H_L3
P2H_H4:
    s_waitcnt vmcnt(0)
    s_cmp_ge_u32 s2, 224
    s_cbranch_scc1 P2H_L3
    buffer_load_dword v5, v4, s[16:19], s56 offen
    s_branch P2H_L3
P2H_H5:
    s_barrier
    s_add_u32 m0, s53, 0
    s_add_u32 s40, s54, 0
    buffer_load_dwordx4 v7, s[12:15], s40 offen lds
    s_add_u32 m0, s53, 1024
    s_add_u32 s40, s54, 8192
    buffer_load_dwordx4 v7, s[12:15], s40 offen lds
    s_add_u32 m0, s53, 2048
    s_add_u32 s40, s54, 16384
    buffer_load_dwordx4 v7, s[12:15], s40 offen lds
    s_add_u32 m0, s53, 3072
    s_add_u32 s40, s54, 24576
    buffer_load_dwordx4 v7, s[12:15], s40 offen lds
    s_branch P2H_L3
P2H_H6:
    s_add_u32 m0, s53, 16384
    s_add_u32 s40, s54, 131072
    buffer_load_dwordx4 v7, s[12:15], s40 offen lds
    s_add_u32 m0, s53, 17408
    s_add_u32 s40, s54, 139264
    buffer_load_dwordx4 v7, s[12:15], s40 offen lds
    s_add_u32 m0, s53, 18432
    s_add_u32 s40, s54, 147456
    buffer_load_dwordx4 v7, s[12:15], s40 offen lds
    s_add_u32 m0, s53, 19456
    s_add_u32 s40, s54, 155648
    buffer_load_dwordx4 v7, s[12:15], s40 offen lds
    s_branch P2H_L3
P2H_DONE:
    s_waitcnt lgkmcnt(0)
    v_add_u32 v2, 0xffff0000, v2
    s_nop 15
    v_cmp_le_f32 vcc, 0x1f800000, v88
    s_nop 1
    s_mov_b64 s[46:47], vcc
    v_cmp_ge_f32 vcc, 0x5f800000, v88
    s_nop 1
    s_and_b64 s[46:47], s[46:47], vcc
    s_mov_b32 s48, 0x7b800000
    v_cmp_gt_f32_e64 vcc, s48, |v80|
    s_nop 1
    s_and_b64 s[46:47], s[46:47], vcc
    v_cmp_gt_f32_e64 vcc, s48, |v81|
    s_nop 1
    s_and_b64 s[46:47], s[46:47], vcc
    v_cmp_gt_f32_e64 vcc, s48, |v82|
    s_nop 1
    s_and_b64 s[46:47], s[46:47], vcc
    v_cmp_gt_f32_e64 vcc, s48, |v83|
    s_nop 1
    s_and_b64 s[46:47], s[46:47], vcc
    v_cmp_gt_f32_e64 vcc, s48, |v84|
    s_nop 1
    s_and_b64 s[46:47], s[46:47], vcc
    v_cmp_gt_f32_e64 vcc, s48, |v85|
    s_nop 1
    s_and_b64 s[46:47], s[46:47], vcc
    v_cmp_gt_f32_e64 vcc, s48, |v86|
    s_nop 1
    s_and_b64 s[46:47], s[46:47], vcc
    v_cmp_gt_f32_e64 vcc, s48, |v87|
    s_nop 1
    s_and_b64 s[46:47], s[46:47], vcc
    s_cmp_eq_u64 s[46:47], -1
    s_cbranch_scc1 P2H_FIN
    s_add_u32 s37, s33, 2097152
    s_add_u32 s38, s33, 4194304
    v_add_u32 v3, 0xffff0000, v3
    v_add_u32 v3, 0xffff0000, v3
    v_mov_b32 v96, 0xff800000
    s_mov_b32 s49, 0
    s_mov_b32 s40, s37
P2H_MX:
    buffer_load_dwordx4 v[12:15], v2, s[8:11], s40 offen sc1
    s_waitcnt vmcnt(0)
    v_mfma_f32_32x32x16_bf16 v[48:63], v[12:15], v[8:11], 0
    s_nop 11
    v_max3_f32 v96, v48, v49, v96
    v_max3_f32 v96, v50, v51, v96
    v_max3_f32 v96, v52, v53, v96
    v_max3_f32 v96, v54, v55, v96
    v_max3_f32 v96, v56, v57, v96
    v_max3_f32 v96, v58, v59, v96
    v_max3_f32 v96, v60, v61, v96
    v_max3_f32 v96, v62, v63, v96
    s_add_u32 s40, s40, 1024
    s_add_u32 s49, s49, 1
    s_cmp_lt_u32 s49, 64
    s_cbranch_scc1 P2H_MX
    v_mov_b32 v97, v96
    s_nop 1
    v_permlane32_swap_b32 v96, v97
    v_max_f32 v96, v96, v97
    v_sub_f32 v64, 0, v96
    v_sub_f32 v65, 0, v96
    v_sub_f32 v66, 0, v96
    v_sub_f32 v67, 0, v96
    v_sub_f32 v68, 0, v96
    v_sub_f32 v69, 0, v96
    v_sub_f32 v70, 0, v96
    v_sub_f32 v71, 0, v96
    v_sub_f32 v72, 0, v96
    v_sub_f32 v73, 0, v96
    v_sub_f32 v74, 0, v96
    v_sub_f32 v75, 0, v96
    v_sub_f32 v76, 0, v96
    v_sub_f32 v77, 0, v96
    v_sub_f32 v78, 0, v96
    v_sub_f32 v79, 0, v96
    v_mov_b32 v80, 0
    v_mov_b32 v81, 0
    v_mov_b32 v82, 0
    v_mov_b32 v83, 0
    v_mov_b32 v84, 0
    v_mov_b32 v85, 0
    v_mov_b32 v86, 0
    v_mov_b32 v87, 0
    v_mov_b32 v88, 0
    v_mov_b32 v89, 0
    v_mov_b32 v90, 0
    v_mov_b32 v91, 0
    v_mov_b32 v92, 0
    v_mov_b32 v93, 0
    v_mov_b32 v94, 0
    v_mov_b32 v95, 0
    s_mov_b32 s49, 0
    s_mov_b32 s40, s37
    s_mov_b32 s41, s38
P2H_FB:
    buffer_load_dwordx4 v[12:15], v2, s[8:11], s40 offen sc1
    s_mov_b64 exec, s[44:45]
    buffer_load_dwordx4 v[20:23], v3, s[8:11], s41 offen offset:0 sc1
    buffer_load_dwordx4 v[24:27], v3, s[8:11], s41 offen offset:512 sc1
    s_mov_b64 exec, -1
    s_waitcnt vmcnt(0)
    v_mfma_f32_32x32x16_bf16 v[48:63], v[12:15], v[8:11], v[64:79]
    s_nop 11
    v_exp_f32 v48, v48
    v_exp_f32 v49, v49
    v_exp_f32 v50, v50
    v_exp_f32 v51, v51
    v_exp_f32 v52, v52
    v_exp_f32 v53, v53
    v_exp_f32 v54, v54
    v_exp_f32 v55, v55
    v_exp_f32 v56, v56
    v_exp_f32 v57, v57
    v_exp_f32 v58, v58
    v_exp_f32 v59, v59
    v_exp_f32 v60, v60
    v_exp_f32 v61, v61
    v_exp_f32 v62, v62
    v_exp_f32 v63, v63
    v_cvt_pk_bf16_f32 v112, v48, v49
    v_cvt_pk_bf16_f32 v113, v50, v51
    v_cvt_pk_bf16_f32 v114, v52, v53
    v_cvt_pk_bf16_f32 v115, v54, v55
    v_cvt_pk_bf16_f32 v116, v56, v57
    v_cvt_pk_bf16_f32 v117, v58, v59
    v_cvt_pk_bf16_f32 v118, v60, v61
    v_cvt_pk_bf16_f32 v119, v62, v63
    v_mfma_f32_32x32x16_bf16 v[80:95], v[20:23], v[112:115], v[80:95]
    s_nop 0
    v_mfma_f32_32x32x16_bf16 v[80:95], v[24:27], v[116:119], v[80:95]
    s_add_u32 s40, s40, 1024
    s_add_u32 s41, s41, 1024
    s_add_u32 s49, s49, 1
    s_cmp_lt_u32 s49, 64
    s_cbranch_scc1 P2H_FB
    s_nop 15
P2H_FIN:
    v_rcp_f32 v6, v88
    s_nop 0
    v_mul_f32 v80, v80, v6
    v_mul_f32 v81, v81, v6
    v_mul_f32 v82, v82, v6
    v_mul_f32 v83, v83, v6
    v_mul_f32 v84, v84, v6
    v_mul_f32 v85, v85, v6
    v_mul_f32 v86, v86, v6
    v_mul_f32 v87, v87, v6
    v_cvt_pk_bf16_f32 v112, v80, v81
    v_cvt_pk_bf16_f32 v113, v82, v83
    v_cvt_pk_bf16_f32 v114, v84, v85
    v_cvt_pk_bf16_f32 v115, v86, v87
    s_lshl_b32 s34, s32, 5
    s_add_u32 s34, s34, s86
    s_lshl_b32 s34, s34, 10
    buffer_store_dwordx4 v[112:115], v2, s[20:23], s34 offen sc1
    s_waitcnt vmcnt(0)
    s_barrier
    s_setprio 0
    v_lshrrev_b32 v2, 4, v1
    v_and_b32 v3, 15, v1
    v_lshrrev_b32 v3, 2, v3
    v_lshrrev_b32 v4, 5, v1
    v_and_b32 v5, 31, v1
    s_sub_u32 s33, s3, 4
    s_mov_b32 s12, s68
    s_mov_b32 s13, s69
    s_mov_b32 s14, 524288
    s_mov_b32 s15, 0x20000
    v_lshlrev_b32 v8, 4, v1
    v_lshrrev_b32 v6, 3, v1
    v_and_b32 v7, 7, v1
    v_lshlrev_b32 v6, 10, v6
    v_and_b32 v12, 1, v2
    v_lshlrev_b32 v12, 2, v12
    v_xor_b32 v12, v12, v7
    v_lshlrev_b32 v12, 4, v12
    v_add_u32 v10, v6, v12
    s_lshl_b32 s36, s88, 1
    s_lshr_b32 s37, s33, 1
    s_add_u32 s36, s36, s37
    s_mul_i32 s36, s36, 32768
    s_and_b32 s37, s33, 1
    s_lshl_b32 s37, s37, 12
    s_add_u32 s36, s36, s37
    s_lshl_b32 s38, s33, 12
    s_lshl_b32 s37, s33, 15
    s_lshl_b32 s39, s89, 7
    s_add_u32 s37, s37, s39
    s_add_u32 s8, s82, s6
    s_addc_u32 s9, s83, 0
    s_add_u32 s8, s8, 10485760
    s_addc_u32 s9, s9, 0
    s_mov_b32 s10, 2097152
    s_mov_b32 s11, 0x20000
    s_barrier
    s_setprio 2
    s_add_u32 m0, s38, 32768
    s_add_u32 s40, s36, 0
    buffer_load_dwordx4 v8, s[8:11], s40 offen sc1 lds
    s_add_u32 m0, s38, 33792
    s_add_u32 s40, s36, 1024
    buffer_load_dwordx4 v8, s[8:11], s40 offen sc1 lds
    s_add_u32 m0, s38, 34816
    s_add_u32 s40, s36, 2048
    buffer_load_dwordx4 v8, s[8:11], s40 offen sc1 lds
    s_add_u32 m0, s38, 35840
    s_add_u32 s40, s36, 3072
    buffer_load_dwordx4 v8, s[8:11], s40 offen sc1 lds
    s_add_u32 m0, s38, 49152
    s_add_u32 s40, s36, 8192
    buffer_load_dwordx4 v8, s[8:11], s40 offen sc1 lds
    s_add_u32 m0, s38, 50176
    s_add_u32 s40, s36, 9216
    buffer_load_dwordx4 v8, s[8:11], s40 offen sc1 lds
    s_add_u32 m0, s38, 51200
    s_add_u32 s40, s36, 10240
    buffer_load_dwordx4 v8, s[8:11], s40 offen sc1 lds
    s_add_u32 m0, s38, 52224
    s_add_u32 s40, s36, 11264
    buffer_load_dwordx4 v8, s[8:11], s40 offen sc1 lds
    s_add_u32 m0, s38, 98304
    s_add_u32 s40, s36, 16384
    buffer_load_dwordx4 v8, s[8:11], s40 offen sc1 lds
    s_add_u32 m0, s38, 99328
    s_add_u32 s40, s36, 17408
    buffer_load_dwordx4 v8, s[8:11], s40 offen sc1 lds
    s_add_u32 m0, s38, 100352
    s_add_u32 s40, s36, 18432
    buffer_load_dwordx4 v8, s[8:11], s40 offen sc1 lds
    s_add_u32 m0, s38, 101376
    s_add_u32 s40, s36, 19456
    buffer_load_dwordx4 v8, s[8:11], s40 offen sc1 lds
    s_waitcnt vmcnt(8)
    s_barrier
    s_add_u32 m0, s38, 114688
    s_add_u32 s40, s36, 24576
    buffer_load_dwordx4 v8, s[8:11], s40 offen sc1 lds
    s_add_u32 m0, s38, 115712
    s_add_u32 s40, s36, 25600
    buffer_load_dwordx4 v8, s[8:11], s40 offen sc1 lds
    s_add_u32 m0, s38, 116736
    s_add_u32 s40, s36, 26624
    buffer_load_dwordx4 v8, s[8:11], s40 offen sc1 lds
    s_add_u32 m0, s38, 117760
    s_add_u32 s40, s36, 27648
    buffer_load_dwordx4 v8, s[8:11], s40 offen sc1 lds
    s_waitcnt vmcnt(8)
    s_barrier
    s_waitcnt vmcnt(4)
    s_barrier
    s_waitcnt vmcnt(0)
    s_barrier
    s_setprio 0
    s_cmp_lt_u32 s2, 224
    s_cbranch_scc1 H_P4
    s_barrier
    s_branch H_P5PRE
H_P4:
    s_sub_u32 s33, s3, 4
    s_mov_b32 s12, s72
    s_mov_b32 s13, s73
    s_mov_b32 s14, 1835008
    s_mov_b32 s15, 0x20000
    s_mov_b32 s16, s74
    s_mov_b32 s17, s75
    s_mov_b32 s18, 1835008
    s_mov_b32 s19, 0x20000
    v_lshrrev_b32 v6, 3, v1
    v_and_b32 v7, 7, v1
    v_lshlrev_b32 v8, 4, v1
    v_lshlrev_b32 v9, 4, v1
    s_mov_b32 s35, 3584
    v_mul_lo_u32 v13, v6, s35
    v_and_b32 v12, 1, v2
    v_lshlrev_b32 v12, 2, v12
    v_xor_b32 v12, v12, v7
    v_lshlrev_b32 v14, 4, v12
    v_add_u32 v10, v13, v14
    v_xor_b32 v12, 2, v12
    v_lshlrev_b32 v14, 4, v12
    v_add_u32 v11, v13, v14
    s_mul_i32 s36, s90, 131072
    s_lshr_b32 s37, s33, 1
    s_lshl_b32 s37, s37, 16
    s_add_u32 s36, s36, s37
    s_and_b32 s37, s33, 1
    s_lshl_b32 s37, s37, 12
    s_add_u32 s36, s36, s37
    s_mul_i32 s37, s33, 57344
    s_lshl_b32 s38, s91, 8
    s_add_u32 s37, s37, s38
    s_mul_i32 s38, s33, 4096
    s_lshl_b32 s39, s33, 11
    s_add_u32 s39, s39, 16384
    s_add_u32 s8, s82, s6
    s_addc_u32 s9, s83, 0
    s_mov_b32 s10, 2097152
    s_mov_b32 s11, 0x20000
    s_add_u32 s24, s82, s6
    s_addc_u32 s25, s83, 0
    s_add_u32 s24, s24, 20971520
    s_addc_u32 s25, s25, 0
    s_mov_b32 s26, 262144
    s_mov_b32 s27, 0x20000
    s_barrier
    s_add_u32 m0, s39, 0
    s_add_u32 s40, s37, 0
    buffer_load_dwordx4 v10, s[12:15], s40 offen lds
    s_add_u32 m0, s39, 1024
    s_add_u32 s40, s37, 28672
    buffer_load_dwordx4 v10, s[12:15], s40 offen lds
    s_add_u32 m0, s39, 8192
    s_add_u32 s40, s37, 128
    buffer_load_dwordx4 v10, s[12:15], s40 offen lds
    s_add_u32 m0, s39, 9216
    s_add_u32 s40, s37, 28800
    buffer_load_dwordx4 v10, s[12:15], s40 offen lds
    s_add_u32 m0, s39, 16384
    s_add_u32 s40, s37, 0
    buffer_load_dwordx4 v11, s[16:19], s40 offen lds
    s_add_u32 m0, s39, 17408
    s_add_u32 s40, s37, 28672
    buffer_load_dwordx4 v11, s[16:19], s40 offen lds
    s_add_u32 m0, s39, 24576
    s_add_u32 s40, s37, 128
    buffer_load_dwordx4 v11, s[16:19], s40 offen lds
    s_add_u32 m0, s39, 25600
    s_add_u32 s40, s37, 28800
    buffer_load_dwordx4 v11, s[16:19], s40 offen lds
    s_add_u32 m0, s39, 49152
    s_add_u32 s40, s37, 229376
    buffer_load_dwordx4 v10, s[12:15], s40 offen lds
    s_add_u32 m0, s39, 50176
    s_add_u32 s40, s37, 258048
    buffer_load_dwordx4 v10, s[12:15], s40 offen lds
    s_add_u32 m0, s39, 57344
    s_add_u32 s40, s37, 229504
    buffer_load_dwordx4 v10, s[12:15], s40 offen lds
    s_add_u32 m0, s39, 58368
    s_add_u32 s40, s37, 258176
    buffer_load_dwordx4 v10, s[12:15], s40 offen lds
    s_add_u32 m0, s39, 65536
    s_add_u32 s40, s37, 229376
    buffer_load_dwordx4 v11, s[16:19], s40 offen lds
    s_add_u32 m0, s39, 66560
    s_add_u32 s40, s37, 258048
    buffer_load_dwordx4 v11, s[16:19], s40 offen lds
    s_add_u32 m0, s39, 73728
    s_add_u32 s40, s37, 229504
    buffer_load_dwordx4 v11, s[16:19], s40 offen lds
    s_add_u32 m0, s39, 74752
    s_add_u32 s40, s37, 258176
    buffer_load_dwordx4 v11, s[16:19], s40 offen lds
    s_add_u32 m0, s39, 98304
    s_add_u32 s40, s37, 458752
    buffer_load_dwordx4 v10, s[12:15], s40 offen lds
    s_add_u32 m0, s39, 99328
    s_add_u32 s40, s37, 487424
    buffer_load_dwordx4 v10, s[12:15], s40 offen lds
    s_add_u32 m0, s39, 106496
    s_add_u32 s40, s37, 458880
    buffer_load_dwordx4 v10, s[12:15], s40 offen lds
    s_add_u32 m0, s39, 107520
    s_add_u32 s40, s37, 487552
    buffer_load_dwordx4 v10, s[12:15], s40 offen lds
    s_add_u32 m0, s39, 114688
    s_add_u32 s40, s37, 458752
    buffer_load_dwordx4 v11, s[16:19], s40 offen lds
    s_add_u32 m0, s39, 115712
    s_add_u32 s40, s37, 487424
    buffer_load_dwordx4 v11, s[16:19], s40 offen lds
    s_add_u32 m0, s39, 122880
    s_add_u32 s40, s37, 458880
    buffer_load_dwordx4 v11, s[16:19], s40 offen lds
    s_add_u32 m0, s39, 123904
    s_add_u32 s40, s37, 487552
    buffer_load_dwordx4 v11, s[16:19], s40 offen lds
    s_barrier
    s_add_u32 m0, s38, 0
    s_add_u32 s40, s36, 0
    buffer_load_dwordx4 v8, s[8:11], s40 offen sc1 lds
    s_add_u32 m0, s38, 1024
    s_add_u32 s40, s36, 1024
    buffer_load_dwordx4 v9, s[8:11], s40 offen sc1 lds
    s_add_u32 m0, s38, 2048
    s_add_u32 s40, s36, 2048
    buffer_load_dwordx4 v8, s[8:11], s40 offen sc1 lds
    s_add_u32 m0, s38, 3072
    s_add_u32 s40, s36, 3072
    buffer_load_dwordx4 v9, s[8:11], s40 offen sc1 lds
    s_add_u32 m0, s38, 49152
    s_add_u32 s40, s36, 8192
    buffer_load_dwordx4 v8, s[8:11], s40 offen sc1 lds
    s_add_u32 m0, s38, 50176
    s_add_u32 s40, s36, 9216
    buffer_load_dwordx4 v9, s[8:11], s40 offen sc1 lds
    s_add_u32 m0, s38, 51200
    s_add_u32 s40, s36, 10240
    buffer_load_dwordx4 v8, s[8:11], s40 offen sc1 lds
    s_add_u32 m0, s38, 52224
    s_add_u32 s40, s36, 11264
    buffer_load_dwordx4 v9, s[8:11], s40 offen sc1 lds
    s_add_u32 m0, s38, 98304
    s_add_u32 s40, s36, 16384
    buffer_load_dwordx4 v8, s[8:11], s40 offen sc1 lds
    s_add_u32 m0, s38, 99328
    s_add_u32 s40, s36, 17408
    buffer_load_dwordx4 v9, s[8:11], s40 offen sc1 lds
    s_add_u32 m0, s38, 100352
    s_add_u32 s40, s36, 18432
    buffer_load_dwordx4 v8, s[8:11], s40 offen sc1 lds
    s_add_u32 m0, s38, 101376
    s_add_u32 s40, s36, 19456
    buffer_load_dwordx4 v9, s[8:11], s40 offen sc1 lds
    v_lshlrev_b32 v6, 3, v4
    v_add_u32 v6, v6, v3
    v_lshlrev_b32 v6, 7, v6
    v_and_b32 v7, 3, v1
    v_lshlrev_b32 v7, 3, v7
    v_add_u32 v6, v6, v7
    v_lshrrev_b32 v7, 1, v3
    v_lshlrev_b32 v7, 6, v7
    v_add_u32 v6, v6, v7
    v_and_b32 v13, 1, v2
    v_lshlrev_b32 v7, 5, v13
    v_add_u32 v6, v6, v7
    v_lshlrev_b32 v7, 14, v13
    v_add_u32 v6, v6, v7
    s_lshr_b32 s41, s33, 1
    s_lshl_b32 s41, s41, 13
    s_add_u32 s41, s41, 16384
    v_add_u32 v6, s41, v6
    s_and_b32 s42, s33, 1
    s_lshl_b32 s42, s42, 6
    v_xor_b32 v6, s42, v6
    v_xor_b32 v7, 32, v6
    v_add_u32 v20, 0, v6
    v_add_u32 v21, 0, v7
    v_add_u32 v22, 49152, v6
    v_add_u32 v23, 49152, v7
    v_add_u32 v24, 98304, v6
    v_add_u32 v25, 98304, v7
    s_lshl_b32 s43, s33, 8
    s_add_u32 s44, s43, 128
    v_lshrrev_b32 v6, 3, v1
    v_and_b32 v6, 1, v6
    v_and_b32 v7, 1, v2
    v_xor_b32 v6, v6, v7
    v_cmp_eq_u32 vcc, 0, v6
    v_mov_b32 v7, 0x3f803f80
    s_nop 0
    v_cndmask_b32 v32, 0, v7, vcc
    v_cndmask_b32 v33, 0, v7, vcc
    v_cndmask_b32 v34, 0, v7, vcc
    v_cndmask_b32 v35, 0, v7, vcc
    v_mov_b32 v36, 0
    v_mov_b32 v37, 0
    v_mov_b32 v38, 0
    v_mov_b32 v39, 0
    v_mov_b32 v40, 0
    v_mov_b32 v41, 0
    v_mov_b32 v42, 0
    v_mov_b32 v43, 0
    s_setprio 2
    s_waitcnt vmcnt(8)
    s_barrier
    s_cmp_lg_u32 s5, 0
    s_cbranch_scc1 CSK20_0
    ds_read_b64_tr_b16 v[96:97], v20 offset:0
    ds_read_b64_tr_b16 v[98:99], v20 offset:512
    ds_read_b64_tr_b16 v[100:101], v21 offset:0
    ds_read_b64_tr_b16 v[102:103], v21 offset:512
    ds_read_b64_tr_b16 v[104:105], v20 offset:2048
    ds_read_b64_tr_b16 v[106:107], v20 offset:2560
    ds_read_b64_tr_b16 v[108:109], v21 offset:2048
    ds_read_b64_tr_b16 v[110:111], v21 offset:2560
    ds_read_b64_tr_b16 v[112:113], v20 offset:4096
    ds_read_b64_tr_b16 v[114:115], v20 offset:4608
    ds_read_b64_tr_b16 v[116:117], v21 offset:4096
    ds_read_b64_tr_b16 v[118:119], v21 offset:4608
    ds_read_b64_tr_b16 v[120:121], v20 offset:6144
    ds_read_b64_tr_b16 v[122:123], v20 offset:6656
    ds_read_b64_tr_b16 v[124:125], v21 offset:6144
    ds_read_b64_tr_b16 v[126:127], v21 offset:6656
    s_waitcnt lgkmcnt(0)
    v_mfma_f32_16x16x32_bf16 v[36:39], v[32:35], v[96:99], v[36:39]
    v_mfma_f32_16x16x32_bf16 v[40:43], v[32:35], v[100:103], v[40:43]
    v_mfma_f32_16x16x32_bf16 v[36:39], v[32:35], v[104:107], v[36:39]
    v_mfma_f32_16x16x32_bf16 v[40:43], v[32:35], v[108:111], v[40:43]
    v_mfma_f32_16x16x32_bf16 v[36:39], v[32:35], v[112:115], v[36:39]
    v_mfma_f32_16x16x32_bf16 v[40:43], v[32:35], v[116:119], v[40:43]
    v_mfma_f32_16x16x32_bf16 v[36:39], v[32:35], v[120:123], v[36:39]
    v_mfma_f32_16x16x32_bf16 v[40:43], v[32:35], v[124:127], v[40:43]
CSK20_0:
    s_waitcnt vmcnt(4)
    s_barrier
    s_add_u32 m0, s38, 0
    s_add_u32 s40, s36, 24576
    buffer_load_dwordx4 v8, s[8:11], s40 offen sc1 lds
    s_add_u32 m0, s38, 1024
    s_add_u32 s40, s36, 25600
    buffer_load_dwordx4 v9, s[8:11], s40 offen sc1 lds
    s_add_u32 m0, s38, 2048
    s_add_u32 s40, s36, 26624
    buffer_load_dwordx4 v8, s[8:11], s40 offen sc1 lds
    s_add_u32 m0, s38, 3072
    s_add_u32 s40, s36, 27648
    buffer_load_dwordx4 v9, s[8:11], s40 offen sc1 lds
    s_add_u32 m0, s39, 0
    s_add_u32 s40, s37, 688128
    buffer_load_dwordx4 v10, s[12:15], s40 offen lds
    s_add_u32 m0, s39, 1024
    s_add_u32 s40, s37, 716800
    buffer_load_dwordx4 v10, s[12:15], s40 offen lds
    s_add_u32 m0, s39, 8192
    s_add_u32 s40, s37, 688256
    buffer_load_dwordx4 v10, s[12:15], s40 offen lds
    s_add_u32 m0, s39, 9216
    s_add_u32 s40, s37, 716928
    buffer_load_dwordx4 v10, s[12:15], s40 offen lds
    s_add_u32 m0, s39, 16384
    s_add_u32 s40, s37, 688128
    buffer_load_dwordx4 v11, s[16:19], s40 offen lds
    s_add_u32 m0, s39, 17408
    s_add_u32 s40, s37, 716800
    buffer_load_dwordx4 v11, s[16:19], s40 offen lds
    s_add_u32 m0, s39, 24576
    s_add_u32 s40, s37, 688256
    buffer_load_dwordx4 v11, s[16:19], s40 offen lds
    s_add_u32 m0, s39, 25600
    s_add_u32 s40, s37, 716928
    buffer_load_dwordx4 v11, s[16:19], s40 offen lds
    s_cmp_lg_u32 s5, 0
    s_cbranch_scc1 CSK20_1
    ds_read_b64_tr_b16 v[96:97], v22 offset:0
    ds_read_b64_tr_b16 v[98:99], v22 offset:512
    ds_read_b64_tr_b16 v[100:101], v23 offset:0
    ds_read_b64_tr_b16 v[102:103], v23 offset:512
    ds_read_b64_tr_b16 v[104:105], v22 offset:2048
    ds_read_b64_tr_b16 v[106:107], v22 offset:2560
    ds_read_b64_tr_b16 v[108:109], v23 offset:2048
    ds_read_b64_tr_b16 v[110:111], v23 offset:2560
    ds_read_b64_tr_b16 v[112:113], v22 offset:4096
    ds_read_b64_tr_b16 v[114:115], v22 offset:4608
    ds_read_b64_tr_b16 v[116:117], v23 offset:4096
    ds_read_b64_tr_b16 v[118:119], v23 offset:4608
    ds_read_b64_tr_b16 v[120:121], v22 offset:6144
    ds_read_b64_tr_b16 v[122:123], v22 offset:6656
    ds_read_b64_tr_b16 v[124:125], v23 offset:6144
    ds_read_b64_tr_b16 v[126:127], v23 offset:6656
    s_waitcnt lgkmcnt(0)
    v_mfma_f32_16x16x32_bf16 v[36:39], v[32:35], v[96:99], v[36:39]
    v_mfma_f32_16x16x32_bf16 v[40:43], v[32:35], v[100:103], v[40:43]
    v_mfma_f32_16x16x32_bf16 v[36:39], v[32:35], v[104:107], v[36:39]
    v_mfma_f32_16x16x32_bf16 v[40:43], v[32:35], v[108:111], v[40:43]
    v_mfma_f32_16x16x32_bf16 v[36:39], v[32:35], v[112:115], v[36:39]
    v_mfma_f32_16x16x32_bf16 v[40:43], v[32:35], v[116:119], v[40:43]
    v_mfma_f32_16x16x32_bf16 v[36:39], v[32:35], v[120:123], v[36:39]
    v_mfma_f32_16x16x32_bf16 v[40:43], v[32:35], v[124:127], v[40:43]
CSK20_1:
    s_waitcnt vmcnt(12)
    s_barrier
    s_add_u32 m0, s38, 49152
    s_add_u32 s40, s36, 32768
    buffer_load_dwordx4 v8, s[8:11], s40 offen sc1 lds
    s_add_u32 m0, s38, 50176
    s_add_u32 s40, s36, 33792
    buffer_load_dwordx4 v9, s[8:11], s40 offen sc1 lds
    s_add_u32 m0, s38, 51200
    s_add_u32 s40, s36, 34816
    buffer_load_dwordx4 v8, s[8:11], s40 offen sc1 lds
    s_add_u32 m0, s38, 52224
    s_add_u32 s40, s36, 35840
    buffer_load_dwordx4 v9, s[8:11], s40 offen sc1 lds
    s_add_u32 m0, s39, 49152
    s_add_u32 s40, s37, 917504
    buffer_load_dwordx4 v10, s[12:15], s40 offen lds
    s_add_u32 m0, s39, 50176
    s_add_u32 s40, s37, 946176
    buffer_load_dwordx4 v10, s[12:15], s40 offen lds
    s_add_u32 m0, s39, 57344
    s_add_u32 s40, s37, 917632
    buffer_load_dwordx4 v10, s[12:15], s40 offen lds
    s_add_u32 m0, s39, 58368
    s_add_u32 s40, s37, 946304
    buffer_load_dwordx4 v10, s[12:15], s40 offen lds
    s_add_u32 m0, s39, 65536
    s_add_u32 s40, s37, 917504
    buffer_load_dwordx4 v11, s[16:19], s40 offen lds
    s_add_u32 m0, s39, 66560
    s_add_u32 s40, s37, 946176
    buffer_load_dwordx4 v11, s[16:19], s40 offen lds
    s_add_u32 m0, s39, 73728
    s_add_u32 s40, s37, 917632
    buffer_load_dwordx4 v11, s[16:19], s40 offen lds
    s_add_u32 m0, s39, 74752
    s_add_u32 s40, s37, 946304
    buffer_load_dwordx4 v11, s[16:19], s40 offen lds
    s_cmp_lg_u32 s5, 0
    s_cbranch_scc1 CSK20_2
    ds_read_b64_tr_b16 v[96:97], v24 offset:0
    ds_read_b64_tr_b16 v[98:99], v24 offset:512
    ds_read_b64_tr_b16 v[100:101], v25 offset:0
    ds_read_b64_tr_b16 v[102:103], v25 offset:512
    ds_read_b64_tr_b16 v[104:105], v24 offset:2048
    ds_read_b64_tr_b16 v[106:107], v24 offset:2560
    ds_read_b64_tr_b16 v[108:109], v25 offset:2048
    ds_read_b64_tr_b16 v[110:111], v25 offset:2560
    ds_read_b64_tr_b16 v[112:113], v24 offset:4096
    ds_read_b64_tr_b16 v[114:115], v24 offset:4608
    ds_read_b64_tr_b16 v[116:117], v25 offset:4096
    ds_read_b64_tr_b16 v[118:119], v25 offset:4608
    ds_read_b64_tr_b16 v[120:121], v24 offset:6144
    ds_read_b64_tr_b16 v[122:123], v24 offset:6656
    ds_read_b64_tr_b16 v[124:125], v25 offset:6144
    ds_read_b64_tr_b16 v[126:127], v25 offset:6656
    s_waitcnt lgkmcnt(0)
    v_mfma_f32_16x16x32_bf16 v[36:39], v[32:35], v[96:99], v[36:39]
    v_mfma_f32_16x16x32_bf16 v[40:43], v[32:35], v[100:103], v[40:43]
    v_mfma_f32_16x16x32_bf16 v[36:39], v[32:35], v[104:107], v[36:39]
    v_mfma_f32_16x16x32_bf16 v[40:43], v[32:35], v[108:111], v[40:43]
    v_mfma_f32_16x16x32_bf16 v[36:39], v[32:35], v[112:115], v[36:39]
    v_mfma_f32_16x16x32_bf16 v[40:43], v[32:35], v[116:119], v[40:43]
    v_mfma_f32_16x16x32_bf16 v[36:39], v[32:35], v[120:123], v[36:39]
    v_mfma_f32_16x16x32_bf16 v[40:43], v[32:35], v[124:127], v[40:43]
CSK20_2:
    s_waitcnt vmcnt(12)
    s_barrier
    s_add_u32 m0, s38, 98304
    s_add_u32 s40, s36, 40960
    buffer_load_dwordx4 v8, s[8:11], s40 offen sc1 lds
    s_add_u32 m0, s38, 99328
    s_add_u32 s40, s36, 41984
    buffer_load_dwordx4 v9, s[8:11], s40 offen sc1 lds
    s_add_u32 m0, s38, 100352
    s_add_u32 s40, s36, 43008
    buffer_load_dwordx4 v8, s[8:11], s40 offen sc1 lds
    s_add_u32 m0, s38, 101376
    s_add_u32 s40, s36, 44032
    buffer_load_dwordx4 v9, s[8:11], s40 offen sc1 lds
    s_add_u32 m0, s39, 98304
    s_add_u32 s40, s37, 1146880
    buffer_load_dwordx4 v10, s[12:15], s40 offen lds
    s_add_u32 m0, s39, 99328
    s_add_u32 s40, s37, 1175552
    buffer_load_dwordx4 v10, s[12:15], s40 offen lds
    s_add_u32 m0, s39, 106496
    s_add_u32 s40, s37, 1147008
    buffer_load_dwordx4 v10, s[12:15], s40 offen lds
    s_add_u32 m0, s39, 107520
    s_add_u32 s40, s37, 1175680
    buffer_load_dwordx4 v10, s[12:15], s40 offen lds
    s_add_u32 m0, s39, 114688
    s_add_u32 s40, s37, 1146880
    buffer_load_dwordx4 v11, s[16:19], s40 offen lds
    s_add_u32 m0, s39, 115712
    s_add_u32 s40, s37, 1175552
    buffer_load_dwordx4 v11, s[16:19], s40 offen lds
    s_add_u32 m0, s39, 122880
    s_add_u32 s40, s37, 1147008
    buffer_load_dwordx4 v11, s[16:19], s40 offen lds
    s_add_u32 m0, s39, 123904
    s_add_u32 s40, s37, 1175680
    buffer_load_dwordx4 v11, s[16:19], s40 offen lds
    s_cmp_lg_u32 s5, 0
    s_cbranch_scc1 CSK20_3
    ds_read_b64_tr_b16 v[96:97], v20 offset:0
    ds_read_b64_tr_b16 v[98:99], v20 offset:512
    ds_read_b64_tr_b16 v[100:101], v21 offset:0
    ds_read_b64_tr_b16 v[102:103], v21 offset:512
    ds_read_b64_tr_b16 v[104:105], v20 offset:2048
    ds_read_b64_tr_b16 v[106:107], v20 offset:2560
    ds_read_b64_tr_b16 v[108:109], v21 offset:2048
    ds_read_b64_tr_b16 v[110:111], v21 offset:2560
    ds_read_b64_tr_b16 v[112:113], v20 offset:4096
    ds_read_b64_tr_b16 v[114:115], v20 offset:4608
    ds_read_b64_tr_b16 v[116:117], v21 offset:4096
    ds_read_b64_tr_b16 v[118:119], v21 offset:4608
    ds_read_b64_tr_b16 v[120:121], v20 offset:6144
    ds_read_b64_tr_b16 v[122:123], v20 offset:6656
    ds_read_b64_tr_b16 v[124:125], v21 offset:6144
    ds_read_b64_tr_b16 v[126:127], v21 offset:6656
    s_waitcnt lgkmcnt(0)
    v_mfma_f32_16x16x32_bf16 v[36:39], v[32:35], v[96:99], v[36:39]
    v_mfma_f32_16x16x32_bf16 v[40:43], v[32:35], v[100:103], v[40:43]
    v_mfma_f32_16x16x32_bf16 v[36:39], v[32:35], v[104:107], v[36:39]
    v_mfma_f32_16x16x32_bf16 v[40:43], v[32:35], v[108:111], v[40:43]
    v_mfma_f32_16x16x32_bf16 v[36:39], v[32:35], v[112:115], v[36:39]
    v_mfma_f32_16x16x32_bf16 v[40:43], v[32:35], v[116:119], v[40:43]
    v_mfma_f32_16x16x32_bf16 v[36:39], v[32:35], v[120:123], v[36:39]
    v_mfma_f32_16x16x32_bf16 v[40:43], v[32:35], v[124:127], v[40:43]
CSK20_3:
    s_waitcnt vmcnt(12)
    s_barrier
    s_add_u32 m0, s38, 0
    s_add_u32 s40, s36, 49152
    buffer_load_dwordx4 v8, s[8:11], s40 offen sc1 lds
    s_add_u32 m0, s38, 1024
    s_add_u32 s40, s36, 50176
    buffer_load_dwordx4 v9, s[8:11], s40 offen sc1 lds
    s_add_u32 m0, s38, 2048
    s_add_u32 s40, s36, 51200
    buffer_load_dwordx4 v8, s[8:11], s40 offen sc1 lds
    s_add_u32 m0, s38, 3072
    s_add_u32 s40, s36, 52224
    buffer_load_dwordx4 v9, s[8:11], s40 offen sc1 lds
    s_add_u32 m0, s39, 0
    s_add_u32 s40, s37, 1376256
    buffer_load_dwordx4 v10, s[12:15], s40 offen lds
    s_add_u32 m0, s39, 1024
    s_add_u32 s40, s37, 1404928
    buffer_load_dwordx4 v10, s[12:15], s40 offen lds
    s_add_u32 m0, s39, 8192
    s_add_u32 s40, s37, 1376384
    buffer_load_dwordx4 v10, s[12:15], s40 offen lds
    s_add_u32 m0, s39, 9216
    s_add_u32 s40, s37, 1405056
    buffer_load_dwordx4 v10, s[12:15], s40 offen lds
    s_add_u32 m0, s39, 16384
    s_add_u32 s40, s37, 1376256
    buffer_load_dwordx4 v11, s[16:19], s40 offen lds
    s_add_u32 m0, s39, 17408
    s_add_u32 s40, s37, 1404928
    buffer_load_dwordx4 v11, s[16:19], s40 offen lds
    s_add_u32 m0, s39, 24576
    s_add_u32 s40, s37, 1376384
    buffer_load_dwordx4 v11, s[16:19], s40 offen lds
    s_add_u32 m0, s39, 25600
    s_add_u32 s40, s37, 1405056
    buffer_load_dwordx4 v11, s[16:19], s40 offen lds
    s_cmp_lg_u32 s5, 0
    s_cbranch_scc1 CSK20_4
    ds_read_b64_tr_b16 v[96:97], v22 offset:0
    ds_read_b64_tr_b16 v[98:99], v22 offset:512
    ds_read_b64_tr_b16 v[100:101], v23 offset:0
    ds_read_b64_tr_b16 v[102:103], v23 offset:512
    ds_read_b64_tr_b16 v[104:105], v22 offset:2048
    ds_read_b64_tr_b16 v[106:107], v22 offset:2560
    ds_read_b64_tr_b16 v[108:109], v23 offset:2048
    ds_read_b64_tr_b16 v[110:111], v23 offset:2560
    ds_read_b64_tr_b16 v[112:113], v22 offset:4096
    ds_read_b64_tr_b16 v[114:115], v22 offset:4608
    ds_read_b64_tr_b16 v[116:117], v23 offset:4096
    ds_read_b64_tr_b16 v[118:119], v23 offset:4608
    ds_read_b64_tr_b16 v[120:121], v22 offset:6144
    ds_read_b64_tr_b16 v[122:123], v22 offset:6656
    ds_read_b64_tr_b16 v[124:125], v23 offset:6144
    ds_read_b64_tr_b16 v[126:127], v23 offset:6656
    s_waitcnt lgkmcnt(0)
    v_mfma_f32_16x16x32_bf16 v[36:39], v[32:35], v[96:99], v[36:39]
    v_mfma_f32_16x16x32_bf16 v[40:43], v[32:35], v[100:103], v[40:43]
    v_mfma_f32_16x16x32_bf16 v[36:39], v[32:35], v[104:107], v[36:39]
    v_mfma_f32_16x16x32_bf16 v[40:43], v[32:35], v[108:111], v[40:43]
    v_mfma_f32_16x16x32_bf16 v[36:39], v[32:35], v[112:115], v[36:39]
    v_mfma_f32_16x16x32_bf16 v[40:43], v[32:35], v[116:119], v[40:43]
    v_mfma_f32_16x16x32_bf16 v[36:39], v[32:35], v[120:123], v[36:39]
    v_mfma_f32_16x16x32_bf16 v[40:43], v[32:35], v[124:127], v[40:43]
CSK20_4:
    s_waitcnt vmcnt(12)
    s_barrier
    s_add_u32 m0, s38, 49152
    s_add_u32 s40, s36, 57344
    buffer_load_dwordx4 v8, s[8:11], s40 offen sc1 lds
    s_add_u32 m0, s38, 50176
    s_add_u32 s40, s36, 58368
    buffer_load_dwordx4 v9, s[8:11], s40 offen sc1 lds
    s_add_u32 m0, s38, 51200
    s_add_u32 s40, s36, 59392
    buffer_load_dwordx4 v8, s[8:11], s40 offen sc1 lds
    s_add_u32 m0, s38, 52224
    s_add_u32 s40, s36, 60416
    buffer_load_dwordx4 v9, s[8:11], s40 offen sc1 lds
    s_add_u32 m0, s39, 49152
    s_add_u32 s40, s37, 1605632
    buffer_load_dwordx4 v10, s[12:15], s40 offen lds
    s_add_u32 m0, s39, 50176
    s_add_u32 s40, s37, 1634304
    buffer_load_dwordx4 v10, s[12:15], s40 offen lds
    s_add_u32 m0, s39, 57344
    s_add_u32 s40, s37, 1605760
    buffer_load_dwordx4 v10, s[12:15], s40 offen lds
    s_add_u32 m0, s39, 58368
    s_add_u32 s40, s37, 1634432
    buffer_load_dwordx4 v10, s[12:15], s40 offen lds
    s_add_u32 m0, s39, 65536
    s_add_u32 s40, s37, 1605632
    buffer_load_dwordx4 v11, s[16:19], s40 offen lds
    s_add_u32 m0, s39, 66560
    s_add_u32 s40, s37, 1634304
    buffer_load_dwordx4 v11, s[16:19], s40 offen lds
    s_add_u32 m0, s39, 73728
    s_add_u32 s40, s37, 1605760
    buffer_load_dwordx4 v11, s[16:19], s40 offen lds
    s_add_u32 m0, s39, 74752
    s_add_u32 s40, s37, 1634432
    buffer_load_dwordx4 v11, s[16:19], s40 offen lds
    s_mul_i32 s45, s90, 4
    s_and_b32 s46, s33, 3
    s_add_u32 s45, s45, s46
    s_lshl_b32 s45, s45, 12
    v_lshlrev_b32 v15, 11, v4
    v_lshlrev_b32 v14, 3, v5
    v_add_u32 v15, v15, v14
    buffer_load_dwordx2 v[128:129], v15, s[24:27], s45 offen offset:0 sc1
    buffer_load_dwordx2 v[130:131], v15, s[24:27], s45 offen offset:256 sc1
    buffer_load_dwordx2 v[132:133], v15, s[24:27], s45 offen offset:512 sc1
    buffer_load_dwordx2 v[134:135], v15, s[24:27], s45 offen offset:768 sc1
    buffer_load_dwordx2 v[136:137], v15, s[24:27], s45 offen offset:1024 sc1
    buffer_load_dwordx2 v[138:139], v15, s[24:27], s45 offen offset:1280 sc1
    buffer_load_dwordx2 v[140:141], v15, s[24:27], s45 offen offset:1536 sc1
    buffer_load_dwordx2 v[142:143], v15, s[24:27], s45 offen offset:1792 sc1
    s_cmp_lg_u32 s5, 0
    s_cbranch_scc1 CSK20_5
    ds_read_b64_tr_b16 v[96:97], v24 offset:0
    ds_read_b64_tr_b16 v[98:99], v24 offset:512
    ds_read_b64_tr_b16 v[100:101], v25 offset:0
    ds_read_b64_tr_b16 v[102:103], v25 offset:512
    ds_read_b64_tr_b16 v[104:105], v24 offset:2048
    ds_read_b64_tr_b16 v[106:107], v24 offset:2560
    ds_read_b64_tr_b16 v[108:109], v25 offset:2048
    ds_read_b64_tr_b16 v[110:111], v25 offset:2560
    ds_read_b64_tr_b16 v[112:113], v24 offset:4096
    ds_read_b64_tr_b16 v[114:115], v24 offset:4608
    ds_read_b64_tr_b16 v[116:117], v25 offset:4096
    ds_read_b64_tr_b16 v[118:119], v25 offset:4608
    ds_read_b64_tr_b16 v[120:121], v24 offset:6144
    ds_read_b64_tr_b16 v[122:123], v24 offset:6656
    ds_read_b64_tr_b16 v[124:125], v25 offset:6144
    ds_read_b64_tr_b16 v[126:127], v25 offset:6656
    s_waitcnt lgkmcnt(0)
    v_mfma_f32_16x16x32_bf16 v[36:39], v[32:35], v[96:99], v[36:39]
    v_mfma_f32_16x16x32_bf16 v[40:43], v[32:35], v[100:103], v[40:43]
    v_mfma_f32_16x16x32_bf16 v[36:39], v[32:35], v[104:107], v[36:39]
    v_mfma_f32_16x16x32_bf16 v[40:43], v[32:35], v[108:111], v[40:43]
    v_mfma_f32_16x16x32_bf16 v[36:39], v[32:35], v[112:115], v[36:39]
    v_mfma_f32_16x16x32_bf16 v[40:43], v[32:35], v[116:119], v[40:43]
    v_mfma_f32_16x16x32_bf16 v[36:39], v[32:35], v[120:123], v[36:39]
    v_mfma_f32_16x16x32_bf16 v[40:43], v[32:35], v[124:127], v[40:43]
CSK20_5:
    s_waitcnt vmcnt(20)
    s_barrier
    s_cmp_lg_u32 s5, 0
    s_cbranch_scc1 CSK20_6
    ds_read_b64_tr_b16 v[96:97], v20 offset:0
    ds_read_b64_tr_b16 v[98:99], v20 offset:512
    ds_read_b64_tr_b16 v[100:101], v21 offset:0
    ds_read_b64_tr_b16 v[102:103], v21 offset:512
    ds_read_b64_tr_b16 v[104:105], v20 offset:2048
    ds_read_b64_tr_b16 v[106:107], v20 offset:2560
    ds_read_b64_tr_b16 v[108:109], v21 offset:2048
    ds_read_b64_tr_b16 v[110:111], v21 offset:2560
    ds_read_b64_tr_b16 v[112:113], v20 offset:4096
    ds_read_b64_tr_b16 v[114:115], v20 offset:4608
    ds_read_b64_tr_b16 v[116:117], v21 offset:4096
    ds_read_b64_tr_b16 v[118:119], v21 offset:4608
    ds_read_b64_tr_b16 v[120:121], v20 offset:6144
    ds_read_b64_tr_b16 v[122:123], v20 offset:6656
    ds_read_b64_tr_b16 v[124:125], v21 offset:6144
    ds_read_b64_tr_b16 v[126:127], v21 offset:6656
    s_waitcnt lgkmcnt(0)
    v_mfma_f32_16x16x32_bf16 v[36:39], v[32:35], v[96:99], v[36:39]
    v_mfma_f32_16x16x32_bf16 v[40:43], v[32:35], v[100:103], v[40:43]
    v_mfma_f32_16x16x32_bf16 v[36:39], v[32:35], v[104:107], v[36:39]
    v_mfma_f32_16x16x32_bf16 v[40:43], v[32:35], v[108:111], v[40:43]
    v_mfma_f32_16x16x32_bf16 v[36:39], v[32:35], v[112:115], v[36:39]
    v_mfma_f32_16x16x32_bf16 v[40:43], v[32:35], v[116:119], v[40:43]
    v_mfma_f32_16x16x32_bf16 v[36:39], v[32:35], v[120:123], v[36:39]
    v_mfma_f32_16x16x32_bf16 v[40:43], v[32:35], v[124:127], v[40:43]
CSK20_6:
    s_waitcnt vmcnt(8)
    s_barrier
    s_cmp_lg_u32 s5, 0
    s_cbranch_scc1 CSK20_7
    ds_read_b64_tr_b16 v[96:97], v22 offset:0
    ds_read_b64_tr_b16 v[98:99], v22 offset:512
    ds_read_b64_tr_b16 v[100:101], v23 offset:0
    ds_read_b64_tr_b16 v[102:103], v23 offset:512
    ds_read_b64_tr_b16 v[104:105], v22 offset:2048
    ds_read_b64_tr_b16 v[106:107], v22 offset:2560
    ds_read_b64_tr_b16 v[108:109], v23 offset:2048
    ds_read_b64_tr_b16 v[110:111], v23 offset:2560
    ds_read_b64_tr_b16 v[112:113], v22 offset:4096
    ds_read_b64_tr_b16 v[114:115], v22 offset:4608
    ds_read_b64_tr_b16 v[116:117], v23 offset:4096
    ds_read_b64_tr_b16 v[118:119], v23 offset:4608
    ds_read_b64_tr_b16 v[120:121], v22 offset:6144
    ds_read_b64_tr_b16 v[122:123], v22 offset:6656
    ds_read_b64_tr_b16 v[124:125], v23 offset:6144
    ds_read_b64_tr_b16 v[126:127], v23 offset:6656
    s_waitcnt lgkmcnt(0)
    v_mfma_f32_16x16x32_bf16 v[36:39], v[32:35], v[96:99], v[36:39]
    v_mfma_f32_16x16x32_bf16 v[40:43], v[32:35], v[100:103], v[40:43]
    v_mfma_f32_16x16x32_bf16 v[36:39], v[32:35], v[104:107], v[36:39]
    v_mfma_f32_16x16x32_bf16 v[40:43], v[32:35], v[108:111], v[40:43]
    v_mfma_f32_16x16x32_bf16 v[36:39], v[32:35], v[112:115], v[36:39]
    v_mfma_f32_16x16x32_bf16 v[40:43], v[32:35], v[116:119], v[40:43]
    v_mfma_f32_16x16x32_bf16 v[36:39], v[32:35], v[120:123], v[36:39]
    v_mfma_f32_16x16x32_bf16 v[40:43], v[32:35], v[124:127], v[40:43]
CSK20_7:
    s_waitcnt vmcnt(0)
    v_add_f32 v128, v128, v130
    v_add_f32 v129, v129, v131
    v_add_f32 v128, v128, v132
    v_add_f32 v129, v129, v133
    v_add_f32 v128, v128, v134
    v_add_f32 v129, v129, v135
    v_add_f32 v128, v128, v136
    v_add_f32 v129, v129, v137
    v_add_f32 v128, v128, v138
    v_add_f32 v129, v129, v139
    v_add_f32 v128, v128, v140
    v_add_f32 v129, v129, v141
    v_add_f32 v128, v128, v142
    v_add_f32 v129, v129, v143
    v_mov_b32 v130, v128
    v_mov_b32 v131, v129
    s_nop 0
    v_permlane32_swap_b32 v128, v130
    v_permlane32_swap_b32 v129, v131
    v_add_f32 v128, v128, v130
    v_add_f32 v129, v129, v131
    s_and_b32 s46, s33, 3
    s_lshl_b32 s46, s46, 7
    s_add_u32 s46, s46, 147456
    v_lshlrev_b32 v6, 2, v5
    v_add_u32 v6, s46, v6
    v_mul_f32 v128, 0x3b000000, v128
    v_mul_f32 v129, 0x3b000000, v129
    v_fma_f32 v129, -v128, v128, v129
    v_max_f32 v129, 0, v129
    v_add_f32 v129, 0x3727c5ac, v129
    v_rsq_f32 v129, v129
    ds_write_b32 v6, v128 offset:0
    ds_write_b32 v6, v129 offset:512
    s_cmp_lg_u32 s5, 0
    s_cbranch_scc1 CSK20_E
    v_lshlrev_b32 v6, 4, v4
    v_and_b32 v7, 15, v1
    v_add_u32 v6, v6, v7
    v_lshlrev_b32 v6, 2, v6
    v_add_u32 v6, 149504, v6
    v_add_u32 v7, s43, v6
    v_add_u32 v6, s44, v6
    ds_write_b32 v7, v36
    ds_write_b32 v6, v40
CSK20_E:
    s_waitcnt lgkmcnt(0)
    s_setprio 0
    s_barrier
H_P5PRE:
    s_mov_b32 s12, s76
    s_mov_b32 s13, s77
    s_mov_b32 s14, 1835008
    s_mov_b32 s15, 0x20000
    v_lshlrev_b32 v8, 4, v1
    v_lshrrev_b32 v6, 3, v1
    v_and_b32 v7, 7, v1
    v_lshlrev_b32 v6, 10, v6
    v_and_b32 v12, 1, v2
    v_lshlrev_b32 v12, 2, v12
    v_xor_b32 v12, v12, v7
    v_lshlrev_b32 v12, 4, v12
    v_add_u32 v10, v6, v12
    s_lshl_b32 s36, s88, 1
    s_lshr_b32 s37, s33, 1
    s_add_u32 s36, s36, s37
    s_mul_i32 s36, s36, 114688
    s_and_b32 s37, s33, 1
    s_lshl_b32 s37, s37, 12
    s_add_u32 s36, s36, s37
    s_lshl_b32 s38, s33, 12
    s_lshl_b32 s37, s33, 15
    s_lshl_b32 s39, s89, 7
    s_add_u32 s37, s37, s39
    s_add_u32 s8, s82, s6
    s_addc_u32 s9, s83, 0
    s_add_u32 s8, s8, 12582912
    s_addc_u32 s9, s9, 0
    s_mov_b32 s10, 7340032
    s_mov_b32 s11, 0x20000
    s_cmp_ge_u32 s2, 224
    s_cbranch_scc1 H_P5ND
    s_barrier
H_P5ND:
    s_add_u32 m0, s38, 0
    s_add_u32 s40, s37, 0
    buffer_load_dwordx4 v10, s[12:15], s40 offen lds
    s_add_u32 m0, s38, 1024
    s_add_u32 s40, s37, 8192
    buffer_load_dwordx4 v10, s[12:15], s40 offen lds
    s_add_u32 m0, s38, 2048
    s_add_u32 s40, s37, 16384
    buffer_load_dwordx4 v10, s[12:15], s40 offen lds
    s_add_u32 m0, s38, 3072
    s_add_u32 s40, s37, 24576
    buffer_load_dwordx4 v10, s[12:15], s40 offen lds
    s_add_u32 m0, s38, 16384
    s_add_u32 s40, s37, 131072
    buffer_load_dwordx4 v10, s[12:15], s40 offen lds
    s_add_u32 m0, s38, 17408
    s_add_u32 s40, s37, 139264
    buffer_load_dwordx4 v10, s[12:15], s40 offen lds
    s_add_u32 m0, s38, 18432
    s_add_u32 s40, s37, 147456
    buffer_load_dwordx4 v10, s[12:15], s40 offen lds
    s_add_u32 m0, s38, 19456
    s_add_u32 s40, s37, 155648
    buffer_load_dwordx4 v10, s[12:15], s40 offen lds
    s_add_u32 m0, s38, 32768
    s_add_u32 s40, s37, 262144
    buffer_load_dwordx4 v10, s[12:15], s40 offen lds
    s_add_u32 m0, s38, 33792
    s_add_u32 s40, s37, 270336
    buffer_load_dwordx4 v10, s[12:15], s40 offen lds
    s_add_u32 m0, s38, 34816
    s_add_u32 s40, s37, 278528
    buffer_load_dwordx4 v10, s[12:15], s40 offen lds
    s_add_u32 m0, s38, 35840
    s_add_u32 s40, s37, 286720
    buffer_load_dwordx4 v10, s[12:15], s40 offen lds
    s_add_u32 m0, s38, 49152
    s_add_u32 s40, s37, 393216
    buffer_load_dwordx4 v10, s[12:15], s40 offen lds
    s_add_u32 m0, s38, 50176
    s_add_u32 s40, s37, 401408
    buffer_load_dwordx4 v10, s[12:15], s40 offen lds
    s_add_u32 m0, s38, 51200
    s_add_u32 s40, s37, 409600
    buffer_load_dwordx4 v10, s[12:15], s40 offen lds
    s_add_u32 m0, s38, 52224
    s_add_u32 s40, s37, 417792
    buffer_load_dwordx4 v10, s[12:15], s40 offen lds
    s_add_u32 m0, s38, 65536
    s_add_u32 s40, s37, 524288
    buffer_load_dwordx4 v10, s[12:15], s40 offen lds
    s_add_u32 m0, s38, 66560
    s_add_u32 s40, s37, 532480
    buffer_load_dwordx4 v10, s[12:15], s40 offen lds
    s_add_u32 m0, s38, 67584
    s_add_u32 s40, s37, 540672
    buffer_load_dwordx4 v10, s[12:15], s40 offen lds
    s_add_u32 m0, s38, 68608
    s_add_u32 s40, s37, 548864
    buffer_load_dwordx4 v10, s[12:15], s40 offen lds
    s_add_u32 m0, s38, 81920
    s_add_u32 s40, s37, 655360
    buffer_load_dwordx4 v10, s[12:15], s40 offen lds
    s_add_u32 m0, s38, 82944
    s_add_u32 s40, s37, 663552
    buffer_load_dwordx4 v10, s[12:15], s40 offen lds
    s_add_u32 m0, s38, 83968
    s_add_u32 s40, s37, 671744
    buffer_load_dwordx4 v10, s[12:15], s40 offen lds
    s_add_u32 m0, s38, 84992
    s_add_u32 s40, s37, 679936
    buffer_load_dwordx4 v10, s[12:15], s40 offen lds
    s_barrier
    s_setprio 2
    s_add_u32 m0, s38, 98304
    s_add_u32 s40, s36, 0
    buffer_load_dwordx4 v8, s[8:11], s40 offen sc1 lds
    s_add_u32 m0, s38, 99328
    s_add_u32 s40, s36, 1024
    buffer_load_dwordx4 v8, s[8:11], s40 offen sc1 lds
    s_add_u32 m0, s38, 100352
    s_add_u32 s40, s36, 2048
    buffer_load_dwordx4 v8, s[8:11], s40 offen sc1 lds
    s_add_u32 m0, s38, 101376
    s_add_u32 s40, s36, 3072
    buffer_load_dwordx4 v8, s[8:11], s40 offen sc1 lds
    s_add_u32 m0, s38, 114688
    s_add_u32 s40, s36, 8192
    buffer_load_dwordx4 v8, s[8:11], s40 offen sc1 lds
    s_add_u32 m0, s38, 115712
    s_add_u32 s40, s36, 9216
    buffer_load_dwordx4 v8, s[8:11], s40 offen sc1 lds
    s_add_u32 m0, s38, 116736
    s_add_u32 s40, s36, 10240
    buffer_load_dwordx4 v8, s[8:11], s40 offen sc1 lds
    s_add_u32 m0, s38, 117760
    s_add_u32 s40, s36, 11264
    buffer_load_dwordx4 v8, s[8:11], s40 offen sc1 lds
    s_add_u32 m0, s38, 131072
    s_add_u32 s40, s36, 16384
    buffer_load_dwordx4 v8, s[8:11], s40 offen sc1 lds
    s_add_u32 m0, s38, 132096
    s_add_u32 s40, s36, 17408
    buffer_load_dwordx4 v8, s[8:11], s40 offen sc1 lds
    s_add_u32 m0, s38, 133120
    s_add_u32 s40, s36, 18432
    buffer_load_dwordx4 v8, s[8:11], s40 offen sc1 lds
    s_add_u32 m0, s38, 134144
    s_add_u32 s40, s36, 19456
    buffer_load_dwordx4 v8, s[8:11], s40 offen sc1 lds
    s_waitcnt vmcnt(8)
    s_barrier
    s_waitcnt vmcnt(4)
    s_barrier
    s_add_u32 m0, s38, 0
    s_add_u32 s40, s36, 24576
    buffer_load_dwordx4 v8, s[8:11], s40 offen sc1 lds
    s_add_u32 m0, s38, 1024
    s_add_u32 s40, s36, 25600
    buffer_load_dwordx4 v8, s[8:11], s40 offen sc1 lds
    s_add_u32 m0, s38, 2048
    s_add_u32 s40, s36, 26624
    buffer_load_dwordx4 v8, s[8:11], s40 offen sc1 lds
    s_add_u32 m0, s38, 3072
    s_add_u32 s40, s36, 27648
    buffer_load_dwordx4 v8, s[8:11], s40 offen sc1 lds
    s_add_u32 m0, s38, 98304
    s_add_u32 s40, s36, 32768
    buffer_load_dwordx4 v8, s[8:11], s40 offen sc1 lds
    s_add_u32 m0, s38, 99328
    s_add_u32 s40, s36, 33792
    buffer_load_dwordx4 v8, s[8:11], s40 offen sc1 lds
    s_add_u32 m0, s38, 100352
    s_add_u32 s40, s36, 34816
    buffer_load_dwordx4 v8, s[8:11], s40 offen sc1 lds
    s_add_u32 m0, s38, 101376
    s_add_u32 s40, s36, 35840
    buffer_load_dwordx4 v8, s[8:11], s40 offen sc1 lds
    s_waitcnt vmcnt(8)
    s_barrier
    s_add_u32 m0, s38, 16384
    s_add_u32 s40, s36, 40960
    buffer_load_dwordx4 v8, s[8:11], s40 offen sc1 lds
    s_add_u32 m0, s38, 17408
    s_add_u32 s40, s36, 41984
    buffer_load_dwordx4 v8, s[8:11], s40 offen sc1 lds
    s_add_u32 m0, s38, 18432
    s_add_u32 s40, s36, 43008
    buffer_load_dwordx4 v8, s[8:11], s40 offen sc1 lds
    s_add_u32 m0, s38, 19456
    s_add_u32 s40, s36, 44032
    buffer_load_dwordx4 v8, s[8:11], s40 offen sc1 lds
    s_add_u32 m0, s38, 114688
    s_add_u32 s40, s37, 786432
    buffer_load_dwordx4 v10, s[12:15], s40 offen lds
    s_add_u32 m0, s38, 115712
    s_add_u32 s40, s37, 794624
    buffer_load_dwordx4 v10, s[12:15], s40 offen lds
    s_add_u32 m0, s38, 116736
    s_add_u32 s40, s37, 802816
    buffer_load_dwordx4 v10, s[12:15], s40 offen lds
    s_add_u32 m0, s38, 117760
    s_add_u32 s40, s37, 811008
    buffer_load_dwordx4 v10, s[12:15], s40 offen lds
    s_waitcnt vmcnt(12)
    s_barrier
    s_add_u32 m0, s38, 32768
    s_add_u32 s40, s36, 49152
    buffer_load_dwordx4 v8, s[8:11], s40 offen sc1 lds
    s_add_u32 m0, s38, 33792
    s_add_u32 s40, s36, 50176
    buffer_load_dwordx4 v8, s[8:11], s40 offen sc1 lds
    s_add_u32 m0, s38, 34816
    s_add_u32 s40, s36, 51200
    buffer_load_dwordx4 v8, s[8:11], s40 offen sc1 lds
    s_add_u32 m0, s38, 35840
    s_add_u32 s40, s36, 52224
    buffer_load_dwordx4 v8, s[8:11], s40 offen sc1 lds
    s_add_u32 m0, s38, 131072
    s_add_u32 s40, s37, 917504
    buffer_load_dwordx4 v10, s[12:15], s40 offen lds
    s_add_u32 m0, s38, 132096
    s_add_u32 s40, s37, 925696
    buffer_load_dwordx4 v10, s[12:15], s40 offen lds
    s_add_u32 m0, s38, 133120
    s_add_u32 s40, s37, 933888
    buffer_load_dwordx4 v10, s[12:15], s40 offen lds
    s_add_u32 m0, s38, 134144
    s_add_u32 s40, s37, 942080
    buffer_load_dwordx4 v10, s[12:15], s40 offen lds
    s_waitcnt vmcnt(16)
    s_barrier
    s_add_u32 m0, s38, 49152
    s_add_u32 s40, s36, 57344
    buffer_load_dwordx4 v8, s[8:11], s40 offen sc1 lds
    s_add_u32 m0, s38, 50176
    s_add_u32 s40, s36, 58368
    buffer_load_dwordx4 v8, s[8:11], s40 offen sc1 lds
    s_add_u32 m0, s38, 51200
    s_add_u32 s40, s36, 59392
    buffer_load_dwordx4 v8, s[8:11], s40 offen sc1 lds
    s_add_u32 m0, s38, 52224
    s_add_u32 s40, s36, 60416
    buffer_load_dwordx4 v8, s[8:11], s40 offen sc1 lds
    s_add_u32 m0, s38, 0
    s_add_u32 s40, s37, 1048576
    buffer_load_dwordx4 v10, s[12:15], s40 offen lds
    s_add_u32 m0, s38, 1024
    s_add_u32 s40, s37, 1056768
    buffer_load_dwordx4 v10, s[12:15], s40 offen lds
    s_add_u32 m0, s38, 2048
    s_add_u32 s40, s37, 1064960
    buffer_load_dwordx4 v10, s[12:15], s40 offen lds
    s_add_u32 m0, s38, 3072
    s_add_u32 s40, s37, 1073152
    buffer_load_dwordx4 v10, s[12:15], s40 offen lds
    s_waitcnt vmcnt(20)
    s_barrier
    s_add_u32 m0, s38, 65536
    s_add_u32 s40, s36, 65536
    buffer_load_dwordx4 v8, s[8:11], s40 offen sc1 lds
    s_add_u32 m0, s38, 66560
    s_add_u32 s40, s36, 66560
    buffer_load_dwordx4 v8, s[8:11], s40 offen sc1 lds
    s_add_u32 m0, s38, 67584
    s_add_u32 s40, s36, 67584
    buffer_load_dwordx4 v8, s[8:11], s40 offen sc1 lds
    s_add_u32 m0, s38, 68608
    s_add_u32 s40, s36, 68608
    buffer_load_dwordx4 v8, s[8:11], s40 offen sc1 lds
    s_add_u32 m0, s38, 98304
    s_add_u32 s40, s37, 1179648
    buffer_load_dwordx4 v10, s[12:15], s40 offen lds
    s_add_u32 m0, s38, 99328
    s_add_u32 s40, s37, 1187840
    buffer_load_dwordx4 v10, s[12:15], s40 offen lds
    s_add_u32 m0, s38, 100352
    s_add_u32 s40, s37, 1196032
    buffer_load_dwordx4 v10, s[12:15], s40 offen lds
    s_add_u32 m0, s38, 101376
    s_add_u32 s40, s37, 1204224
    buffer_load_dwordx4 v10, s[12:15], s40 offen lds
    s_waitcnt vmcnt(20)
    s_barrier
    s_add_u32 m0, s38, 81920
    s_add_u32 s40, s36, 73728
    buffer_load_dwordx4 v8, s[8:11], s40 offen sc1 lds
    s_add_u32 m0, s38, 82944
    s_add_u32 s40, s36, 74752
    buffer_load_dwordx4 v8, s[8:11], s40 offen sc1 lds
    s_add_u32 m0, s38, 83968
    s_add_u32 s40, s36, 75776
    buffer_load_dwordx4 v8, s[8:11], s40 offen sc1 lds
    s_add_u32 m0, s38, 84992
    s_add_u32 s40, s36, 76800
    buffer_load_dwordx4 v8, s[8:11], s40 offen sc1 lds
    s_add_u32 m0, s38, 16384
    s_add_u32 s40, s37, 1310720
    buffer_load_dwordx4 v10, s[12:15], s40 offen lds
    s_add_u32 m0, s38, 17408
    s_add_u32 s40, s37, 1318912
    buffer_load_dwordx4 v10, s[12:15], s40 offen lds
    s_add_u32 m0, s38, 18432
    s_add_u32 s40, s37, 1327104
    buffer_load_dwordx4 v10, s[12:15], s40 offen lds
    s_add_u32 m0, s38, 19456
    s_add_u32 s40, s37, 1335296
    buffer_load_dwordx4 v10, s[12:15], s40 offen lds
    s_waitcnt vmcnt(20)
    s_barrier
    s_add_u32 m0, s38, 114688
    s_add_u32 s40, s36, 81920
    buffer_load_dwordx4 v8, s[8:11], s40 offen sc1 lds
    s_add_u32 m0, s38, 115712
    s_add_u32 s40, s36, 82944
    buffer_load_dwordx4 v8, s[8:11], s40 offen sc1 lds
    s_add_u32 m0, s38, 116736
    s_add_u32 s40, s36, 83968
    buffer_load_dwordx4 v8, s[8:11], s40 offen sc1 lds
    s_add_u32 m0, s38, 117760
    s_add_u32 s40, s36, 84992
    buffer_load_dwordx4 v8, s[8:11], s40 offen sc1 lds
    s_add_u32 m0, s38, 32768
    s_add_u32 s40, s37, 1441792
    buffer_load_dwordx4 v10, s[12:15], s40 offen lds
    s_add_u32 m0, s38, 33792
    s_add_u32 s40, s37, 1449984
    buffer_load_dwordx4 v10, s[12:15], s40 offen lds
    s_add_u32 m0, s38, 34816
    s_add_u32 s40, s37, 1458176
    buffer_load_dwordx4 v10, s[12:15], s40 offen lds
    s_add_u32 m0, s38, 35840
    s_add_u32 s40, s37, 1466368
    buffer_load_dwordx4 v10, s[12:15], s40 offen lds
    s_waitcnt vmcnt(20)
    s_barrier
    s_add_u32 m0, s38, 131072
    s_add_u32 s40, s36, 90112
    buffer_load_dwordx4 v8, s[8:11], s40 offen sc1 lds
    s_add_u32 m0, s38, 132096
    s_add_u32 s40, s36, 91136
    buffer_load_dwordx4 v8, s[8:11], s40 offen sc1 lds
    s_add_u32 m0, s38, 133120
    s_add_u32 s40, s36, 92160
    buffer_load_dwordx4 v8, s[8:11], s40 offen sc1 lds
    s_add_u32 m0, s38, 134144
    s_add_u32 s40, s36, 93184
    buffer_load_dwordx4 v8, s[8:11], s40 offen sc1 lds
    s_add_u32 m0, s38, 49152
    s_add_u32 s40, s37, 1572864
    buffer_load_dwordx4 v10, s[12:15], s40 offen lds
    s_add_u32 m0, s38, 50176
    s_add_u32 s40, s37, 1581056
    buffer_load_dwordx4 v10, s[12:15], s40 offen lds
    s_add_u32 m0, s38, 51200
    s_add_u32 s40, s37, 1589248
    buffer_load_dwordx4 v10, s[12:15], s40 offen lds
    s_add_u32 m0, s38, 52224
    s_add_u32 s40, s37, 1597440
    buffer_load_dwordx4 v10, s[12:15], s40 offen lds
    s_waitcnt vmcnt(20)
    s_barrier
    s_add_u32 m0, s38, 0
    s_add_u32 s40, s36, 98304
    buffer_load_dwordx4 v8, s[8:11], s40 offen sc1 lds
    s_add_u32 m0, s38, 1024
    s_add_u32 s40, s36, 99328
    buffer_load_dwordx4 v8, s[8:11], s40 offen sc1 lds
    s_add_u32 m0, s38, 2048
    s_add_u32 s40, s36, 100352
    buffer_load_dwordx4 v8, s[8:11], s40 offen sc1 lds
    s_add_u32 m0, s38, 3072
    s_add_u32 s40, s36, 101376
    buffer_load_dwordx4 v8, s[8:11], s40 offen sc1 lds
    s_add_u32 m0, s38, 65536
    s_add_u32 s40, s37, 1703936
    buffer_load_dwordx4 v10, s[12:15], s40 offen lds
    s_add_u32 m0, s38, 66560
    s_add_u32 s40, s37, 1712128
    buffer_load_dwordx4 v10, s[12:15], s40 offen lds
    s_add_u32 m0, s38, 67584
    s_add_u32 s40, s37, 1720320
    buffer_load_dwordx4 v10, s[12:15], s40 offen lds
    s_add_u32 m0, s38, 68608
    s_add_u32 s40, s37, 1728512
    buffer_load_dwordx4 v10, s[12:15], s40 offen lds
    s_waitcnt vmcnt(20)
    s_barrier
    s_add_u32 m0, s38, 98304
    s_add_u32 s40, s36, 106496
    buffer_load_dwordx4 v8, s[8:11], s40 offen sc1 lds
    s_add_u32 m0, s38, 99328
    s_add_u32 s40, s36, 107520
    buffer_load_dwordx4 v8, s[8:11], s40 offen sc1 lds
    s_add_u32 m0, s38, 100352
    s_add_u32 s40, s36, 108544
    buffer_load_dwordx4 v8, s[8:11], s40 offen sc1 lds
    s_add_u32 m0, s38, 101376
    s_add_u32 s40, s36, 109568
    buffer_load_dwordx4 v8, s[8:11], s40 offen sc1 lds
    s_waitcnt vmcnt(16)
    s_barrier
    s_waitcnt vmcnt(8)
    s_barrier
    s_waitcnt vmcnt(0)
    s_barrier
    s_setprio 0
    s_cmp_eq_u32 s5, 1
    s_cbranch_scc1 H_FIN
    s_sub_u32 s33, s3, 4
    s_mov_b32 s12, s66
    s_mov_b32 s13, s67
    s_mov_b32 s14, 1572864
    s_mov_b32 s15, 0x20000
    v_lshrrev_b32 v6, 3, v1
    v_and_b32 v7, 7, v1
    v_lshlrev_b32 v8, 4, v1
    v_lshlrev_b32 v9, 4, v1
    s_mov_b32 s35, 3072
    v_mul_lo_u32 v13, v6, s35
    v_and_b32 v12, 1, v2
    v_lshlrev_b32 v12, 2, v12
    v_xor_b32 v12, v12, v7
    v_lshlrev_b32 v14, 4, v12
    v_add_u32 v10, v13, v14
    s_mul_i32 s36, s85, 65536
    s_lshl_b32 s37, s33, 11
    s_add_u32 s36, s36, s37
    s_mul_i32 s37, s33, 49152
    s_lshl_b32 s38, s84, 7
    s_add_u32 s37, s37, s38
    s_mul_i32 s38, s33, 2048
    s_lshl_b32 s39, s33, 11
    s_add_u32 s39, s39, 49152
    s_barrier
    s_add_u32 m0, s39, 0
    s_add_u32 s40, s37, 0
    buffer_load_dwordx4 v10, s[12:15], s40 offen lds
    s_add_u32 m0, s39, 1024
    s_add_u32 s40, s37, 24576
    buffer_load_dwordx4 v10, s[12:15], s40 offen lds
    s_add_u32 m0, s39, 8192
    s_add_u32 s40, s37, 1024
    buffer_load_dwordx4 v10, s[12:15], s40 offen lds
    s_add_u32 m0, s39, 9216
    s_add_u32 s40, s37, 25600
    buffer_load_dwordx4 v10, s[12:15], s40 offen lds
    s_add_u32 m0, s39, 16384
    s_add_u32 s40, s37, 2048
    buffer_load_dwordx4 v10, s[12:15], s40 offen lds
    s_add_u32 m0, s39, 17408
    s_add_u32 s40, s37, 26624
    buffer_load_dwordx4 v10, s[12:15], s40 offen lds
    s_add_u32 m0, s39, 24576
    s_add_u32 s40, s37, 196608
    buffer_load_dwordx4 v10, s[12:15], s40 offen lds
    s_add_u32 m0, s39, 25600
    s_add_u32 s40, s37, 221184
    buffer_load_dwordx4 v10, s[12:15], s40 offen lds
    s_add_u32 m0, s39, 32768
    s_add_u32 s40, s37, 197632
    buffer_load_dwordx4 v10, s[12:15], s40 offen lds
    s_add_u32 m0, s39, 33792
    s_add_u32 s40, s37, 222208
    buffer_load_dwordx4 v10, s[12:15], s40 offen lds
    s_add_u32 m0, s39, 40960
    s_add_u32 s40, s37, 198656
    buffer_load_dwordx4 v10, s[12:15], s40 offen lds
    s_add_u32 m0, s39, 41984
    s_add_u32 s40, s37, 223232
    buffer_load_dwordx4 v10, s[12:15], s40 offen lds
    s_add_u32 m0, s39, 49152
    s_add_u32 s40, s37, 393216
    buffer_load_dwordx4 v10, s[12:15], s40 offen lds
    s_add_u32 m0, s39, 50176
    s_add_u32 s40, s37, 417792
    buffer_load_dwordx4 v10, s[12:15], s40 offen lds
    s_add_u32 m0, s39, 57344
    s_add_u32 s40, s37, 394240
    buffer_load_dwordx4 v10, s[12:15], s40 offen lds
    s_add_u32 m0, s39, 58368
    s_add_u32 s40, s37, 418816
    buffer_load_dwordx4 v10, s[12:15], s40 offen lds
    s_add_u32 m0, s39, 65536
    s_add_u32 s40, s37, 395264
    buffer_load_dwordx4 v10, s[12:15], s40 offen lds
    s_add_u32 m0, s39, 66560
    s_add_u32 s40, s37, 419840
    buffer_load_dwordx4 v10, s[12:15], s40 offen lds
    s_add_u32 m0, s39, 73728
    s_add_u32 s40, s37, 589824
    buffer_load_dwordx4 v10, s[12:15], s40 offen lds
    s_add_u32 m0, s39, 74752
    s_add_u32 s40, s37, 614400
    buffer_load_dwordx4 v10, s[12:15], s40 offen lds
    s_add_u32 m0, s39, 81920
    s_add_u32 s40, s37, 590848
    buffer_load_dwordx4 v10, s[12:15], s40 offen lds
    s_add_u32 m0, s39, 82944
    s_add_u32 s40, s37, 615424
    buffer_load_dwordx4 v10, s[12:15], s40 offen lds
    s_add_u32 m0, s39, 90112
    s_add_u32 s40, s37, 591872
    buffer_load_dwordx4 v10, s[12:15], s40 offen lds
    s_add_u32 m0, s39, 91136
    s_add_u32 s40, s37, 616448
    buffer_load_dwordx4 v10, s[12:15], s40 offen lds
    s_mov_b32 s5, 1
    s_mov_b32 s6, 33554432
    s_branch H_P1B
H_FIN:
KEND:
    s_endpgm
.section .rodata,"a"
.p2align 6
.amdhsa_kernel interleave_layers__softmax_full_mha__glu_gated_glu__prompt_kernel
  .amdhsa_next_free_vgpr 256
  .amdhsa_next_free_sgpr 102
  .amdhsa_accum_offset 256
  .amdhsa_group_segment_fixed_size 0
  .amdhsa_kernarg_size 80
  .amdhsa_user_sgpr_count 2
  .amdhsa_user_sgpr_kernarg_segment_ptr 1
  .amdhsa_system_sgpr_workgroup_id_x 1
  .amdhsa_float_denorm_mode_32 3
.end_amdhsa_kernel
```
